```python
import torch

def _softmax(x, axis=-1):
    return torch.softmax(x, dim=axis)
def _gelu(x):
    return torch.nn.functional.gelu(x, approximate="tanh")
def _silu(x):
    return torch.nn.functional.silu(x)
def _sigmoid(x):
    return torch.sigmoid(x)
def _layernorm(x, axis=-1, eps=1e-5):
    m = x.mean(dim=axis, keepdim=True)
    v = x.var(dim=axis, keepdim=True, unbiased=False)
    return (x - m) / torch.sqrt(v + eps)
def _scatter_add(tgt, idx, src, axis=0):
    return tgt.clone().index_add_(axis, idx, src)
def _segment_sum(src, seg, n):
    out = torch.zeros((n,) + src.shape[1:], dtype=src.dtype)
    return out.index_add_(0, seg, src)
def _pad(x, pw):
    flat = tuple(v for pair in reversed(pw) for v in pair)
    return torch.nn.functional.pad(x, flat)

kernel_name = 'parallel_sum__ssm_conv_s4d__mixer_channel_mlp__prompt'

def setup_inputs():

    _w = (lambda a: (lambda t: t.to(torch.bfloat16) if t.is_floating_point() else t)(torch.as_tensor(a)))
    def _A_setup():
        Bsz, L, D, N = 1, 2048, 640, 128
        return {
            "u": _w((lambda *s: torch.randn(*s, dtype=torch.bfloat16) * 0.05)(Bsz, L, D)),
            "log_A_real": _w((lambda *s: torch.randn(*s, dtype=torch.bfloat16) * 3.2)(D, N) * 0.5),
            "A_imag": _w((lambda *s: torch.randn(*s, dtype=torch.bfloat16) * 0.05)(D, N) * 3.14),
            "C_real": _w((lambda *s: torch.randn(*s, dtype=torch.bfloat16) * 0.1)(D, N) / N ** 0.5),
            "C_imag": _w((lambda *s: torch.randn(*s, dtype=torch.bfloat16) * 0.2)(D, N) / N ** 0.5),
            "log_dt": _w((lambda *s: torch.randn(*s, dtype=torch.bfloat16) * 0.05)(D) * 0.5 - 4.0),
            "D_skip": _w((lambda *s: torch.randn(*s, dtype=torch.bfloat16) * 0.05)(D)),
        }
    _A_in = _A_setup()

    def _B_setup():
        B, S, D, F = 1, 2048, 640, 1728
        return {
            "x": _w((lambda *s: torch.randn(*s, dtype=torch.bfloat16) * 0.05)(B, S, D)),
            "w1": _w((lambda *s: torch.randn(*s, dtype=torch.bfloat16) * 1.6)(D, F) * (D ** -0.5)),
            "b1": _w((lambda *s: torch.randn(*s, dtype=torch.bfloat16) * 0.8)(F)),
            "w2": _w((lambda *s: torch.randn(*s, dtype=torch.bfloat16) * 0.05)(F, D) * (F ** -0.5)),
            "b2": _w((lambda *s: torch.randn(*s, dtype=torch.bfloat16) * 0.05)(D)),
        }
    _B_in = _B_setup()

    return {
        "A_u": _A_in["u"],
        "A_log_A_real": _A_in["log_A_real"],
        "A_A_imag": _A_in["A_imag"],
        "A_C_real": _A_in["C_real"],
        "A_C_imag": _A_in["C_imag"],
        "A_log_dt": _A_in["log_dt"],
        "A_D_skip": _A_in["D_skip"],
        "B_x": _B_in["x"],
        "B_w1": _B_in["w1"],
        "B_b1": _B_in["b1"],
        "B_w2": _B_in["w2"],
        "B_b2": _B_in["b2"],
    }

def reference(A_u, A_log_A_real, A_A_imag, A_C_real, A_C_imag, A_log_dt, A_D_skip, B_x, B_w1, B_b1, B_w2, B_b2):
    def _A_ref(u, log_A_real, A_imag, C_real, C_imag, log_dt, D_skip):
        L = u.shape[1]
        dt = torch.exp(log_dt)
        A = -torch.exp(log_A_real) + 1j * A_imag
        C = (C_real + 1j * C_imag) * dt[:, None]
        pos = (lambda x, dt: x.to(dt))(torch.arange(L), log_dt.dtype)
        P = torch.exp((A * dt[:, None])[:, :, None] * pos[None, None, :])
        K = 2.0 * torch.einsum("dn,dnl->dl", C, P).real
        L2 = 2 * L
        u_t = (lambda x, *d: x.permute(*d))(u, 0, 2, 1)
        Kf = (lambda x, *a, **k: torch.fft.rfft(x.float(), *a, **k))(K, L2)
        Uf = (lambda x, *a, **k: torch.fft.rfft(x.float(), *a, **k))(u_t, L2)
        y = (lambda x, *a, **k: torch.fft.irfft(x, *a, **k).to(torch.bfloat16))(Uf * Kf[None, :, :], L2)[:, :, :L]
        y = (lambda x, *d: x.permute(*d))(y, 0, 2, 1)
        return y + u * D_skip[None, None, :]

    def _B_ref(x, w1, b1, w2, b2):
        y = _layernorm(x, axis=-1)
        h = _gelu(torch.einsum("bsd,df->bsf", y, w1) + b1)
        return torch.einsum("bsf,fd->bsd", h, w2) + b2

    x = A_u
    xn = _layernorm(x, axis=-1)
    return x + _A_ref(xn, A_log_A_real, A_A_imag, A_C_real, A_C_imag, A_log_dt, A_D_skip) + _B_ref(xn, B_w1, B_b1, B_w2, B_b2)
```

```asm
; @launch grid=(256,1,1) block=(256,1,1) lds=163840
.amdgcn_target "amdgcn-amd-amdhsa--gfx950"
.text
.globl parallel_sum__ssm_conv_s4d__mixer_channel_mlp__prompt_kernel
.p2align 8
.type parallel_sum__ssm_conv_s4d__mixer_channel_mlp__prompt_kernel,@function
parallel_sum__ssm_conv_s4d__mixer_channel_mlp__prompt_kernel:
    s_load_dwordx16 s[4:19], s[0:1], 0
    s_load_dwordx8 s[20:27], s[0:1], 64
    s_load_dwordx4 s[28:31], s[0:1], 96
    s_load_dwordx2 s[32:33], s[0:1], 112
    s_cmp_lt_u32 s2, 256
    s_cbranch_scc1 L_go
    s_endpgm
L_go:
    v_lshrrev_b32_e64 v1, 6, v0
    v_and_b32 v0, 63, v0
    s_lshr_b32 s35, s2, 3
    v_readfirstlane_b32 s3, v1
    s_and_b32 s34, s2, 7
    v_lshlrev_b32 v1, 4, v0
    s_cmp_lg_u32 s3, 3
    s_cbranch_scc1 Lpf_1
    s_getpc_b64 s[56:57]
Lpc_2:
    s_sub_u32 s56, s56, Lpc_2-L_go
    s_subb_u32 s57, s57, 0
    s_and_b32 s58, s35, 7
    s_mul_i32 s58, s58, 44
    v_min_u32 v2, 43, v0
    v_add_u32 v2, s58, v2
    v_lshlrev_b32 v2, 7, v2
    v_min_u32 v2, L_codeend-L_go-128, v2
    v_mov_b32 v3, s57
    v_add_co_u32 v2, vcc, s56, v2
    s_nop 1
    v_addc_co_u32 v3, vcc, 0, v3, vcc
    global_load_dword v255, v[2:3], off
Lpf_1:
    s_cmp_lt_u32 s35, 4
    s_cbranch_scc1 L_F
    s_sub_u32 s61, s35, 4
    s_cmp_lt_u32 s61, 20
    s_cselect_b32 s93, 0, 1
    s_cbranch_scc0 L_N0
    s_mul_i32 s86, s34, 20
    s_add_u32 s86, s86, s61
    s_lshl_b32 s56, s86, 2
    s_add_u32 s56, s56, s3
    s_lshl_b32 s57, s56, 8
    v_lshl_add_u32 v24, v0, 2, s57
    s_lshl_b32 s57, s56, 1
    v_mov_b32 v25, s57
    s_waitcnt lgkmcnt(0)
    global_load_dword v40, v24, s[6:7]
    global_load_ushort v38, v25, s[14:15]
    global_load_dword v41, v24, s[8:9]
    global_load_dword v42, v24, s[10:11]
    global_load_dword v43, v24, s[12:13]
    global_load_ushort v39, v25, s[16:17]
    global_load_ushort v25, v25, s[26:27]
L_Gs:
    s_and_b32 s56, s61, 3
    s_lshr_b32 s57, s34, 1
    s_lshl_b32 s57, s57, 2
    s_add_u32 s88, s56, s57
    s_lshr_b32 s56, s61, 2
    s_and_b32 s57, s34, 1
    s_mul_i32 s57, s57, 7
    s_add_u32 s89, s56, s57
    s_lshl_b32 s65, s3, 12
    s_lshl_b32 s56, s88, 2
    s_add_u32 s56, s56, s3
    s_mul_i32 s66, s56, 40960
    s_mul_i32 s67, s3, 55296
    s_lshl_b32 s57, s89, 8
    s_add_u32 s67, s67, s57
    s_lshr_b32 s56, s61, 2
    s_mul_i32 s56, s56, 47
    s_lshr_b32 s56, s56, 5
    s_and_b32 s57, s61, 3
    s_mul_i32 s57, s57, 5
    s_lshr_b32 s57, s57, 1
    s_add_u32 s64, s56, s57
    s_sub_u32 s56, s64, 10
    s_cmp_ge_u32 s64, 10
    s_cselect_b32 s64, s56, s64
    s_lshl_b32 s56, s64, 7
    s_add_u32 s66, s66, s56
    s_sub_u32 s95, s66, 1280
    s_mul_i32 s56, s64, 221184
    s_add_u32 s67, s67, s56
    s_sub_u32 s69, s67, 2211840
    v_lshrrev_b32 v6, 3, v0
    v_and_b32 v7, 7, v0
    v_lshrrev_b32 v8, 4, v0
    v_xor_b32 v8, v8, v7
    v_mul_u32_u24 v9, 1280, v6
    v_lshl_add_u32 v10, v8, 4, v9
    v_xor_b32_e64 v8, 4, v8
    v_lshl_add_u32 v11, v8, 4, v9
    v_add_u32 v11, 9216, v11
    v_add_u32 v12, 18432, v10
    v_add_u32 v13, 18432, v11
    v_lshrrev_b32 v6, 4, v0
    v_and_b32 v7, 15, v0
    v_lshlrev_b32 v8, 2, v6
    v_xor_b32 v8, v8, v7
    v_mul_u32_u24 v9, 3456, v6
    v_lshl_add_u32 v14, v8, 4, v9
    v_lshlrev_b32 v7, 28, v8
    s_cmp_eq_u32 s89, 13
    s_cselect_b32 s56, 0x80000000, 0
    v_and_b32 v7, s56, v7
    v_or_b32 v14, v14, v7
    v_add_u32 v15, 12800, v14
    v_add_u32 v16, 25600, v14
    v_add_u32 v17, 38400, v14
    s_mov_b32 s36, s4
    s_mov_b32 s37, s5
    s_mov_b32 s38, 2621440
    s_mov_b32 s39, 0x20000
    s_mov_b32 s40, s20
    s_mov_b32 s41, s21
    s_mov_b32 s42, 2211840
    s_mov_b32 s43, 0x20000
    s_cmp_eq_u32 s93, 0
    s_cbranch_scc0 L_Gi
    s_add_u32 m0, s65, 0
    s_cmp_ge_u32 s64, 10
    s_cselect_b32 s83, s95, s66
    s_add_u32 s83, s83, 0
    buffer_load_dwordx4 v10, s[36:39], s83 offen lds
    buffer_load_dwordx4 v11, s[36:39], s83 offen offset:1024 lds
    buffer_load_dwordx4 v12, s[36:39], s83 offen offset:2048 lds
    buffer_load_dwordx4 v13, s[36:39], s83 offen offset:3072 lds
    s_add_u32 m0, s65, 16384
    s_cmp_ge_u32 s64, 10
    s_cselect_b32 s83, s69, s67
    s_add_u32 s83, s83, 0
    s_nop 0
    buffer_load_dwordx4 v14, s[40:43], s83 offen lds
    buffer_load_dwordx4 v15, s[40:43], s83 offen offset:1024 lds
    buffer_load_dwordx4 v16, s[40:43], s83 offen offset:2048 lds
    buffer_load_dwordx4 v17, s[40:43], s83 offen offset:3072 lds
    s_add_u32 m0, s65, 32768
    s_cmp_ge_u32 s64, 9
    s_cselect_b32 s83, s95, s66
    s_add_u32 s83, s83, 128
    buffer_load_dwordx4 v10, s[36:39], s83 offen lds
    buffer_load_dwordx4 v11, s[36:39], s83 offen offset:1024 lds
L_Gi:
    s_mov_b32 s44, s32
    s_mov_b32 s45, s33
    s_mov_b32 s46, 14942208
    s_mov_b32 s47, 0x20000
    s_mov_b32 s48, s28
    s_mov_b32 s49, s29
    s_mov_b32 s50, 2621440
    s_mov_b32 s51, 0x20000
    v_mov_b32_e64 v254, 0
    buffer_load_dword v254, v254, s[44:47], 0 offen sc1
    s_and_b32 s56, s3, 1
    s_lshl_b32 s57, s88, 1
    s_add_u32 s56, s56, s57
    s_lshl_b32 s82, s56, 10
    s_add_u32 s82, s82, 32768
    s_mul_i32 s84, s56, 221184
    s_lshl_b32 s97, s56, 12
    s_lshr_b32 s56, s3, 1
    s_lshl_b32 s57, s89, 1
    s_add_u32 s56, s56, s57
    s_lshl_b32 s57, s56, 7
    s_add_u32 s97, s97, s57
    s_add_u32 s97, s97, 14680064
    s_lshl_b32 s57, s56, 11
    s_add_u32 s84, s84, s57
    s_add_u32 s84, s84, 7602176
    s_add_u32 s85, s84, 110592
    s_cmp_eq_u32 s56, 27
    s_cselect_b32 s84, 0x80000000, s84
    s_cselect_b32 s85, 0x80000000, s85
    s_cselect_b32 s56, 26, s56
    s_lshl_b32 s80, s56, 10
    s_add_u32 s80, s80, 65536
    s_sub_u32 s56, s35, 4
    s_mul_i32 s57, s56, 52
    s_lshr_b32 s57, s57, 8
    s_mul_i32 s58, s57, 5
    s_sub_u32 s56, s56, s58
    s_lshl_b32 s59, s57, 1
    s_add_u32 s60, s57, s56
    s_cmp_lt_u32 s56, 2
    s_cselect_b32 s58, 2, 0
    s_cselect_b32 s56, 0, 1
    s_add_u32 s60, s60, s58
    s_add_u32 s59, s59, s56
    s_sub_u32 s56, s35, 24
    s_lshr_b32 s57, s56, 1
    s_add_u32 s57, s57, 1
    s_cmp_ge_u32 s35, 24
    s_cselect_b32 s59, s56, s59
    s_cselect_b32 s60, s57, s60
    s_and_b32 s60, s60, 3
    s_lshr_b32 s56, s34, 1
    s_lshl_b32 s56, s56, 3
    s_add_u32 s59, s59, s56
    s_and_b32 s56, s34, 1
    s_lshl_b32 s56, s56, 2
    s_add_u32 s60, s60, s56
    s_mul_i32 s90, s60, 276480
    s_mul_i32 s91, s3, 5120
    s_add_u32 s90, s90, s91
    s_add_u32 s90, s90, 5373952
    v_add_u32 v2, 0x1000, v1
    s_add_u32 s77, s90, 266240
    s_cmp_lt_u32 s3, 2
    s_cselect_b32 s77, s77, 0x80000000
    v_and_b32 v6, 31, v0
    v_lshrrev_b32 v7, 5, v0
    v_lshlrev_b32_e64 v4, 4, v6
    v_lshl_add_u32 v5, v7, 31, v4
    v_bfe_u32 v8, v0, 1, 3
    v_xor_b32_e64 v8, v8, v7
    s_and_b32 s56, s3, 1
    s_lshl_b32 s56, s56, 13
    v_lshl_add_u32 v9, v6, 7, s56
    v_xor_b32_e64 v6, 0, v8
    v_lshl_add_u32 v240, v6, 4, v9
    v_add_u32 v241, 0x10000, v240
    v_add_u32 v242, 0x20000, v240
    v_xor_b32_e64 v6, 2, v8
    v_lshl_add_u32 v243, v6, 4, v9
    v_add_u32 v244, 0x10000, v243
    v_add_u32 v245, 0x20000, v243
    v_xor_b32_e64 v6, 4, v8
    v_lshl_add_u32 v246, v6, 4, v9
    v_add_u32 v247, 0x10000, v246
    v_add_u32 v248, 0x20000, v246
    v_xor_b32_e64 v6, 6, v8
    v_lshl_add_u32 v249, v6, 4, v9
    v_add_u32 v250, 0x10000, v249
    v_add_u32 v251, 0x20000, v249
    v_bfe_u32 v6, v0, 2, 2
    v_lshl_add_u32 v8, v7, 3, v6
    v_lshlrev_b32_e64 v8, 8, v8
    v_bfe_u32 v9, v0, 4, 1
    v_lshl_add_u32 v8, v9, 5, v8
    v_mul_u32_u24 v3, 55296, v9
    v_lshl_add_u32 v3, v7, 8, v3
    v_and_b32_e64 v9, 3, v0
    v_lshl_add_u32 v8, v9, 3, v8
    s_and_b32 s56, s3, 2
    v_xor_b32 v6, s56, v6
    v_lshl_add_u32 v18, v6, 6, v8
    v_xor_b32_e64 v21, 64, v18
    v_add_u32 v19, 0x10000, v18
    v_add_u32 v20, 0x20000, v18
    v_add_u32 v22, 0x10000, v21
    v_add_u32 v23, 0x20000, v21
    v_and_b32_e64 v6, 15, v0
    v_lshl_add_u32 v3, v6, 4, v3
    s_cmp_eq_u32 s93, 0
    s_cbranch_scc0 L_Npack
    s_lshl_b32 s56, s3, 13
    s_nop 0
    s_add_u32 s56, s56, 131072
    v_xor_b32_e64 v8, 0, v0
    v_lshl_add_u32 v228, v8, 4, s56
    v_xor_b32_e64 v8, 1, v0
    v_lshl_add_u32 v229, v8, 4, s56
    v_xor_b32_e64 v8, 4, v0
    v_lshl_add_u32 v230, v8, 4, s56
    v_xor_b32_e64 v8, 5, v0
    v_lshl_add_u32 v231, v8, 4, s56
    v_xor_b32_e64 v8, 8, v0
    v_lshl_add_u32 v232, v8, 4, s56
    v_xor_b32_e64 v8, 9, v0
    v_lshl_add_u32 v233, v8, 4, s56
    v_xor_b32_e64 v8, 12, v0
    v_lshl_add_u32 v234, v8, 4, s56
    v_xor_b32_e64 v8, 13, v0
    v_lshl_add_u32 v235, v8, 4, s56
    v_bfe_u32 v6, v0, 1, 1
    v_bfe_u32 v7, v0, 2, 2
    v_lshl_add_u32 v6, v7, 2, v6
    v_lshrrev_b32 v7, 4, v0
    v_lshlrev_b32 v7, 1, v7
    v_xor_b32_e64 v6, v6, v7
    v_bfe_u32 v7, v0, 1, 3
    v_lshl_add_u32 v7, v7, 10, s56
    v_and_b32_e64 v8, 1, v0
    v_lshl_add_u32 v7, v8, 3, v7
    v_xor_b32_e64 v8, 0, v6
    v_lshl_add_u32 v236, v8, 4, v7
    v_xor_b32_e64 v8, 1, v6
    v_lshl_add_u32 v237, v8, 4, v7
    v_xor_b32_e64 v8, 8, v6
    v_lshl_add_u32 v238, v8, 4, v7
    v_xor_b32_e64 v8, 9, v6
    v_lshl_add_u32 v239, v8, 4, v7
    v_and_b32 v44, 15, v0
    v_lshrrev_b32 v45, 4, v0
    v_lshlrev_b32 v45, 3, v45
    v_sub_u32 v44, v45, v44
    v_and_b32 v45, 0xffff, v44
    v_lshl_add_u32 v44, v44, 16, v45
    s_mov_b32 s56, 0x3f803f80
    v_mov_b32 v46, 0xfff5fff4
    v_pk_add_i16 v46, v44, v46
    v_pk_sub_i16 v47, 0, v46
    v_pk_max_i16 v48, v46, v47
    v_mov_b32 v46, 0xfff7fff6
    v_pk_add_i16 v46, v44, v46
    v_pk_sub_i16 v47, 0, v46
    v_pk_max_i16 v49, v46, v47
    v_mov_b32 v46, 0xfff9fff8
    v_pk_add_i16 v46, v44, v46
    v_pk_sub_i16 v47, 0, v46
    v_pk_max_i16 v50, v46, v47
    v_mov_b32 v46, 0xfffbfffa
    v_pk_add_i16 v46, v44, v46
    v_pk_sub_i16 v47, 0, v46
    v_pk_max_i16 v51, v46, v47
    v_mov_b32 v46, 0x20002
    v_pk_sub_i16 v52, v48, v46
    v_pk_sub_i16 v53, v49, v46
    v_pk_sub_i16 v54, v50, v46
    v_pk_sub_i16 v55, v51, v46
    v_pk_ashrrev_i16 v52, 15, v52 op_sel_hi:[0,1]
    v_pk_ashrrev_i16 v53, 15, v53 op_sel_hi:[0,1]
    v_pk_ashrrev_i16 v54, 15, v54 op_sel_hi:[0,1]
    v_pk_ashrrev_i16 v55, 15, v55 op_sel_hi:[0,1]
    v_and_b32 v52, s56, v52
    v_and_b32 v53, s56, v53
    v_and_b32 v54, s56, v54
    v_and_b32 v55, s56, v55
    v_accvgpr_write_b32 a224, v52
    v_accvgpr_write_b32 a225, v53
    v_accvgpr_write_b32 a226, v54
    v_accvgpr_write_b32 a227, v55
    v_mov_b32 v46, 0x30003
    v_pk_sub_i16 v52, v48, v46
    v_pk_sub_i16 v53, v49, v46
    v_pk_sub_i16 v54, v50, v46
    v_pk_sub_i16 v55, v51, v46
    v_pk_ashrrev_i16 v52, 15, v52 op_sel_hi:[0,1]
    v_pk_ashrrev_i16 v53, 15, v53 op_sel_hi:[0,1]
    v_pk_ashrrev_i16 v54, 15, v54 op_sel_hi:[0,1]
    v_pk_ashrrev_i16 v55, 15, v55 op_sel_hi:[0,1]
    v_and_b32 v52, s56, v52
    v_and_b32 v53, s56, v53
    v_and_b32 v54, s56, v54
    v_and_b32 v55, s56, v55
    v_accvgpr_write_b32 a228, v52
    v_accvgpr_write_b32 a229, v53
    v_accvgpr_write_b32 a230, v54
    v_accvgpr_write_b32 a231, v55
    v_mov_b32 v46, 0x40004
    v_pk_sub_i16 v52, v48, v46
    v_pk_sub_i16 v53, v49, v46
    v_pk_sub_i16 v54, v50, v46
    v_pk_sub_i16 v55, v51, v46
    v_pk_ashrrev_i16 v52, 15, v52 op_sel_hi:[0,1]
    v_pk_ashrrev_i16 v53, 15, v53 op_sel_hi:[0,1]
    v_pk_ashrrev_i16 v54, 15, v54 op_sel_hi:[0,1]
    v_pk_ashrrev_i16 v55, 15, v55 op_sel_hi:[0,1]
    v_and_b32 v52, s56, v52
    v_and_b32 v53, s56, v53
    v_and_b32 v54, s56, v54
    v_and_b32 v55, s56, v55
    v_accvgpr_write_b32 a232, v52
    v_accvgpr_write_b32 a233, v53
    v_accvgpr_write_b32 a234, v54
    v_accvgpr_write_b32 a235, v55
    v_mov_b32 v46, 0x50005
    v_pk_sub_i16 v52, v48, v46
    v_pk_sub_i16 v53, v49, v46
    v_pk_sub_i16 v54, v50, v46
    v_pk_sub_i16 v55, v51, v46
    v_pk_ashrrev_i16 v52, 15, v52 op_sel_hi:[0,1]
    v_pk_ashrrev_i16 v53, 15, v53 op_sel_hi:[0,1]
    v_pk_ashrrev_i16 v54, 15, v54 op_sel_hi:[0,1]
    v_pk_ashrrev_i16 v55, 15, v55 op_sel_hi:[0,1]
    v_and_b32 v52, s56, v52
    v_and_b32 v53, s56, v53
    v_and_b32 v54, s56, v54
    v_and_b32 v55, s56, v55
    v_accvgpr_write_b32 a236, v52
    v_accvgpr_write_b32 a237, v53
    v_accvgpr_write_b32 a238, v54
    v_accvgpr_write_b32 a239, v55
    v_mov_b32 v46, 0xfffafff9
    v_pk_add_i16 v46, v44, v46
    v_pk_sub_i16 v47, 0, v46
    v_pk_max_i16 v48, v46, v47
    v_mov_b32 v46, 0xfffcfffb
    v_pk_add_i16 v46, v44, v46
    v_pk_sub_i16 v47, 0, v46
    v_pk_max_i16 v49, v46, v47
    v_mov_b32 v46, 0xfffefffd
    v_pk_add_i16 v46, v44, v46
    v_pk_sub_i16 v47, 0, v46
    v_pk_max_i16 v50, v46, v47
    v_mov_b32 v46, 0xffff
    v_pk_add_i16 v46, v44, v46
    v_pk_sub_i16 v47, 0, v46
    v_pk_max_i16 v51, v46, v47
    v_mov_b32 v46, 0x40004
    v_pk_sub_i16 v52, v48, v46
    v_pk_sub_i16 v53, v49, v46
    v_pk_sub_i16 v54, v50, v46
    v_pk_sub_i16 v55, v51, v46
    v_pk_ashrrev_i16 v52, 15, v52 op_sel_hi:[0,1]
    v_pk_ashrrev_i16 v53, 15, v53 op_sel_hi:[0,1]
    v_pk_ashrrev_i16 v54, 15, v54 op_sel_hi:[0,1]
    v_pk_ashrrev_i16 v55, 15, v55 op_sel_hi:[0,1]
    v_accvgpr_write_b32 a220, v52
    v_accvgpr_write_b32 a221, v53
    v_accvgpr_write_b32 a222, v54
    v_accvgpr_write_b32 a223, v55
    v_and_b32_e64 v200, 15, v0
    v_bfe_u32 v201, v0, 4, 1
    v_cmp_gt_u32 s[54:55], 32, v0
    v_lshlrev_b32_e64 v201, 3, v201
    v_mov_b32 v203, 0x3f80
    v_sub_u32 v200, v200, v201
    v_and_b32 v201, 1, v200
    v_ashrrev_i32 v200, 1, v200
    v_lshlrev_b32 v201, 4, v201
    v_lshlrev_b32_e64 v203, v201, v203
    v_cmp_eq_u32 s[100:101], 0, v200
    s_nop 1
    v_cndmask_b32 v202, 0, v203, s[100:101]
    v_cndmask_b32 v192, 0, v202, s[54:55]
    v_sub_u32 v196, v202, v192
    v_cmp_eq_u32 s[100:101], 1, v200
    s_nop 1
    v_cndmask_b32 v202, 0, v203, s[100:101]
    v_cndmask_b32 v193, 0, v202, s[54:55]
    v_sub_u32 v197, v202, v193
    v_cmp_eq_u32 s[100:101], 2, v200
    s_nop 1
    v_cndmask_b32 v202, 0, v203, s[100:101]
    v_cndmask_b32 v194, 0, v202, s[54:55]
    v_sub_u32 v198, v202, v194
    v_cmp_eq_u32 s[100:101], 3, v200
    s_nop 1
    s_nop 0
    v_cndmask_b32 v202, 0, v203, s[100:101]
    v_cndmask_b32 v195, 0, v202, s[54:55]
    v_sub_u32_e64 v199, v202, v195
    v_accvgpr_write_b32 a208, v192
    v_accvgpr_write_b32 a209, v193
    v_accvgpr_write_b32 a210, v194
    v_accvgpr_write_b32 a211, v195
    v_accvgpr_write_b32 a212, v196
    v_accvgpr_write_b32 a213, v197
    v_accvgpr_write_b32 a214, v198
    v_accvgpr_write_b32 a215, v199
    s_waitcnt vmcnt(12)
    v_lshlrev_b32 v38, 16, v38
    v_mul_f32 v38, 0x3fb8aa3b, v38
    v_exp_f32 v38, v38
    v_lshlrev_b32 v39, 16, v39
    v_cvt_pk_bf16_f32 v38, v38, v38
    v_and_b32 v38, 0xffff0000, v38
    v_lshlrev_b32 v96, 16, v40
    v_lshlrev_b32 v97, 16, v41
    v_lshlrev_b32 v98, 16, v42
    v_lshlrev_b32 v99, 16, v43
    v_and_b32 v144, 0xffff0000, v40
    v_and_b32 v145, 0xffff0000, v41
    v_and_b32 v146, 0xffff0000, v42
    v_and_b32 v147, 0xffff0000, v43
    v_mul_f32 v96, 0x3fb8aa3b, v96
    v_mul_f32_e64 v97, v97, v38
    v_mul_f32 v144, 0x3fb8aa3b, v144
    v_mul_f32 v145, v145, v38
    v_exp_f32 v96, v96
    v_exp_f32 v144, v144
    v_mul_f32 v97, 0x3e22f983, v97
    v_mul_f32 v98, v98, v38
    v_mul_f32 v99, v99, v38
    v_mul_f32 v145, 0x3e22f983, v145
    v_mul_f32 v146, v146, v38
    v_mul_f32_e64 v147, v147, v38
    v_cvt_pk_bf16_f32 v96, v96, v96
    v_and_b32 v96, 0xffff0000, v96
    v_cvt_pk_bf16_f32 v144, v144, v144
    v_and_b32 v144, 0xffff0000, v144
    v_mul_f32 v96, v96, v38
    v_add_f32 v68, v98, v98
    v_add_f32 v69, v99, v99
    v_mul_f32 v144, v144, v38
    v_add_f32 v116, v146, v146
    v_add_f32 v117, v147, v147
    v_mul_f32 v96, 0xbfb8aa3b, v96
    v_mul_f32 v144, 0xbfb8aa3b, v144
    v_mul_f32 v98, 0x43000000, v96
    v_mul_f32 v99, 0x43000000, v97
    v_mul_f32 v146, 0x43000000, v144
    v_mul_f32 v147, 0x43000000, v145
    v_fract_f32 v97, v97
    v_fract_f32 v99, v99
    v_fract_f32 v145, v145
    v_fract_f32 v147, v147
    v_exp_f32 v96, v96
    v_exp_f32 v98, v98
    v_cos_f32 v56, v97
    v_sin_f32 v57, v97
    v_cos_f32 v60, v99
    v_sin_f32 v61, v99
    v_exp_f32 v144, v144
    v_exp_f32 v146, v146
    v_cos_f32 v104, v145
    v_sin_f32 v105, v145
    v_cos_f32 v108, v147
    v_sin_f32 v109, v147
    v_pk_mul_f32 v[56:57], v[56:57], v[96:97] op_sel_hi:[1,0]
    v_pk_mul_f32 v[60:61], v[60:61], v[98:99] op_sel_hi:[1,0]
    v_pk_mul_f32 v[104:105], v[104:105], v[144:145] op_sel_hi:[1,0]
    v_pk_mul_f32 v[108:109], v[108:109], v[146:147] op_sel_hi:[1,0]
    v_pk_mul_f32 v[44:45], v[56:57], v[56:57] op_sel_hi:[1,0]
    v_pk_mul_f32 v[46:47], v[104:105], v[104:105] op_sel_hi:[1,0]
    v_pk_mul_f32 v[48:49], v[60:61], v[60:61] op_sel_hi:[1,0]
    v_pk_mul_f32 v[50:51], v[108:109], v[108:109] op_sel_hi:[1,0]
    v_pk_fma_f32 v[58:59], v[56:57], v[56:57], v[44:45] op_sel:[1,1,0] op_sel_hi:[0,1,1] neg_lo:[0,1,0]
    v_pk_fma_f32 v[106:107], v[104:105], v[104:105], v[46:47] op_sel:[1,1,0] op_sel_hi:[0,1,1] neg_lo:[0,1,0]
    v_pk_fma_f32 v[62:63], v[60:61], v[60:61], v[48:49] op_sel:[1,1,0] op_sel_hi:[0,1,1] neg_lo:[0,1,0]
    v_pk_fma_f32 v[110:111], v[108:109], v[108:109], v[50:51] op_sel:[1,1,0] op_sel_hi:[0,1,1] neg_lo:[0,1,0]
    v_pk_mul_f32 v[44:45], v[58:59], v[58:59] op_sel_hi:[1,0]
    v_pk_mul_f32 v[46:47], v[106:107], v[106:107] op_sel_hi:[1,0]
    v_pk_mul_f32 v[48:49], v[62:63], v[62:63] op_sel_hi:[1,0]
    v_pk_mul_f32 v[50:51], v[110:111], v[110:111] op_sel_hi:[1,0]
    v_pk_fma_f32 v[58:59], v[58:59], v[58:59], v[44:45] op_sel:[1,1,0] op_sel_hi:[0,1,1] neg_lo:[0,1,0]
    v_pk_fma_f32 v[106:107], v[106:107], v[106:107], v[46:47] op_sel:[1,1,0] op_sel_hi:[0,1,1] neg_lo:[0,1,0]
    v_pk_fma_f32 v[64:65], v[62:63], v[62:63], v[48:49] op_sel:[1,1,0] op_sel_hi:[0,1,1] neg_lo:[0,1,0]
    v_pk_fma_f32 v[112:113], v[110:111], v[110:111], v[50:51] op_sel:[1,1,0] op_sel_hi:[0,1,1] neg_lo:[0,1,0]
    v_pk_mul_f32 v[44:45], v[58:59], v[58:59] op_sel_hi:[1,0]
    v_pk_mul_f32 v[46:47], v[106:107], v[106:107] op_sel_hi:[1,0]
    v_pk_mul_f32 v[48:49], v[64:65], v[64:65] op_sel_hi:[1,0]
    v_pk_mul_f32 v[50:51], v[112:113], v[112:113] op_sel_hi:[1,0]
    v_pk_fma_f32 v[58:59], v[58:59], v[58:59], v[44:45] op_sel:[1,1,0] op_sel_hi:[0,1,1] neg_lo:[0,1,0]
    v_pk_fma_f32 v[106:107], v[106:107], v[106:107], v[46:47] op_sel:[1,1,0] op_sel_hi:[0,1,1] neg_lo:[0,1,0]
    v_pk_fma_f32 v[66:67], v[64:65], v[64:65], v[48:49] op_sel:[1,1,0] op_sel_hi:[0,1,1] neg_lo:[0,1,0]
    v_pk_fma_f32 v[114:115], v[112:113], v[112:113], v[50:51] op_sel:[1,1,0] op_sel_hi:[0,1,1] neg_lo:[0,1,0]
    v_pk_mul_f32 v[44:45], v[58:59], v[58:59] op_sel_hi:[1,0]
    v_pk_mul_f32 v[46:47], v[106:107], v[106:107] op_sel_hi:[1,0]
    v_pk_fma_f32 v[96:97], v[58:59], v[58:59], v[44:45] op_sel:[1,1,0] op_sel_hi:[0,1,1] neg_lo:[0,1,0]
    v_pk_fma_f32 v[144:145], v[106:107], v[106:107], v[46:47] op_sel:[1,1,0] op_sel_hi:[0,1,1] neg_lo:[0,1,0]
    v_mov_b32 v148, 0x3f80
    v_mov_b32 v149, 0x3f80
    v_cvt_pk_bf16_f32 v150, v58, v59
    v_cvt_pk_bf16_f32 v151, v106, v107
    ds_write_b128 v228, v[148:151] offset:0
    v_cvt_pk_bf16_f32 v152, v96, v97
    v_cvt_pk_bf16_f32 v153, v144, v145
    v_pk_mul_f32 v[44:45], v[58:59], v[96:97] op_sel_hi:[1,0]
    v_pk_mul_f32 v[46:47], v[106:107], v[144:145] op_sel_hi:[1,0]
    v_pk_mul_f32 v[48:49], v[96:97], v[96:97] op_sel_hi:[1,0]
    v_pk_mul_f32 v[50:51], v[144:145], v[144:145] op_sel_hi:[1,0]
    v_pk_fma_f32 v[94:95], v[58:59], v[96:97], v[44:45] op_sel:[1,1,0] op_sel_hi:[0,1,1] neg_lo:[0,1,0]
    v_pk_fma_f32 v[142:143], v[106:107], v[144:145], v[46:47] op_sel:[1,1,0] op_sel_hi:[0,1,1] neg_lo:[0,1,0]
    v_pk_fma_f32 v[92:93], v[96:97], v[96:97], v[48:49] op_sel:[1,1,0] op_sel_hi:[0,1,1] neg_lo:[0,1,0]
    v_pk_fma_f32 v[140:141], v[144:145], v[144:145], v[50:51] op_sel:[1,1,0] op_sel_hi:[0,1,1] neg_lo:[0,1,0]
    v_cvt_pk_bf16_f32 v154, v94, v95
    v_cvt_pk_bf16_f32 v155, v142, v143
    ds_write_b128 v229, v[152:155] offset:1024
    v_cvt_pk_bf16_f32 v156, v92, v93
    v_cvt_pk_bf16_f32 v157, v140, v141
    v_pk_mul_f32 v[44:45], v[94:95], v[96:97] op_sel_hi:[1,0]
    v_pk_mul_f32 v[46:47], v[142:143], v[144:145] op_sel_hi:[1,0]
    v_pk_mul_f32 v[48:49], v[92:93], v[96:97] op_sel_hi:[1,0]
    v_pk_mul_f32 v[50:51], v[140:141], v[144:145] op_sel_hi:[1,0]
    v_pk_fma_f32 v[94:95], v[94:95], v[96:97], v[44:45] op_sel:[1,1,0] op_sel_hi:[0,1,1] neg_lo:[0,1,0]
    v_pk_fma_f32 v[142:143], v[142:143], v[144:145], v[46:47] op_sel:[1,1,0] op_sel_hi:[0,1,1] neg_lo:[0,1,0]
    v_pk_fma_f32 v[92:93], v[92:93], v[96:97], v[48:49] op_sel:[1,1,0] op_sel_hi:[0,1,1] neg_lo:[0,1,0]
    v_pk_fma_f32 v[140:141], v[140:141], v[144:145], v[50:51] op_sel:[1,1,0] op_sel_hi:[0,1,1] neg_lo:[0,1,0]
    v_cvt_pk_bf16_f32 v158, v94, v95
    v_cvt_pk_bf16_f32 v159, v142, v143
    ds_write_b128 v230, v[156:159] offset:2048
    v_cvt_pk_bf16_f32 v148, v92, v93
    v_cvt_pk_bf16_f32 v149, v140, v141
    v_pk_mul_f32 v[44:45], v[94:95], v[96:97] op_sel_hi:[1,0]
    v_pk_mul_f32 v[46:47], v[142:143], v[144:145] op_sel_hi:[1,0]
    v_pk_mul_f32 v[48:49], v[92:93], v[96:97] op_sel_hi:[1,0]
    v_pk_mul_f32 v[50:51], v[140:141], v[144:145] op_sel_hi:[1,0]
    v_pk_fma_f32 v[94:95], v[94:95], v[96:97], v[44:45] op_sel:[1,1,0] op_sel_hi:[0,1,1] neg_lo:[0,1,0]
    v_pk_fma_f32 v[142:143], v[142:143], v[144:145], v[46:47] op_sel:[1,1,0] op_sel_hi:[0,1,1] neg_lo:[0,1,0]
    v_pk_fma_f32 v[92:93], v[92:93], v[96:97], v[48:49] op_sel:[1,1,0] op_sel_hi:[0,1,1] neg_lo:[0,1,0]
    v_pk_fma_f32 v[140:141], v[140:141], v[144:145], v[50:51] op_sel:[1,1,0] op_sel_hi:[0,1,1] neg_lo:[0,1,0]
    v_cvt_pk_bf16_f32 v150, v94, v95
    v_cvt_pk_bf16_f32 v151, v142, v143
    ds_write_b128 v231, v[148:151] offset:3072
    v_cvt_pk_bf16_f32 v152, v92, v93
    v_cvt_pk_bf16_f32 v153, v140, v141
    v_pk_mul_f32 v[44:45], v[94:95], v[96:97] op_sel_hi:[1,0]
    v_pk_mul_f32 v[46:47], v[142:143], v[144:145] op_sel_hi:[1,0]
    v_pk_mul_f32 v[48:49], v[92:93], v[96:97] op_sel_hi:[1,0]
    v_pk_mul_f32 v[50:51], v[140:141], v[144:145] op_sel_hi:[1,0]
    v_pk_fma_f32 v[94:95], v[94:95], v[96:97], v[44:45] op_sel:[1,1,0] op_sel_hi:[0,1,1] neg_lo:[0,1,0]
    v_pk_fma_f32 v[142:143], v[142:143], v[144:145], v[46:47] op_sel:[1,1,0] op_sel_hi:[0,1,1] neg_lo:[0,1,0]
    v_pk_fma_f32 v[92:93], v[92:93], v[96:97], v[48:49] op_sel:[1,1,0] op_sel_hi:[0,1,1] neg_lo:[0,1,0]
    v_pk_fma_f32 v[140:141], v[140:141], v[144:145], v[50:51] op_sel:[1,1,0] op_sel_hi:[0,1,1] neg_lo:[0,1,0]
    v_cvt_pk_bf16_f32 v154, v94, v95
    v_cvt_pk_bf16_f32 v155, v142, v143
    ds_write_b128 v232, v[152:155] offset:4096
    v_cvt_pk_bf16_f32 v156, v92, v93
    v_cvt_pk_bf16_f32 v157, v140, v141
    v_pk_mul_f32 v[44:45], v[94:95], v[96:97] op_sel_hi:[1,0]
    v_pk_mul_f32 v[46:47], v[142:143], v[144:145] op_sel_hi:[1,0]
    v_pk_mul_f32 v[48:49], v[92:93], v[96:97] op_sel_hi:[1,0]
    v_pk_mul_f32 v[50:51], v[140:141], v[144:145] op_sel_hi:[1,0]
    v_pk_fma_f32 v[94:95], v[94:95], v[96:97], v[44:45] op_sel:[1,1,0] op_sel_hi:[0,1,1] neg_lo:[0,1,0]
    v_pk_fma_f32 v[142:143], v[142:143], v[144:145], v[46:47] op_sel:[1,1,0] op_sel_hi:[0,1,1] neg_lo:[0,1,0]
    v_pk_fma_f32 v[92:93], v[92:93], v[96:97], v[48:49] op_sel:[1,1,0] op_sel_hi:[0,1,1] neg_lo:[0,1,0]
    v_pk_fma_f32 v[140:141], v[140:141], v[144:145], v[50:51] op_sel:[1,1,0] op_sel_hi:[0,1,1] neg_lo:[0,1,0]
    v_cvt_pk_bf16_f32 v158, v94, v95
    v_cvt_pk_bf16_f32 v159, v142, v143
    ds_write_b128 v233, v[156:159] offset:5120
    v_cvt_pk_bf16_f32 v148, v92, v93
    v_cvt_pk_bf16_f32 v149, v140, v141
    v_pk_mul_f32 v[44:45], v[94:95], v[96:97] op_sel_hi:[1,0]
    v_pk_mul_f32 v[46:47], v[142:143], v[144:145] op_sel_hi:[1,0]
    v_pk_mul_f32 v[48:49], v[92:93], v[96:97] op_sel_hi:[1,0]
    v_pk_mul_f32 v[50:51], v[140:141], v[144:145] op_sel_hi:[1,0]
    v_pk_fma_f32 v[94:95], v[94:95], v[96:97], v[44:45] op_sel:[1,1,0] op_sel_hi:[0,1,1] neg_lo:[0,1,0]
    v_pk_fma_f32 v[142:143], v[142:143], v[144:145], v[46:47] op_sel:[1,1,0] op_sel_hi:[0,1,1] neg_lo:[0,1,0]
    v_pk_fma_f32 v[92:93], v[92:93], v[96:97], v[48:49] op_sel:[1,1,0] op_sel_hi:[0,1,1] neg_lo:[0,1,0]
    v_pk_fma_f32 v[140:141], v[140:141], v[144:145], v[50:51] op_sel:[1,1,0] op_sel_hi:[0,1,1] neg_lo:[0,1,0]
    v_cvt_pk_bf16_f32 v150, v94, v95
    v_cvt_pk_bf16_f32 v151, v142, v143
    ds_write_b128 v234, v[148:151] offset:6144
    v_cvt_pk_bf16_f32 v152, v92, v93
    v_cvt_pk_bf16_f32 v153, v140, v141
    v_pk_mul_f32 v[44:45], v[94:95], v[96:97] op_sel_hi:[1,0]
    v_pk_mul_f32 v[46:47], v[142:143], v[144:145] op_sel_hi:[1,0]
    v_pk_fma_f32 v[94:95], v[94:95], v[96:97], v[44:45] op_sel:[1,1,0] op_sel_hi:[0,1,1] neg_lo:[0,1,0]
    v_pk_fma_f32 v[142:143], v[142:143], v[144:145], v[46:47] op_sel:[1,1,0] op_sel_hi:[0,1,1] neg_lo:[0,1,0]
    v_cvt_pk_bf16_f32 v154, v94, v95
    v_cvt_pk_bf16_f32 v155, v142, v143
    ds_write_b128 v235, v[152:155] offset:7168
    ds_read_b64 v[164:165], v236 offset:0
    ds_read_b64 v[166:167], v237 offset:0
    ds_read_b64 v[168:169], v238 offset:0
    ds_read_b64 v[170:171], v239 offset:0
    ds_read_b64 v[172:173], v236 offset:256
    ds_read_b64 v[174:175], v237 offset:256
    ds_read_b64 v[176:177], v238 offset:256
    ds_read_b64 v[178:179], v239 offset:256
    ds_read_b64 v[180:181], v236 offset:512
    ds_read_b64 v[182:183], v237 offset:512
    ds_read_b64 v[184:185], v238 offset:512
    ds_read_b64 v[186:187], v239 offset:512
    ds_read_b64 v[188:189], v236 offset:768
    ds_read_b64 v[190:191], v237 offset:768
    ds_read_b64 v[192:193], v238 offset:768
    ds_read_b64 v[194:195], v239 offset:768
    v_cvt_pk_bf16_f32 v156, v68, -v69
    v_cvt_pk_bf16_f32 v157, v116, -v117
    v_pk_mul_f32 v[44:45], v[68:69], v[56:57] op_sel_hi:[1,0]
    v_pk_mul_f32 v[46:47], v[116:117], v[104:105] op_sel_hi:[1,0]
    v_pk_mul_f32 v[48:49], v[68:69], v[60:61] op_sel_hi:[1,0]
    v_pk_mul_f32 v[50:51], v[116:117], v[108:109] op_sel_hi:[1,0]
    v_pk_fma_f32 v[92:93], v[68:69], v[56:57], v[44:45] op_sel:[1,1,0] op_sel_hi:[0,1,1] neg_lo:[0,1,0]
    v_pk_fma_f32 v[140:141], v[116:117], v[104:105], v[46:47] op_sel:[1,1,0] op_sel_hi:[0,1,1] neg_lo:[0,1,0]
    v_pk_fma_f32 v[76:77], v[68:69], v[60:61], v[48:49] op_sel:[1,1,0] op_sel_hi:[0,1,1] neg_lo:[0,1,0]
    v_pk_fma_f32 v[124:125], v[116:117], v[108:109], v[50:51] op_sel:[1,1,0] op_sel_hi:[0,1,1] neg_lo:[0,1,0]
    v_cvt_pk_bf16_f32 v158, v92, -v93
    v_cvt_pk_bf16_f32 v159, v140, -v141
    ds_write_b128 v228, v[156:159] offset:0
    v_cvt_pk_bf16_f32 v148, v76, -v77
    v_cvt_pk_bf16_f32 v149, v124, -v125
    v_pk_mul_f32 v[44:45], v[92:93], v[56:57] op_sel_hi:[1,0]
    v_pk_mul_f32 v[46:47], v[140:141], v[104:105] op_sel_hi:[1,0]
    v_pk_mul_f32 v[48:49], v[92:93], v[60:61] op_sel_hi:[1,0]
    v_pk_mul_f32 v[50:51], v[140:141], v[108:109] op_sel_hi:[1,0]
    v_pk_fma_f32 v[70:71], v[92:93], v[56:57], v[44:45] op_sel:[1,1,0] op_sel_hi:[0,1,1] neg_lo:[0,1,0]
    v_pk_fma_f32 v[118:119], v[140:141], v[104:105], v[46:47] op_sel:[1,1,0] op_sel_hi:[0,1,1] neg_lo:[0,1,0]
    v_pk_fma_f32 v[94:95], v[92:93], v[60:61], v[48:49] op_sel:[1,1,0] op_sel_hi:[0,1,1] neg_lo:[0,1,0]
    v_pk_fma_f32 v[142:143], v[140:141], v[108:109], v[50:51] op_sel:[1,1,0] op_sel_hi:[0,1,1] neg_lo:[0,1,0]
    v_cvt_pk_bf16_f32 v152, v70, -v71
    v_cvt_pk_bf16_f32 v153, v118, -v119
    v_cvt_pk_bf16_f32 v150, v94, -v95
    v_cvt_pk_bf16_f32 v151, v142, -v143
    ds_write_b128 v232, v[148:151] offset:4096
    v_pk_mul_f32 v[44:45], v[70:71], v[56:57] op_sel_hi:[1,0]
    v_pk_mul_f32 v[46:47], v[118:119], v[104:105] op_sel_hi:[1,0]
    v_pk_mul_f32 v[48:49], v[70:71], v[60:61] op_sel_hi:[1,0]
    v_pk_mul_f32 v[50:51], v[118:119], v[108:109] op_sel_hi:[1,0]
    v_pk_fma_f32 v[92:93], v[70:71], v[56:57], v[44:45] op_sel:[1,1,0] op_sel_hi:[0,1,1] neg_lo:[0,1,0]
    v_pk_fma_f32 v[140:141], v[118:119], v[104:105], v[46:47] op_sel:[1,1,0] op_sel_hi:[0,1,1] neg_lo:[0,1,0]
    v_pk_fma_f32 v[78:79], v[70:71], v[60:61], v[48:49] op_sel:[1,1,0] op_sel_hi:[0,1,1] neg_lo:[0,1,0]
    v_pk_fma_f32 v[126:127], v[118:119], v[108:109], v[50:51] op_sel:[1,1,0] op_sel_hi:[0,1,1] neg_lo:[0,1,0]
    v_cvt_pk_bf16_f32 v154, v92, -v93
    v_cvt_pk_bf16_f32 v155, v140, -v141
    ds_write_b128 v229, v[152:155] offset:1024
    v_cvt_pk_bf16_f32 v156, v78, -v79
    v_cvt_pk_bf16_f32 v157, v126, -v127
    v_pk_mul_f32 v[44:45], v[92:93], v[56:57] op_sel_hi:[1,0]
    v_pk_mul_f32 v[46:47], v[140:141], v[104:105] op_sel_hi:[1,0]
    v_pk_mul_f32 v[48:49], v[92:93], v[60:61] op_sel_hi:[1,0]
    v_pk_mul_f32 v[50:51], v[140:141], v[108:109] op_sel_hi:[1,0]
    v_pk_fma_f32 v[72:73], v[92:93], v[56:57], v[44:45] op_sel:[1,1,0] op_sel_hi:[0,1,1] neg_lo:[0,1,0]
    v_pk_fma_f32 v[120:121], v[140:141], v[104:105], v[46:47] op_sel:[1,1,0] op_sel_hi:[0,1,1] neg_lo:[0,1,0]
    v_pk_fma_f32 v[94:95], v[92:93], v[60:61], v[48:49] op_sel:[1,1,0] op_sel_hi:[0,1,1] neg_lo:[0,1,0]
    v_pk_fma_f32 v[142:143], v[140:141], v[108:109], v[50:51] op_sel:[1,1,0] op_sel_hi:[0,1,1] neg_lo:[0,1,0]
    v_cvt_pk_bf16_f32 v148, v72, -v73
    v_cvt_pk_bf16_f32 v149, v120, -v121
    v_cvt_pk_bf16_f32 v158, v94, -v95
    v_cvt_pk_bf16_f32 v159, v142, -v143
    ds_write_b128 v233, v[156:159] offset:5120
    v_pk_mul_f32 v[44:45], v[72:73], v[56:57] op_sel_hi:[1,0]
    v_pk_mul_f32 v[46:47], v[120:121], v[104:105] op_sel_hi:[1,0]
    v_pk_mul_f32 v[48:49], v[72:73], v[60:61] op_sel_hi:[1,0]
    v_pk_mul_f32 v[50:51], v[120:121], v[108:109] op_sel_hi:[1,0]
    v_pk_fma_f32 v[92:93], v[72:73], v[56:57], v[44:45] op_sel:[1,1,0] op_sel_hi:[0,1,1] neg_lo:[0,1,0]
    v_pk_fma_f32 v[140:141], v[120:121], v[104:105], v[46:47] op_sel:[1,1,0] op_sel_hi:[0,1,1] neg_lo:[0,1,0]
    v_pk_fma_f32 v[80:81], v[72:73], v[60:61], v[48:49] op_sel:[1,1,0] op_sel_hi:[0,1,1] neg_lo:[0,1,0]
    v_pk_fma_f32 v[128:129], v[120:121], v[108:109], v[50:51] op_sel:[1,1,0] op_sel_hi:[0,1,1] neg_lo:[0,1,0]
    v_cvt_pk_bf16_f32 v150, v92, -v93
    v_cvt_pk_bf16_f32 v151, v140, -v141
    ds_write_b128 v230, v[148:151] offset:2048
    v_cvt_pk_bf16_f32 v152, v80, -v81
    v_cvt_pk_bf16_f32 v153, v128, -v129
    v_pk_mul_f32 v[44:45], v[92:93], v[56:57] op_sel_hi:[1,0]
    v_pk_mul_f32 v[46:47], v[140:141], v[104:105] op_sel_hi:[1,0]
    v_pk_mul_f32 v[48:49], v[92:93], v[60:61] op_sel_hi:[1,0]
    v_pk_mul_f32 v[50:51], v[140:141], v[108:109] op_sel_hi:[1,0]
    v_pk_fma_f32 v[74:75], v[92:93], v[56:57], v[44:45] op_sel:[1,1,0] op_sel_hi:[0,1,1] neg_lo:[0,1,0]
    v_pk_fma_f32 v[122:123], v[140:141], v[104:105], v[46:47] op_sel:[1,1,0] op_sel_hi:[0,1,1] neg_lo:[0,1,0]
    v_pk_fma_f32 v[94:95], v[92:93], v[60:61], v[48:49] op_sel:[1,1,0] op_sel_hi:[0,1,1] neg_lo:[0,1,0]
    v_pk_fma_f32 v[142:143], v[140:141], v[108:109], v[50:51] op_sel:[1,1,0] op_sel_hi:[0,1,1] neg_lo:[0,1,0]
    v_cvt_pk_bf16_f32 v156, v74, -v75
    v_cvt_pk_bf16_f32 v157, v122, -v123
    v_cvt_pk_bf16_f32 v154, v94, -v95
    v_cvt_pk_bf16_f32 v155, v142, -v143
    ds_write_b128 v234, v[152:155] offset:6144
    v_pk_mul_f32 v[44:45], v[74:75], v[56:57] op_sel_hi:[1,0]
    v_pk_mul_f32 v[46:47], v[122:123], v[104:105] op_sel_hi:[1,0]
    v_pk_mul_f32 v[48:49], v[74:75], v[60:61] op_sel_hi:[1,0]
    v_pk_mul_f32 v[50:51], v[122:123], v[108:109] op_sel_hi:[1,0]
    v_pk_fma_f32 v[92:93], v[74:75], v[56:57], v[44:45] op_sel:[1,1,0] op_sel_hi:[0,1,1] neg_lo:[0,1,0]
    v_pk_fma_f32 v[140:141], v[122:123], v[104:105], v[46:47] op_sel:[1,1,0] op_sel_hi:[0,1,1] neg_lo:[0,1,0]
    v_pk_fma_f32 v[82:83], v[74:75], v[60:61], v[48:49] op_sel:[1,1,0] op_sel_hi:[0,1,1] neg_lo:[0,1,0]
    v_pk_fma_f32 v[130:131], v[122:123], v[108:109], v[50:51] op_sel:[1,1,0] op_sel_hi:[0,1,1] neg_lo:[0,1,0]
    v_cvt_pk_bf16_f32 v158, v92, -v93
    v_cvt_pk_bf16_f32 v159, v140, -v141
    ds_write_b128 v231, v[156:159] offset:3072
    v_cvt_pk_bf16_f32 v148, v82, -v83
    v_cvt_pk_bf16_f32 v149, v130, -v131
    v_pk_mul_f32 v[44:45], v[92:93], v[60:61] op_sel_hi:[1,0]
    v_pk_mul_f32 v[46:47], v[140:141], v[108:109] op_sel_hi:[1,0]
    v_pk_fma_f32 v[94:95], v[92:93], v[60:61], v[44:45] op_sel:[1,1,0] op_sel_hi:[0,1,1] neg_lo:[0,1,0]
    v_pk_fma_f32 v[142:143], v[140:141], v[108:109], v[46:47] op_sel:[1,1,0] op_sel_hi:[0,1,1] neg_lo:[0,1,0]
    v_cvt_pk_bf16_f32 v150, v94, -v95
    v_cvt_pk_bf16_f32 v151, v142, -v143
    ds_write_b128 v235, v[148:151] offset:7168
    ds_read_b64 v[196:197], v236 offset:0
    ds_read_b64 v[198:199], v237 offset:0
    ds_read_b64 v[200:201], v238 offset:0
    ds_read_b64 v[202:203], v239 offset:0
    ds_read_b64 v[204:205], v236 offset:256
    ds_read_b64 v[206:207], v237 offset:256
    ds_read_b64 v[208:209], v238 offset:256
    ds_read_b64 v[210:211], v239 offset:256
    ds_read_b64 v[212:213], v236 offset:512
    ds_read_b64 v[214:215], v237 offset:512
    ds_read_b64 v[216:217], v238 offset:512
    ds_read_b64 v[218:219], v239 offset:512
    ds_read_b64 v[220:221], v236 offset:768
    ds_read_b64 v[222:223], v237 offset:768
    ds_read_b64 v[224:225], v238 offset:768
    ds_read_b64 v[226:227], v239 offset:768
    v_pk_mul_f32 v[44:45], v[68:69], v[62:63] op_sel_hi:[1,0]
    v_pk_mul_f32 v[46:47], v[116:117], v[110:111] op_sel_hi:[1,0]
    v_pk_mul_f32 v[48:49], v[70:71], v[62:63] op_sel_hi:[1,0]
    v_pk_mul_f32 v[50:51], v[118:119], v[110:111] op_sel_hi:[1,0]
    v_pk_fma_f32 v[84:85], v[68:69], v[62:63], v[44:45] op_sel:[1,1,0] op_sel_hi:[0,1,1] neg_lo:[0,1,0]
    v_pk_fma_f32 v[132:133], v[116:117], v[110:111], v[46:47] op_sel:[1,1,0] op_sel_hi:[0,1,1] neg_lo:[0,1,0]
    v_pk_fma_f32 v[94:95], v[70:71], v[62:63], v[48:49] op_sel:[1,1,0] op_sel_hi:[0,1,1] neg_lo:[0,1,0]
    v_pk_fma_f32 v[142:143], v[118:119], v[110:111], v[50:51] op_sel:[1,1,0] op_sel_hi:[0,1,1] neg_lo:[0,1,0]
    s_waitcnt lgkmcnt(8)
    s_nop 0
    v_mfma_f32_16x16x32_bf16 v[26:29], v[196:199], v[164:167], 0
    buffer_load_dwordx4 v12, s[36:39], s83 offen offset:2048 lds
    v_cvt_pk_bf16_f32 v152, v84, -v85
    v_cvt_pk_bf16_f32 v153, v132, -v133
    v_mfma_f32_16x16x32_bf16 v[26:29], v[200:203], v[168:171], v[26:29]
    v_cvt_pk_bf16_f32 v154, v94, -v95
    v_cvt_pk_bf16_f32 v155, v142, -v143
    ds_write_b128 v228, v[152:155] offset:0
    v_pk_mul_f32 v[44:45], v[72:73], v[62:63] op_sel_hi:[1,0]
    v_pk_mul_f32 v[46:47], v[120:121], v[110:111] op_sel_hi:[1,0]
    v_pk_mul_f32 v[48:49], v[74:75], v[62:63] op_sel_hi:[1,0]
    v_pk_mul_f32 v[50:51], v[122:123], v[110:111] op_sel_hi:[1,0]
    v_pk_fma_f32 v[88:89], v[72:73], v[62:63], v[44:45] op_sel:[1,1,0] op_sel_hi:[0,1,1] neg_lo:[0,1,0]
    v_pk_fma_f32 v[136:137], v[120:121], v[110:111], v[46:47] op_sel:[1,1,0] op_sel_hi:[0,1,1] neg_lo:[0,1,0]
    v_pk_fma_f32 v[94:95], v[74:75], v[62:63], v[48:49] op_sel:[1,1,0] op_sel_hi:[0,1,1] neg_lo:[0,1,0]
    v_pk_fma_f32 v[142:143], v[122:123], v[110:111], v[50:51] op_sel:[1,1,0] op_sel_hi:[0,1,1] neg_lo:[0,1,0]
    v_mfma_f32_16x16x32_bf16 v[26:29], v[204:207], v[172:175], v[26:29]
    buffer_load_dwordx4 v13, s[36:39], s83 offen offset:3072 lds
    v_cvt_pk_bf16_f32 v156, v88, -v89
    v_cvt_pk_bf16_f32 v157, v136, -v137
    v_mfma_f32_16x16x32_bf16 v[26:29], v[208:211], v[176:179], v[26:29]
    v_cvt_pk_bf16_f32 v158, v94, -v95
    v_cvt_pk_bf16_f32 v159, v142, -v143
    ds_write_b128 v229, v[156:159] offset:1024
    v_pk_mul_f32 v[44:45], v[76:77], v[62:63] op_sel_hi:[1,0]
    v_pk_mul_f32 v[46:47], v[124:125], v[110:111] op_sel_hi:[1,0]
    v_pk_mul_f32 v[48:49], v[78:79], v[62:63] op_sel_hi:[1,0]
    v_pk_mul_f32 v[50:51], v[126:127], v[110:111] op_sel_hi:[1,0]
    v_pk_fma_f32 v[86:87], v[76:77], v[62:63], v[44:45] op_sel:[1,1,0] op_sel_hi:[0,1,1] neg_lo:[0,1,0]
    v_pk_fma_f32 v[134:135], v[124:125], v[110:111], v[46:47] op_sel:[1,1,0] op_sel_hi:[0,1,1] neg_lo:[0,1,0]
    v_pk_fma_f32 v[94:95], v[78:79], v[62:63], v[48:49] op_sel:[1,1,0] op_sel_hi:[0,1,1] neg_lo:[0,1,0]
    v_pk_fma_f32 v[142:143], v[126:127], v[110:111], v[50:51] op_sel:[1,1,0] op_sel_hi:[0,1,1] neg_lo:[0,1,0]
    s_waitcnt lgkmcnt(2)
    s_add_u32 m0, s65, 49152
    s_cmp_ge_u32 s64, 9
    s_cselect_b32 s83, s69, s67
    s_nop 0
    s_add_u32 s83, s83, 221184
    buffer_load_dwordx4 v14, s[40:43], s83 offen lds
    v_mfma_f32_16x16x32_bf16 v[26:29], v[212:215], v[180:183], v[26:29]
    v_cvt_pk_bf16_f32 v148, v86, -v87
    v_cvt_pk_bf16_f32 v149, v134, -v135
    v_mfma_f32_16x16x32_bf16 v[26:29], v[216:219], v[184:187], v[26:29]
    v_cvt_pk_bf16_f32 v150, v94, -v95
    v_cvt_pk_bf16_f32 v151, v142, -v143
    ds_write_b128 v230, v[148:151] offset:2048
    v_pk_mul_f32 v[44:45], v[80:81], v[62:63] op_sel_hi:[1,0]
    v_pk_mul_f32 v[46:47], v[128:129], v[110:111] op_sel_hi:[1,0]
    v_pk_mul_f32 v[48:49], v[82:83], v[62:63] op_sel_hi:[1,0]
    v_pk_mul_f32 v[50:51], v[130:131], v[110:111] op_sel_hi:[1,0]
    v_pk_fma_f32 v[90:91], v[80:81], v[62:63], v[44:45] op_sel:[1,1,0] op_sel_hi:[0,1,1] neg_lo:[0,1,0]
    v_pk_fma_f32 v[138:139], v[128:129], v[110:111], v[46:47] op_sel:[1,1,0] op_sel_hi:[0,1,1] neg_lo:[0,1,0]
    v_pk_fma_f32 v[94:95], v[82:83], v[62:63], v[48:49] op_sel:[1,1,0] op_sel_hi:[0,1,1] neg_lo:[0,1,0]
    v_pk_fma_f32 v[142:143], v[130:131], v[110:111], v[50:51] op_sel:[1,1,0] op_sel_hi:[0,1,1] neg_lo:[0,1,0]
    v_mfma_f32_16x16x32_bf16 v[26:29], v[220:223], v[188:191], v[26:29]
    buffer_load_dwordx4 v15, s[40:43], s83 offen offset:1024 lds
    v_cvt_pk_bf16_f32 v152, v90, -v91
    v_cvt_pk_bf16_f32 v153, v138, -v139
    v_mfma_f32_16x16x32_bf16 v[26:29], v[224:227], v[192:195], v[26:29]
    v_cvt_pk_bf16_f32 v154, v94, -v95
    v_cvt_pk_bf16_f32 v155, v142, -v143
    ds_write_b128 v231, v[152:155] offset:3072
    v_pk_mul_f32 v[44:45], v[68:69], v[64:65] op_sel_hi:[1,0]
    v_pk_mul_f32 v[46:47], v[116:117], v[112:113] op_sel_hi:[1,0]
    v_pk_mul_f32 v[48:49], v[72:73], v[64:65] op_sel_hi:[1,0]
    v_pk_mul_f32 v[50:51], v[120:121], v[112:113] op_sel_hi:[1,0]
    v_pk_fma_f32 v[70:71], v[68:69], v[64:65], v[44:45] op_sel:[1,1,0] op_sel_hi:[0,1,1] neg_lo:[0,1,0]
    v_pk_fma_f32 v[118:119], v[116:117], v[112:113], v[46:47] op_sel:[1,1,0] op_sel_hi:[0,1,1] neg_lo:[0,1,0]
    v_pk_fma_f32 v[94:95], v[72:73], v[64:65], v[48:49] op_sel:[1,1,0] op_sel_hi:[0,1,1] neg_lo:[0,1,0]
    v_pk_fma_f32 v[142:143], v[120:121], v[112:113], v[50:51] op_sel:[1,1,0] op_sel_hi:[0,1,1] neg_lo:[0,1,0]
    v_cvt_pk_bf16_f32 v156, v70, -v71
    buffer_load_dwordx4 v16, s[40:43], s83 offen offset:2048 lds
    v_cvt_pk_bf16_f32 v157, v118, -v119
    v_cvt_pk_bf16_f32 v158, v94, -v95
    v_cvt_pk_bf16_f32 v159, v142, -v143
    ds_write_b128 v232, v[156:159] offset:4096
    v_pk_mul_f32 v[44:45], v[76:77], v[64:65] op_sel_hi:[1,0]
    v_pk_mul_f32 v[46:47], v[124:125], v[112:113] op_sel_hi:[1,0]
    v_pk_mul_f32 v[48:49], v[80:81], v[64:65] op_sel_hi:[1,0]
    v_pk_mul_f32 v[50:51], v[128:129], v[112:113] op_sel_hi:[1,0]
    v_pk_fma_f32 v[74:75], v[76:77], v[64:65], v[44:45] op_sel:[1,1,0] op_sel_hi:[0,1,1] neg_lo:[0,1,0]
    v_pk_fma_f32 v[122:123], v[124:125], v[112:113], v[46:47] op_sel:[1,1,0] op_sel_hi:[0,1,1] neg_lo:[0,1,0]
    v_pk_fma_f32 v[94:95], v[80:81], v[64:65], v[48:49] op_sel:[1,1,0] op_sel_hi:[0,1,1] neg_lo:[0,1,0]
    v_pk_fma_f32 v[142:143], v[128:129], v[112:113], v[50:51] op_sel:[1,1,0] op_sel_hi:[0,1,1] neg_lo:[0,1,0]
    v_cvt_pk_bf16_f32 v148, v74, -v75
    v_cvt_pk_bf16_f32 v149, v122, -v123
    v_cvt_pk_bf16_f32 v150, v94, -v95
    buffer_load_dwordx4 v17, s[40:43], s83 offen offset:3072 lds
    v_cvt_pk_bf16_f32 v151, v142, -v143
    ds_write_b128 v233, v[148:151] offset:5120
    v_pk_mul_f32 v[44:45], v[84:85], v[64:65] op_sel_hi:[1,0]
    v_pk_mul_f32 v[46:47], v[132:133], v[112:113] op_sel_hi:[1,0]
    v_pk_mul_f32 v[48:49], v[88:89], v[64:65] op_sel_hi:[1,0]
    v_pk_mul_f32 v[50:51], v[136:137], v[112:113] op_sel_hi:[1,0]
    v_pk_fma_f32 v[78:79], v[84:85], v[64:65], v[44:45] op_sel:[1,1,0] op_sel_hi:[0,1,1] neg_lo:[0,1,0]
    v_pk_fma_f32 v[126:127], v[132:133], v[112:113], v[46:47] op_sel:[1,1,0] op_sel_hi:[0,1,1] neg_lo:[0,1,0]
    v_pk_fma_f32 v[94:95], v[88:89], v[64:65], v[48:49] op_sel:[1,1,0] op_sel_hi:[0,1,1] neg_lo:[0,1,0]
    v_pk_fma_f32 v[142:143], v[136:137], v[112:113], v[50:51] op_sel:[1,1,0] op_sel_hi:[0,1,1] neg_lo:[0,1,0]
    v_cvt_pk_bf16_f32 v152, v78, -v79
    v_cvt_pk_bf16_f32 v153, v126, -v127
    v_cvt_pk_bf16_f32 v154, v94, -v95
    v_cvt_pk_bf16_f32 v155, v142, -v143
    ds_write_b128 v234, v[152:155] offset:6144
    s_add_u32 m0, s65, 65536
    s_cmp_ge_u32 s64, 8
    s_cselect_b32 s83, s95, s66
    s_add_u32 s83, s83, 256
    buffer_load_dwordx4 v10, s[36:39], s83 offen lds
    v_pk_mul_f32 v[44:45], v[86:87], v[64:65] op_sel_hi:[1,0]
    v_pk_mul_f32 v[46:47], v[134:135], v[112:113] op_sel_hi:[1,0]
    v_pk_mul_f32 v[48:49], v[90:91], v[64:65] op_sel_hi:[1,0]
    v_pk_mul_f32 v[50:51], v[138:139], v[112:113] op_sel_hi:[1,0]
    v_pk_fma_f32 v[82:83], v[86:87], v[64:65], v[44:45] op_sel:[1,1,0] op_sel_hi:[0,1,1] neg_lo:[0,1,0]
    v_pk_fma_f32 v[130:131], v[134:135], v[112:113], v[46:47] op_sel:[1,1,0] op_sel_hi:[0,1,1] neg_lo:[0,1,0]
    v_pk_fma_f32 v[94:95], v[90:91], v[64:65], v[48:49] op_sel:[1,1,0] op_sel_hi:[0,1,1] neg_lo:[0,1,0]
    v_pk_fma_f32 v[142:143], v[138:139], v[112:113], v[50:51] op_sel:[1,1,0] op_sel_hi:[0,1,1] neg_lo:[0,1,0]
    v_cvt_pk_bf16_f32 v156, v82, -v83
    v_cvt_pk_bf16_f32 v157, v130, -v131
    v_cvt_pk_bf16_f32 v158, v94, -v95
    v_cvt_pk_bf16_f32 v159, v142, -v143
    ds_write_b128 v235, v[156:159] offset:7168
    ds_read_b64 v[196:197], v236 offset:0
    ds_read_b64 v[198:199], v237 offset:0
    buffer_load_dwordx4 v11, s[36:39], s83 offen offset:1024 lds
    ds_read_b64 v[200:201], v238 offset:0
    ds_read_b64 v[202:203], v239 offset:0
    ds_read_b64 v[204:205], v236 offset:256
    ds_read_b64 v[206:207], v237 offset:256
    ds_read_b64 v[208:209], v238 offset:256
    ds_read_b64 v[210:211], v239 offset:256
    ds_read_b64 v[212:213], v236 offset:512
    ds_read_b64 v[214:215], v237 offset:512
    ds_read_b64 v[216:217], v238 offset:512
    ds_read_b64 v[218:219], v239 offset:512
    ds_read_b64 v[220:221], v236 offset:768
    ds_read_b64 v[222:223], v237 offset:768
    ds_read_b64 v[224:225], v238 offset:768
    ds_read_b64 v[226:227], v239 offset:768
    v_pk_mul_f32 v[44:45], v[68:69], v[66:67] op_sel_hi:[1,0]
    buffer_load_dwordx4 v12, s[36:39], s83 offen offset:2048 lds
    v_pk_mul_f32 v[46:47], v[116:117], v[114:115] op_sel_hi:[1,0]
    v_pk_mul_f32 v[48:49], v[76:77], v[66:67] op_sel_hi:[1,0]
    v_pk_mul_f32 v[50:51], v[124:125], v[114:115] op_sel_hi:[1,0]
    v_pk_fma_f32 v[72:73], v[68:69], v[66:67], v[44:45] op_sel:[1,1,0] op_sel_hi:[0,1,1] neg_lo:[0,1,0]
    v_pk_fma_f32 v[120:121], v[116:117], v[114:115], v[46:47] op_sel:[1,1,0] op_sel_hi:[0,1,1] neg_lo:[0,1,0]
    v_pk_fma_f32 v[94:95], v[76:77], v[66:67], v[48:49] op_sel:[1,1,0] op_sel_hi:[0,1,1] neg_lo:[0,1,0]
    v_pk_fma_f32 v[142:143], v[124:125], v[114:115], v[50:51] op_sel:[1,1,0] op_sel_hi:[0,1,1] neg_lo:[0,1,0]
    s_waitcnt lgkmcnt(8)
    s_nop 0
    v_mfma_f32_16x16x32_bf16 v[30:33], v[196:199], v[164:167], 0
    v_cvt_pk_bf16_f32 v148, v72, -v73
    v_cvt_pk_bf16_f32 v149, v120, -v121
    v_mfma_f32_16x16x32_bf16 v[30:33], v[200:203], v[168:171], v[30:33]
    v_cvt_pk_bf16_f32 v150, v94, -v95
    v_cvt_pk_bf16_f32 v151, v142, -v143
    ds_write_b128 v228, v[148:151] offset:0
    buffer_load_dwordx4 v13, s[36:39], s83 offen offset:3072 lds
    v_pk_mul_f32 v[44:45], v[84:85], v[66:67] op_sel_hi:[1,0]
    v_pk_mul_f32 v[46:47], v[132:133], v[114:115] op_sel_hi:[1,0]
    v_pk_mul_f32 v[48:49], v[86:87], v[66:67] op_sel_hi:[1,0]
    v_pk_mul_f32 v[50:51], v[134:135], v[114:115] op_sel_hi:[1,0]
    v_pk_fma_f32 v[92:93], v[84:85], v[66:67], v[44:45] op_sel:[1,1,0] op_sel_hi:[0,1,1] neg_lo:[0,1,0]
    v_pk_fma_f32 v[140:141], v[132:133], v[114:115], v[46:47] op_sel:[1,1,0] op_sel_hi:[0,1,1] neg_lo:[0,1,0]
    v_pk_fma_f32 v[94:95], v[86:87], v[66:67], v[48:49] op_sel:[1,1,0] op_sel_hi:[0,1,1] neg_lo:[0,1,0]
    v_pk_fma_f32 v[142:143], v[134:135], v[114:115], v[50:51] op_sel:[1,1,0] op_sel_hi:[0,1,1] neg_lo:[0,1,0]
    v_mfma_f32_16x16x32_bf16 v[30:33], v[204:207], v[172:175], v[30:33]
    v_cvt_pk_bf16_f32 v152, v92, -v93
    v_cvt_pk_bf16_f32 v153, v140, -v141
    v_mfma_f32_16x16x32_bf16 v[30:33], v[208:211], v[176:179], v[30:33]
    v_cvt_pk_bf16_f32 v154, v94, -v95
    v_cvt_pk_bf16_f32 v155, v142, -v143
    ds_write_b128 v229, v[152:155] offset:1024
    s_add_u32 m0, s65, 81920
    s_cmp_ge_u32 s64, 8
    s_cselect_b32 s83, s69, s67
    s_add_u32 s83, s83, 442368
    buffer_load_dwordx4 v14, s[40:43], s83 offen lds
    v_pk_mul_f32 v[44:45], v[70:71], v[66:67] op_sel_hi:[1,0]
    v_pk_mul_f32 v[46:47], v[118:119], v[114:115] op_sel_hi:[1,0]
    v_pk_mul_f32 v[48:49], v[74:75], v[66:67] op_sel_hi:[1,0]
    v_pk_mul_f32 v[50:51], v[122:123], v[114:115] op_sel_hi:[1,0]
    v_pk_fma_f32 v[92:93], v[70:71], v[66:67], v[44:45] op_sel:[1,1,0] op_sel_hi:[0,1,1] neg_lo:[0,1,0]
    v_pk_fma_f32 v[140:141], v[118:119], v[114:115], v[46:47] op_sel:[1,1,0] op_sel_hi:[0,1,1] neg_lo:[0,1,0]
    v_pk_fma_f32 v[94:95], v[74:75], v[66:67], v[48:49] op_sel:[1,1,0] op_sel_hi:[0,1,1] neg_lo:[0,1,0]
    v_pk_fma_f32 v[142:143], v[122:123], v[114:115], v[50:51] op_sel:[1,1,0] op_sel_hi:[0,1,1] neg_lo:[0,1,0]
    s_waitcnt lgkmcnt(2)
    s_nop 0
    v_mfma_f32_16x16x32_bf16 v[30:33], v[212:215], v[180:183], v[30:33]
    v_cvt_pk_bf16_f32 v156, v92, -v93
    v_cvt_pk_bf16_f32 v157, v140, -v141
    v_mfma_f32_16x16x32_bf16 v[30:33], v[216:219], v[184:187], v[30:33]
    v_cvt_pk_bf16_f32 v158, v94, -v95
    v_cvt_pk_bf16_f32 v159, v142, -v143
    ds_write_b128 v230, v[156:159] offset:2048
    buffer_load_dwordx4 v15, s[40:43], s83 offen offset:1024 lds
    v_pk_mul_f32 v[44:45], v[78:79], v[66:67] op_sel_hi:[1,0]
    v_pk_mul_f32 v[46:47], v[126:127], v[114:115] op_sel_hi:[1,0]
    v_pk_mul_f32 v[48:49], v[82:83], v[66:67] op_sel_hi:[1,0]
    v_pk_mul_f32 v[50:51], v[130:131], v[114:115] op_sel_hi:[1,0]
    v_pk_fma_f32 v[92:93], v[78:79], v[66:67], v[44:45] op_sel:[1,1,0] op_sel_hi:[0,1,1] neg_lo:[0,1,0]
    v_pk_fma_f32 v[140:141], v[126:127], v[114:115], v[46:47] op_sel:[1,1,0] op_sel_hi:[0,1,1] neg_lo:[0,1,0]
    v_pk_fma_f32 v[94:95], v[82:83], v[66:67], v[48:49] op_sel:[1,1,0] op_sel_hi:[0,1,1] neg_lo:[0,1,0]
    v_pk_fma_f32 v[142:143], v[130:131], v[114:115], v[50:51] op_sel:[1,1,0] op_sel_hi:[0,1,1] neg_lo:[0,1,0]
    v_mfma_f32_16x16x32_bf16 v[30:33], v[220:223], v[188:191], v[30:33]
    v_cvt_pk_bf16_f32 v148, v92, -v93
    v_cvt_pk_bf16_f32 v149, v140, -v141
    v_mfma_f32_16x16x32_bf16 v[30:33], v[224:227], v[192:195], v[30:33]
    v_cvt_pk_bf16_f32 v150, v94, -v95
    v_cvt_pk_bf16_f32 v151, v142, -v143
    ds_write_b128 v231, v[148:151] offset:3072
    buffer_load_dwordx4 v16, s[40:43], s83 offen offset:2048 lds
    v_pk_mul_f32 v[44:45], v[72:73], v[66:67] op_sel_hi:[1,0]
    v_pk_mul_f32 v[46:47], v[120:121], v[114:115] op_sel_hi:[1,0]
    v_pk_fma_f32 v[92:93], v[72:73], v[66:67], v[44:45] op_sel:[1,1,0] op_sel_hi:[0,1,1] neg_lo:[0,1,0]
    v_pk_fma_f32 v[140:141], v[120:121], v[114:115], v[46:47] op_sel:[1,1,0] op_sel_hi:[0,1,1] neg_lo:[0,1,0]
    v_cvt_pk_bf16_f32 v152, v92, -v93
    v_cvt_pk_bf16_f32 v153, v140, -v141
    ds_write_b128 v232, v[152:155] offset:4096
    ds_read_b64 v[196:197], v236 offset:0
    ds_read_b64 v[198:199], v237 offset:0
    ds_read_b64 v[200:201], v238 offset:0
    ds_read_b64 v[202:203], v239 offset:0
    ds_read_b64 v[204:205], v236 offset:256
    ds_read_b64 v[206:207], v237 offset:256
    ds_read_b64 v[208:209], v238 offset:256
    ds_read_b64 v[210:211], v239 offset:256
    buffer_load_dwordx4 v17, s[40:43], s83 offen offset:3072 lds
    ds_read_b64 v[212:213], v236 offset:512
    ds_read_b64 v[214:215], v237 offset:512
    ds_read_b64 v[216:217], v238 offset:512
    ds_read_b64 v[218:219], v239 offset:512
    ds_read_b64 v[220:221], v236 offset:768
    ds_read_b64 v[222:223], v237 offset:768
    ds_read_b64 v[224:225], v238 offset:768
    ds_read_b64 v[226:227], v239 offset:768
    s_waitcnt vmcnt(14)
    v_readfirstlane_b32 s76, v254
    s_nop 0
    s_mul_i32 s76, s76, 0x19660d
    s_add_u32 s76, s76, 0x3c6ef35f
    s_barrier
    ds_read_b64_tr_b16 v[128:129], v18 offset:16384
    ds_read_b64_tr_b16 v[130:131], v18 offset:17408
    ds_read_b64_tr_b16 v[132:133], v21 offset:16384
    ds_read_b64_tr_b16 v[134:135], v21 offset:17408
    ds_read_b128 v[136:139], v240 offset:0
    ds_read_b128 v[140:143], v240 offset:4096
    ds_read_b64_tr_b16 v[144:145], v18 offset:20480
    ds_read_b64_tr_b16 v[146:147], v18 offset:21504
    ds_read_b64_tr_b16 v[148:149], v21 offset:20480
    ds_read_b64_tr_b16 v[150:151], v21 offset:21504
    ds_read_b128 v[152:155], v243 offset:0
    ds_read_b128 v[156:159], v243 offset:4096
    s_waitcnt lgkmcnt(15)
    v_mfma_f32_16x16x32_bf16 v[34:37], v[196:199], v[164:167], 0
    v_mfma_f32_16x16x32_bf16 v[34:37], v[200:203], v[168:171], v[34:37]
    v_mfma_f32_16x16x32_bf16 v[34:37], v[204:207], v[172:175], v[34:37]
    v_mfma_f32_16x16x32_bf16 v[34:37], v[208:211], v[176:179], v[34:37]
    s_waitcnt lgkmcnt(12)
    v_mfma_f32_16x16x32_bf16 v[34:37], v[212:215], v[180:183], v[34:37]
    v_mfma_f32_16x16x32_bf16 v[34:37], v[216:219], v[184:187], v[34:37]
    v_mfma_f32_16x16x32_bf16 v[34:37], v[220:223], v[188:191], v[34:37]
    v_mfma_f32_16x16x32_bf16 v[34:37], v[224:227], v[192:195], v[34:37]
    s_branch L_Gm
L_N0:
    s_lshl_b32 s62, s34, 3
    s_add_u32 s62, s62, s61
    s_sub_u32 s62, s62, 20
    s_lshl_b32 s86, s62, 7
    s_add_u32 s86, s86, 8192
    s_cmp_lt_u32 s62, 54
    s_cselect_b32 s63, 0, 0x80000000
    s_lshl_b32 s56, s62, 2
    s_add_u32 s56, s56, s3
    s_mul_i32 s56, s56, 10240
    s_or_b32 s78, s56, s63
    v_lshrrev_b32 v6, 4, v0
    v_and_b32 v7, 15, v0
    v_lshlrev_b32 v8, 1, v6
    v_xor_b32_e64 v7, v7, v8
    v_mul_u32_u24 v6, 1280, v6
    v_lshl_add_u32 v46, v7, 4, v6
    v_xor_b32_e64 v7, 8, v7
    v_lshl_add_u32 v47, v7, 4, v6
    v_add_u32 v47, 4096, v47
    s_lshl_b32 s79, s3, 11
    s_waitcnt lgkmcnt(0)
    s_branch L_Gs
L_Npack:
    s_add_u32 m0, s65, 0
    s_cmp_ge_u32 s64, 10
    s_cselect_b32 s83, s95, s66
    s_add_u32 s83, s83, 0
    s_nop 0
    buffer_load_dwordx4 v10, s[36:39], s83 offen lds
    buffer_load_dwordx4 v11, s[36:39], s83 offen offset:1024 lds
    buffer_load_dwordx4 v12, s[36:39], s83 offen offset:2048 lds
    buffer_load_dwordx4 v13, s[36:39], s83 offen offset:3072 lds
    s_add_u32 m0, s65, 16384
    s_cmp_ge_u32 s64, 10
    s_cselect_b32 s83, s69, s67
    s_add_u32 s83, s83, 0
    buffer_load_dwordx4 v14, s[40:43], s83 offen lds
    buffer_load_dwordx4 v15, s[40:43], s83 offen offset:1024 lds
    buffer_load_dwordx4 v16, s[40:43], s83 offen offset:2048 lds
    buffer_load_dwordx4 v17, s[40:43], s83 offen offset:3072 lds
    s_mov_b32 s52, s24
    s_mov_b32 s53, s25
    s_mov_b32 s54, 2211840
    s_mov_b32 s55, 0x20000
    s_add_u32 m0, s79, 131072
    s_add_u32 s57, s78, 0
    buffer_load_dwordx4 v46, s[52:55], s57 offen lds
    buffer_load_dwordx4 v47, s[52:55], s57 offen offset:1024 lds
    s_add_u32 m0, s79, 139264
    s_add_u32 s57, s78, 256
    buffer_load_dwordx4 v46, s[52:55], s57 offen lds
    buffer_load_dwordx4 v47, s[52:55], s57 offen offset:1024 lds
    s_add_u32 m0, s79, 147456
    s_add_u32 s57, s78, 512
    buffer_load_dwordx4 v46, s[52:55], s57 offen lds
    buffer_load_dwordx4 v47, s[52:55], s57 offen offset:1024 lds
    s_add_u32 m0, s79, 155648
    s_add_u32 s57, s78, 768
    buffer_load_dwordx4 v46, s[52:55], s57 offen lds
    buffer_load_dwordx4 v47, s[52:55], s57 offen offset:1024 lds
    s_add_u32 m0, s79, 114688
    s_add_u32 s57, s78, 1024
    buffer_load_dwordx4 v46, s[52:55], s57 offen lds
    buffer_load_dwordx4 v47, s[52:55], s57 offen offset:1024 lds
    s_add_u32 m0, s65, 32768
    s_cmp_ge_u32 s64, 9
    s_cselect_b32 s83, s95, s66
    s_add_u32 s83, s83, 128
    buffer_load_dwordx4 v10, s[36:39], s83 offen lds
    buffer_load_dwordx4 v11, s[36:39], s83 offen offset:1024 lds
    buffer_load_dwordx4 v12, s[36:39], s83 offen offset:2048 lds
    buffer_load_dwordx4 v13, s[36:39], s83 offen offset:3072 lds
    s_add_u32 m0, s65, 49152
    s_cmp_ge_u32 s64, 9
    s_cselect_b32 s83, s69, s67
    s_add_u32 s83, s83, 221184
    buffer_load_dwordx4 v14, s[40:43], s83 offen lds
    buffer_load_dwordx4 v15, s[40:43], s83 offen offset:1024 lds
    buffer_load_dwordx4 v16, s[40:43], s83 offen offset:2048 lds
    buffer_load_dwordx4 v17, s[40:43], s83 offen offset:3072 lds
    v_bfe_u32 v40, v0, 2, 2
    v_bfe_u32 v41, v0, 4, 1
    v_lshl_add_u32 v40, v41, 2, v40
    v_lshlrev_b32_e64 v41, 1, v40
    v_bfe_u32 v42, v0, 1, 1
    v_xor_b32 v41, v41, v42
    s_lshl_b32 s56, s3, 1
    v_xor_b32 v41, s56, v41
    v_lshrrev_b32 v42, 5, v0
    v_lshlrev_b32_e64 v42, 12, v42
    v_lshl_add_u32 v42, v40, 8, v42
    v_and_b32_e64 v43, 1, v0
    v_lshl_add_u32 v42, v43, 3, v42
    v_add_u32 v42, 114688, v42
    v_lshl_add_u32 v44, v41, 4, v42
    v_xor_b32_e64 v41, 8, v41
    v_lshl_add_u32 v45, v41, 4, v42
    s_mul_i32 s58, s62, 5120
    s_add_u32 s58, s58, 5373952
    s_or_b32 s58, s58, s63
    s_waitcnt vmcnt(8)
    s_barrier
    s_nop 0
    ds_read_b64_tr_b16 v[64:65], v44 offset:16384
    ds_read_b64_tr_b16 v[66:67], v44 offset:18432
    ds_read_b64_tr_b16 v[68:69], v45 offset:16384
    ds_read_b64_tr_b16 v[70:71], v45 offset:18432
    ds_read_b64_tr_b16 v[72:73], v44 offset:24576
    ds_read_b64_tr_b16 v[74:75], v44 offset:26624
    s_add_u32 s56, s3, 0
    s_mul_i32 s57, s56, 52
    s_lshr_b32 s57, s57, 8
    s_mul_i32 s57, s57, 271360
    s_lshl_b32 s56, s56, 10
    s_add_u32 s56, s56, s57
    s_add_u32 s56, s56, s58
    s_waitcnt lgkmcnt(4)
    buffer_store_dwordx4 v[64:67], v1, s[44:47], s56 offen sc1
    ds_read_b64_tr_b16 v[76:77], v45 offset:24576
    ds_read_b64_tr_b16 v[78:79], v45 offset:26624
    s_add_u32 s56, s3, 4
    s_mul_i32 s57, s56, 52
    s_lshr_b32 s57, s57, 8
    s_mul_i32 s57, s57, 271360
    s_lshl_b32 s56, s56, 10
    s_add_u32 s56, s56, s57
    s_add_u32 s56, s56, s58
    s_waitcnt lgkmcnt(4)
    buffer_store_dwordx4 v[68:71], v1, s[44:47], s56 offen sc1
    ds_read_b64_tr_b16 v[80:81], v44 offset:32768
    ds_read_b64_tr_b16 v[82:83], v44 offset:34816
    s_add_u32 s56, s3, 8
    s_mul_i32 s57, s56, 52
    s_lshr_b32 s57, s57, 8
    s_mul_i32 s57, s57, 271360
    s_lshl_b32 s56, s56, 10
    s_add_u32 s56, s56, s57
    s_add_u32 s56, s56, s58
    s_waitcnt lgkmcnt(4)
    buffer_store_dwordx4 v[72:75], v1, s[44:47], s56 offen sc1
    ds_read_b64_tr_b16 v[84:85], v45 offset:32768
    ds_read_b64_tr_b16 v[86:87], v45 offset:34816
    s_add_u32 s56, s3, 12
    s_mul_i32 s57, s56, 52
    s_lshr_b32 s57, s57, 8
    s_mul_i32 s57, s57, 271360
    s_lshl_b32 s56, s56, 10
    s_add_u32 s56, s56, s57
    s_add_u32 s56, s56, s58
    s_waitcnt lgkmcnt(4)
    buffer_store_dwordx4 v[76:79], v1, s[44:47], s56 offen sc1
    ds_read_b64_tr_b16 v[88:89], v44 offset:40960
    ds_read_b64_tr_b16 v[90:91], v44 offset:43008
    s_add_u32 s56, s3, 16
    s_mul_i32 s57, s56, 52
    s_lshr_b32 s57, s57, 8
    s_mul_i32 s57, s57, 271360
    s_lshl_b32 s56, s56, 10
    s_add_u32 s56, s56, s57
    s_add_u32 s56, s56, s58
    s_waitcnt lgkmcnt(4)
    buffer_store_dwordx4 v[80:83], v1, s[44:47], s56 offen sc1
    ds_read_b64_tr_b16 v[92:93], v45 offset:40960
    ds_read_b64_tr_b16 v[94:95], v45 offset:43008
    s_add_u32 s56, s3, 20
    s_mul_i32 s57, s56, 52
    s_lshr_b32 s57, s57, 8
    s_mul_i32 s57, s57, 271360
    s_lshl_b32 s56, s56, 10
    s_add_u32 s56, s56, s57
    s_add_u32 s56, s56, s58
    s_waitcnt lgkmcnt(4)
    buffer_store_dwordx4 v[84:87], v1, s[44:47], s56 offen sc1
    ds_read_b64_tr_b16 v[96:97], v44 offset:0
    ds_read_b64_tr_b16 v[98:99], v44 offset:2048
    s_add_u32 s56, s3, 24
    s_mul_i32 s57, s56, 52
    s_lshr_b32 s57, s57, 8
    s_mul_i32 s57, s57, 271360
    s_lshl_b32 s56, s56, 10
    s_add_u32 s56, s56, s57
    s_add_u32 s56, s56, s58
    s_waitcnt lgkmcnt(4)
    buffer_store_dwordx4 v[88:91], v1, s[44:47], s56 offen sc1
    ds_read_b64_tr_b16 v[100:101], v45 offset:0
    ds_read_b64_tr_b16 v[102:103], v45 offset:2048
    s_add_u32 s56, s3, 28
    s_mul_i32 s57, s56, 52
    s_lshr_b32 s57, s57, 8
    s_mul_i32 s57, s57, 271360
    s_lshl_b32 s56, s56, 10
    s_add_u32 s56, s56, s57
    s_add_u32 s56, s56, s58
    s_waitcnt lgkmcnt(4)
    buffer_store_dwordx4 v[92:95], v1, s[44:47], s56 offen sc1
    s_add_u32 s56, s3, 32
    s_mul_i32 s57, s56, 52
    s_lshr_b32 s57, s57, 8
    s_mul_i32 s57, s57, 271360
    s_lshl_b32 s56, s56, 10
    s_add_u32 s56, s56, s57
    s_add_u32 s56, s56, s58
    s_waitcnt lgkmcnt(2)
    buffer_store_dwordx4 v[96:99], v1, s[44:47], s56 offen sc1
    s_add_u32 s56, s3, 36
    s_mul_i32 s57, s56, 52
    s_lshr_b32 s57, s57, 8
    s_mul_i32 s57, s57, 271360
    s_lshl_b32 s56, s56, 10
    s_add_u32 s56, s56, s57
    s_add_u32 s56, s56, s58
    s_waitcnt lgkmcnt(0)
    buffer_store_dwordx4 v[100:103], v1, s[44:47], s56 offen sc1
    s_add_u32 m0, s65, 65536
    s_cmp_ge_u32 s64, 8
    s_cselect_b32 s83, s95, s66
    s_add_u32 s83, s83, 256
    buffer_load_dwordx4 v10, s[36:39], s83 offen lds
    buffer_load_dwordx4 v11, s[36:39], s83 offen offset:1024 lds
    buffer_load_dwordx4 v12, s[36:39], s83 offen offset:2048 lds
    buffer_load_dwordx4 v13, s[36:39], s83 offen offset:3072 lds
    s_add_u32 m0, s65, 81920
    s_cmp_ge_u32 s64, 8
    s_cselect_b32 s83, s69, s67
    s_add_u32 s83, s83, 442368
    buffer_load_dwordx4 v14, s[40:43], s83 offen lds
    buffer_load_dwordx4 v15, s[40:43], s83 offen offset:1024 lds
    buffer_load_dwordx4 v16, s[40:43], s83 offen offset:2048 lds
    buffer_load_dwordx4 v17, s[40:43], s83 offen offset:3072 lds
    v_readfirstlane_b32 s76, v254
    s_nop 0
    s_mul_i32 s76, s76, 0x19660d
    s_add_u32 s76, s76, 0x3c6ef35f
    s_waitcnt vmcnt(8)
    s_barrier
    s_cmp_lg_u32 s3, 0
    s_cbranch_scc1 Lw0_3
    v_mov_b32_e64 v224, s76
    v_mov_b32 v225, 0
    s_mov_b64 exec, 1
    buffer_store_dword v224, v225, s[44:47], s86 offen sc1
    s_mov_b64 exec, -1
Lw0_3:
    s_barrier
    ds_read_b64_tr_b16 v[128:129], v18 offset:16384
    ds_read_b64_tr_b16 v[130:131], v18 offset:17408
    ds_read_b64_tr_b16 v[132:133], v21 offset:16384
    ds_read_b64_tr_b16 v[134:135], v21 offset:17408
    ds_read_b128 v[136:139], v240 offset:0
    ds_read_b128 v[140:143], v240 offset:4096
    ds_read_b64_tr_b16 v[144:145], v18 offset:20480
    ds_read_b64_tr_b16 v[146:147], v18 offset:21504
    ds_read_b64_tr_b16 v[148:149], v21 offset:20480
    ds_read_b64_tr_b16 v[150:151], v21 offset:21504
    ds_read_b128 v[152:155], v243 offset:0
    ds_read_b128 v[156:159], v243 offset:4096
L_Gm:
    s_waitcnt lgkmcnt(6)
    v_mfma_f32_32x32x16_bf16 v[64:79], v[128:131], v[136:139], 0
    ds_read_b64_tr_b16 v[160:161], v18 offset:24576
    ds_read_b64_tr_b16 v[162:163], v18 offset:25600
    s_add_u32 m0, s65, 98304
    s_cmp_ge_u32 s64, 7
    s_cselect_b32 s83, s95, s66
    s_nop 0
    s_add_u32 s83, s83, 384
    buffer_load_dwordx4 v10, s[36:39], s83 offen lds
    v_mfma_f32_32x32x16_bf16 v[80:95], v[128:131], v[140:143], 0
    ds_read_b64_tr_b16 v[164:165], v21 offset:24576
    ds_read_b64_tr_b16 v[166:167], v21 offset:25600
    v_mfma_f32_32x32x16_bf16 v[112:127], v[132:135], v[140:143], 0
    ds_read_b128 v[168:171], v246 offset:0
    buffer_load_dwordx4 v11, s[36:39], s83 offen offset:1024 lds
    v_mfma_f32_32x32x16_bf16 v[96:111], v[132:135], v[136:139], 0
    ds_read_b128 v[172:175], v246 offset:4096
    s_waitcnt lgkmcnt(6)
    s_nop 0
    v_mfma_f32_32x32x16_bf16 v[64:79], v[144:147], v[152:155], v[64:79]
    ds_read_b64_tr_b16 v[128:129], v18 offset:28672
    ds_read_b64_tr_b16 v[130:131], v18 offset:29696
    buffer_load_dwordx4 v12, s[36:39], s83 offen offset:2048 lds
    v_mfma_f32_32x32x16_bf16 v[80:95], v[144:147], v[156:159], v[80:95]
    ds_read_b64_tr_b16 v[132:133], v21 offset:28672
    ds_read_b64_tr_b16 v[134:135], v21 offset:29696
    v_mfma_f32_32x32x16_bf16 v[112:127], v[148:151], v[156:159], v[112:127]
    ds_read_b128 v[136:139], v249 offset:0
    buffer_load_dwordx4 v13, s[36:39], s83 offen offset:3072 lds
    v_mfma_f32_32x32x16_bf16 v[96:111], v[148:151], v[152:155], v[96:111]
    ds_read_b128 v[140:143], v249 offset:4096
    s_waitcnt lgkmcnt(6)
    v_mfma_f32_32x32x16_bf16 v[64:79], v[160:163], v[168:171], v[64:79]
    s_waitcnt vmcnt(12)
    s_barrier
    ds_read_b64_tr_b16 v[144:145], v18 offset:49152
    ds_read_b64_tr_b16 v[146:147], v18 offset:50176
    s_add_u32 m0, s65, 114688
    s_cmp_ge_u32 s64, 7
    s_cselect_b32 s83, s69, s67
    s_nop 0
    s_add_u32 s83, s83, 663552
    buffer_load_dwordx4 v14, s[40:43], s83 offen lds
    v_mfma_f32_32x32x16_bf16 v[80:95], v[160:163], v[172:175], v[80:95]
    ds_read_b64_tr_b16 v[148:149], v21 offset:49152
    ds_read_b64_tr_b16 v[150:151], v21 offset:50176
    v_mfma_f32_32x32x16_bf16 v[112:127], v[164:167], v[172:175], v[112:127]
    ds_read_b128 v[152:155], v240 offset:32768
    buffer_load_dwordx4 v15, s[40:43], s83 offen offset:1024 lds
    v_mfma_f32_32x32x16_bf16 v[96:111], v[164:167], v[168:171], v[96:111]
    ds_read_b128 v[156:159], v240 offset:36864
    s_waitcnt lgkmcnt(6)
    s_nop 0
    v_mfma_f32_32x32x16_bf16 v[64:79], v[128:131], v[136:139], v[64:79]
    ds_read_b64_tr_b16 v[160:161], v18 offset:53248
    ds_read_b64_tr_b16 v[162:163], v18 offset:54272
    buffer_load_dwordx4 v16, s[40:43], s83 offen offset:2048 lds
    v_mfma_f32_32x32x16_bf16 v[80:95], v[128:131], v[140:143], v[80:95]
    ds_read_b64_tr_b16 v[164:165], v21 offset:53248
    ds_read_b64_tr_b16 v[166:167], v21 offset:54272
    v_mfma_f32_32x32x16_bf16 v[112:127], v[132:135], v[140:143], v[112:127]
    ds_read_b128 v[168:171], v243 offset:32768
    buffer_load_dwordx4 v17, s[40:43], s83 offen offset:3072 lds
    v_mfma_f32_32x32x16_bf16 v[96:111], v[132:135], v[136:139], v[96:111]
    ds_read_b128 v[172:175], v243 offset:36864
    s_waitcnt lgkmcnt(6)
    v_mfma_f32_32x32x16_bf16 v[64:79], v[144:147], v[152:155], v[64:79]
    ds_read_b64_tr_b16 v[128:129], v18 offset:57344
    ds_read_b64_tr_b16 v[130:131], v18 offset:58368
    s_add_u32 m0, s65, 131072
    s_cmp_ge_u32 s64, 6
    s_cselect_b32 s83, s95, s66
    s_add_u32 s83, s83, 512
    buffer_load_dwordx4 v10, s[36:39], s83 offen lds
    s_lshl_b32 s57, s3, 14
    v_mfma_f32_32x32x16_bf16 v[80:95], v[144:147], v[156:159], v[80:95]
    ds_read_b64_tr_b16 v[132:133], v21 offset:57344
    ds_read_b64_tr_b16 v[134:135], v21 offset:58368
    v_and_b32_e64 v60, 15, v0
    s_add_u32 s56, s57, 7232
    v_mfma_f32_32x32x16_bf16 v[112:127], v[148:151], v[156:159], v[112:127]
    ds_read_b128 v[136:139], v246 offset:32768
    buffer_load_dwordx4 v11, s[36:39], s83 offen offset:1024 lds
    v_lshrrev_b32 v61, 4, v0
    v_lshrrev_b32 v62, 5, v0
    v_mfma_f32_32x32x16_bf16 v[96:111], v[148:151], v[152:155], v[96:111]
    ds_read_b128 v[140:143], v246 offset:36864
    v_bfe_u32 v63, v0, 4, 1
    v_cmp_gt_u32 s[54:55], 32, v0
    s_waitcnt lgkmcnt(6)
    s_nop 0
    v_mfma_f32_32x32x16_bf16 v[64:79], v[160:163], v[168:171], v[64:79]
    ds_read_b64_tr_b16 v[144:145], v18 offset:61440
    ds_read_b64_tr_b16 v[146:147], v18 offset:62464
    buffer_load_dwordx4 v12, s[36:39], s83 offen offset:2048 lds
    v_lshl_add_u32 v40, v60, 4, s56
    v_lshlrev_b32_e64 v41, 3, v60
    v_mfma_f32_32x32x16_bf16 v[80:95], v[160:163], v[172:175], v[80:95]
    ds_read_b64_tr_b16 v[148:149], v21 offset:61440
    ds_read_b64_tr_b16 v[150:151], v21 offset:62464
    v_lshl_add_u32 v40, v62, 8, v40
    v_lshlrev_b32_e64 v59, 2, v60
    v_mfma_f32_32x32x16_bf16 v[112:127], v[164:167], v[172:175], v[112:127]
    ds_read_b128 v[152:155], v249 offset:32768
    buffer_load_dwordx4 v13, s[36:39], s83 offen offset:3072 lds
    v_lshl_add_u32 v40, v63, 3, v40
    v_add_u32 v41, 528, v41
    v_mfma_f32_32x32x16_bf16 v[96:111], v[164:167], v[168:171], v[96:111]
    ds_read_b128 v[156:159], v249 offset:36864
    v_add_u32 v59, 1078, v59
    v_mov_b32 v42, 64
    s_waitcnt lgkmcnt(6)
    v_mfma_f32_32x32x16_bf16 v[64:79], v[128:131], v[136:139], v[64:79]
    s_waitcnt vmcnt(12)
    s_barrier
    ds_read_b64_tr_b16 v[160:161], v19 offset:16384
    ds_read_b64_tr_b16 v[162:163], v19 offset:17408
    s_add_u32 m0, s65, 147456
    s_cmp_ge_u32 s64, 6
    s_cselect_b32 s83, s69, s67
    s_add_u32 s83, s83, 884736
    buffer_load_dwordx4 v14, s[40:43], s83 offen lds
    v_cndmask_b32 v41, v59, v41, s[54:55]
    v_cndmask_b32 v42, v42, 4, s[54:55]
    v_mfma_f32_32x32x16_bf16 v[80:95], v[128:131], v[140:143], v[80:95]
    ds_read_b64_tr_b16 v[164:165], v22 offset:16384
    ds_read_b64_tr_b16 v[166:167], v22 offset:17408
    v_lshl_add_u32 v41, v63, 7, v41
    v_mfma_f32_32x32x16_bf16 v[112:127], v[132:135], v[140:143], v[112:127]
    ds_read_b128 v[168:171], v241 offset:0
    buffer_load_dwordx4 v15, s[40:43], s83 offen offset:1024 lds
    v_lshlrev_b32 v53, 1, v60
    v_add_u32 v41, s56, v41
    v_mfma_f32_32x32x16_bf16 v[96:111], v[132:135], v[136:139], v[96:111]
    ds_read_b128 v[172:175], v241 offset:4096
    v_lshl_add_u32 v53, v61, 7, v53
    v_add_u32 v42, v42, v41
    s_waitcnt lgkmcnt(6)
    v_mfma_f32_32x32x16_bf16 v[64:79], v[144:147], v[152:155], v[64:79]
    ds_read_b64_tr_b16 v[128:129], v19 offset:20480
    ds_read_b64_tr_b16 v[130:131], v19 offset:21504
    buffer_load_dwordx4 v16, s[40:43], s83 offen offset:2048 lds
    v_add_u32 v53, 1534, v53
    v_mov_b32 v59, 1984
    v_mfma_f32_32x32x16_bf16 v[80:95], v[144:147], v[156:159], v[80:95]
    ds_read_b64_tr_b16 v[132:133], v22 offset:20480
    ds_read_b64_tr_b16 v[134:135], v22 offset:21504
    v_mov_b32_e64 v44, s56
    v_cndmask_b32 v43, v59, v53, s[54:55]
    v_mfma_f32_32x32x16_bf16 v[112:127], v[148:151], v[156:159], v[112:127]
    ds_read_b128 v[136:139], v244 offset:0
    buffer_load_dwordx4 v17, s[40:43], s83 offen offset:3072 lds
    v_lshlrev_b32 v45, 4, v0
    v_add_u32 v43, s56, v43
    v_mfma_f32_32x32x16_bf16 v[96:111], v[148:151], v[152:155], v[96:111]
    ds_read_b128 v[140:143], v244 offset:4096
    v_lshlrev_b32_e64 v58, 3, v0
    v_add_u32 v45, 16, v45
    s_waitcnt lgkmcnt(6)
    v_mfma_f32_32x32x16_bf16 v[64:79], v[160:163], v[168:171], v[64:79]
    ds_read_b64_tr_b16 v[144:145], v19 offset:24576
    ds_read_b64_tr_b16 v[146:147], v19 offset:25600
    s_add_u32 m0, s65, 0
    s_cmp_ge_u32 s64, 5
    s_cselect_b32 s83, s95, s66
    s_nop 0
    s_add_u32 s83, s83, 640
    buffer_load_dwordx4 v10, s[36:39], s83 offen lds
    v_add_u32 v58, 272, v58
    v_add_u32_e64 v47, s57, v1
    v_mfma_f32_32x32x16_bf16 v[80:95], v[160:163], v[172:175], v[80:95]
    ds_read_b64_tr_b16 v[148:149], v22 offset:24576
    ds_read_b64_tr_b16 v[150:151], v22 offset:25600
    v_cndmask_b32 v45, v58, v45, s[54:55]
    v_cmp_ge_u32 s[54:55], 32, v0
    v_mfma_f32_32x32x16_bf16 v[112:127], v[164:167], v[172:175], v[112:127]
    ds_read_b128 v[152:155], v247 offset:0
    buffer_load_dwordx4 v11, s[36:39], s83 offen offset:1024 lds
    v_add_u32 v47, 8192, v47
    v_add_u32_e64 v45, s56, v45
    v_mfma_f32_32x32x16_bf16 v[96:111], v[164:167], v[168:171], v[96:111]
    ds_read_b128 v[156:159], v247 offset:4096
    v_cndmask_b32 v53, v59, v53, s[54:55]
    s_waitcnt lgkmcnt(6)
    s_nop 0
    v_mfma_f32_32x32x16_bf16 v[64:79], v[128:131], v[136:139], v[64:79]
    ds_read_b64_tr_b16 v[160:161], v19 offset:28672
    ds_read_b64_tr_b16 v[162:163], v19 offset:29696
    buffer_load_dwordx4 v12, s[36:39], s83 offen offset:2048 lds
    v_add_u32_e64 v46, -2, v45
    v_mov_b32 v58, 1856
    v_mfma_f32_32x32x16_bf16 v[80:95], v[128:131], v[140:143], v[80:95]
    ds_read_b64_tr_b16 v[164:165], v22 offset:28672
    ds_read_b64_tr_b16 v[166:167], v22 offset:29696
    v_cndmask_b32 v46, v45, v46, s[54:55]
    v_cmp_eq_u32 s[54:55], 0, v0
    v_mfma_f32_32x32x16_bf16 v[112:127], v[132:135], v[140:143], v[112:127]
    ds_read_b128 v[168:171], v250 offset:0
    buffer_load_dwordx4 v13, s[36:39], s83 offen offset:3072 lds
    v_add_u32 v48, 784, v44
    v_lshlrev_b32_e64 v231, 5, v60
    v_mfma_f32_32x32x16_bf16 v[96:111], v[132:135], v[136:139], v[96:111]
    ds_read_b128 v[172:175], v250 offset:4096
    v_cndmask_b32 v53, v53, v58, s[54:55]
    v_cmp_eq_u32 s[54:55], 32, v0
    s_waitcnt lgkmcnt(6)
    v_mfma_f32_32x32x16_bf16 v[64:79], v[144:147], v[152:155], v[64:79]
    s_waitcnt vmcnt(12)
    s_barrier
    ds_read_b64_tr_b16 v[128:129], v19 offset:49152
    ds_read_b64_tr_b16 v[130:131], v19 offset:50176
    s_add_u32 m0, s65, 16384
    s_cmp_ge_u32 s64, 5
    s_cselect_b32 s83, s69, s67
    s_nop 0
    s_add_u32 s83, s83, 1105920
    buffer_load_dwordx4 v14, s[40:43], s83 offen lds
    v_add_u32_e64 v53, s56, v53
    s_mul_i32 s56, s3, 16416
    v_mfma_f32_32x32x16_bf16 v[80:95], v[144:147], v[156:159], v[80:95]
    ds_read_b64_tr_b16 v[132:133], v22 offset:49152
    ds_read_b64_tr_b16 v[134:135], v22 offset:50176
    v_cndmask_b32 v48, v41, v48, s[54:55]
    v_lshl_add_u32 v231, v61, 4, v231
    v_mfma_f32_32x32x16_bf16 v[112:127], v[148:151], v[156:159], v[112:127]
    ds_read_b128 v[136:139], v241 offset:32768
    buffer_load_dwordx4 v15, s[40:43], s83 offen offset:1024 lds
    v_cmp_gt_u32 s[54:55], 36, v0
    v_add_u32_e64 v52, s56, v1
    v_mfma_f32_32x32x16_bf16 v[96:111], v[148:151], v[152:155], v[96:111]
    ds_read_b128 v[140:143], v241 offset:36864
    v_add_u32_e64 v231, s56, v231
    s_add_u32 s56, s57, 9216
    s_waitcnt lgkmcnt(6)
    s_nop 0
    v_mfma_f32_32x32x16_bf16 v[64:79], v[160:163], v[168:171], v[64:79]
    ds_read_b64_tr_b16 v[144:145], v19 offset:53248
    ds_read_b64_tr_b16 v[146:147], v19 offset:54272
    buffer_load_dwordx4 v16, s[40:43], s83 offen offset:2048 lds
    v_mov_b32 v59, s56
    v_lshrrev_b32 v58, 1, v0
    v_mfma_f32_32x32x16_bf16 v[80:95], v[160:163], v[172:175], v[80:95]
    ds_read_b64_tr_b16 v[148:149], v22 offset:53248
    ds_read_b64_tr_b16 v[150:151], v22 offset:54272
    v_cndmask_b32 v52, v59, v52, s[54:55]
    v_mfma_f32_32x32x16_bf16 v[112:127], v[164:167], v[172:175], v[112:127]
    ds_read_b128 v[152:155], v244 offset:32768
    buffer_load_dwordx4 v17, s[40:43], s83 offen offset:3072 lds
    v_cmp_gt_u32 s[54:55], 4, v58
    v_sub_u32_e64 v50, 3, v58
    v_mfma_f32_32x32x16_bf16 v[96:111], v[164:167], v[168:171], v[96:111]
    ds_read_b128 v[156:159], v244 offset:36864
    v_add_u32_e64 v58, 64, v58
    s_add_u32 s56, s57, 4864
    s_waitcnt lgkmcnt(6)
    v_mfma_f32_32x32x16_bf16 v[64:79], v[128:131], v[136:139], v[64:79]
    ds_read_b64_tr_b16 v[160:161], v19 offset:57344
    ds_read_b64_tr_b16 v[162:163], v19 offset:58368
    s_add_u32 m0, s65, 32768
    s_cmp_ge_u32 s64, 4
    s_cselect_b32 s83, s95, s66
    s_nop 0
    s_add_u32 s83, s83, 768
    buffer_load_dwordx4 v10, s[36:39], s83 offen lds
    v_cndmask_b32 v50, v58, v50, s[54:55]
    v_and_b32_e64 v58, 1, v0
    v_mfma_f32_32x32x16_bf16 v[80:95], v[128:131], v[140:143], v[80:95]
    ds_read_b64_tr_b16 v[164:165], v22 offset:57344
    ds_read_b64_tr_b16 v[166:167], v22 offset:58368
    v_lshl_add_u32 v50, v50, 4, s56
    v_mul_u32_u24 v62, 1216, v58
    v_mfma_f32_32x32x16_bf16 v[112:127], v[132:135], v[140:143], v[112:127]
    ds_read_b128 v[168:171], v247 offset:32768
    buffer_load_dwordx4 v11, s[36:39], s83 offen offset:1024 lds
    v_cmp_gt_u32 s[54:55], 12, v0
    v_add_u32_e64 v50, v50, v62
    v_mfma_f32_32x32x16_bf16 v[96:111], v[132:135], v[136:139], v[96:111]
    ds_read_b128 v[172:175], v247 offset:36864
    s_add_u32 s56, s57, 5936
    v_cndmask_b32 v50, v59, v50, s[54:55]
    s_waitcnt lgkmcnt(6)
    s_nop 0
    v_mfma_f32_32x32x16_bf16 v[64:79], v[144:147], v[152:155], v[64:79]
    ds_read_b64_tr_b16 v[128:129], v19 offset:61440
    ds_read_b64_tr_b16 v[130:131], v19 offset:62464
    buffer_load_dwordx4 v12, s[36:39], s83 offen offset:2048 lds
    v_sub_u32 v49, s56, v1
    v_lshrrev_b32 v59, 1, v60
    v_mfma_f32_32x32x16_bf16 v[80:95], v[144:147], v[156:159], v[80:95]
    ds_read_b64_tr_b16 v[132:133], v22 offset:61440
    ds_read_b64_tr_b16 v[134:135], v22 offset:62464
    v_lshlrev_b32 v62, 2, v61
    v_xor_b32 v58, 1, v58
    v_mfma_f32_32x32x16_bf16 v[112:127], v[148:151], v[156:159], v[112:127]
    ds_read_b128 v[136:139], v250 offset:32768
    buffer_load_dwordx4 v13, s[36:39], s83 offen offset:3072 lds
    v_sub_u32_e64 v59, v62, v59
    v_mul_u32_u24 v58, 1216, v58
    v_mfma_f32_32x32x16_bf16 v[96:111], v[148:151], v[152:155], v[96:111]
    ds_read_b128 v[140:143], v250 offset:36864
    v_lshlrev_b32 v59, 2, v59
    s_waitcnt lgkmcnt(6)
    v_mfma_f32_32x32x16_bf16 v[64:79], v[160:163], v[168:171], v[64:79]
    s_waitcnt vmcnt(12)
    s_barrier
    ds_read_b64_tr_b16 v[144:145], v20 offset:16384
    ds_read_b64_tr_b16 v[146:147], v20 offset:17408
    s_add_u32 m0, s65, 49152
    s_cmp_ge_u32 s64, 4
    s_cselect_b32 s83, s69, s67
    s_add_u32 s83, s83, 1327104
    buffer_load_dwordx4 v14, s[40:43], s83 offen lds
    s_add_u32 s56, s57, 4892
    v_sub_u32_e64 v62, v60, v62
    v_mfma_f32_32x32x16_bf16 v[80:95], v[160:163], v[172:175], v[80:95]
    ds_read_b64_tr_b16 v[148:149], v23 offset:16384
    ds_read_b64_tr_b16 v[150:151], v23 offset:17408
    v_add3_u32 v227, v59, v58, s56
    s_add_u32 s56, s57, 8756
    v_mfma_f32_32x32x16_bf16 v[112:127], v[164:167], v[172:175], v[112:127]
    ds_read_b128 v[152:155], v242 offset:0
    buffer_load_dwordx4 v15, s[40:43], s83 offen offset:1024 lds
    v_lshlrev_b32_e64 v61, 1, v61
    v_lshl_add_u32 v230, v62, 2, s56
    v_mfma_f32_32x32x16_bf16 v[96:111], v[164:167], v[168:171], v[96:111]
    ds_read_b128 v[156:159], v242 offset:4096
    v_sub_u32_e64 v61, v60, v61
    s_add_u32 s56, s57, 8240
    s_waitcnt lgkmcnt(6)
    s_nop 0
    v_mfma_f32_32x32x16_bf16 v[64:79], v[128:131], v[136:139], v[64:79]
    ds_read_b64_tr_b16 v[160:161], v20 offset:20480
    ds_read_b64_tr_b16 v[162:163], v20 offset:21504
    buffer_load_dwordx4 v16, s[40:43], s83 offen offset:2048 lds
    v_add_u32 v228, 0x200, v227
    v_lshl_add_u32 v229, v61, 3, s56
    v_mfma_f32_32x32x16_bf16 v[80:95], v[128:131], v[140:143], v[80:95]
    ds_read_b64_tr_b16 v[164:165], v23 offset:20480
    ds_read_b64_tr_b16 v[166:167], v23 offset:21504
    v_and_b32 v24, 3, v0
    v_lshrrev_b32 v59, 2, v0
    v_mfma_f32_32x32x16_bf16 v[112:127], v[132:135], v[140:143], v[112:127]
    ds_read_b128 v[168:171], v245 offset:0
    buffer_load_dwordx4 v17, s[40:43], s83 offen offset:3072 lds
    v_mul_u32_u24 v24, 16416, v24
    s_lshl_b32 s56, s3, 10
    v_mfma_f32_32x32x16_bf16 v[96:111], v[132:135], v[136:139], v[96:111]
    ds_read_b128 v[172:175], v245 offset:4096
    v_lshl_add_u32 v24, v59, 4, v24
    s_add_u32 s56, s56, 576
    s_waitcnt lgkmcnt(6)
    v_mfma_f32_32x32x16_bf16 v[64:79], v[144:147], v[152:155], v[64:79]
    ds_read_b64_tr_b16 v[128:129], v20 offset:24576
    ds_read_b64_tr_b16 v[130:131], v20 offset:25600
    s_add_u32 m0, s65, 65536
    s_cmp_ge_u32 s64, 3
    s_cselect_b32 s83, s95, s66
    s_add_u32 s83, s83, 896
    buffer_load_dwordx4 v10, s[36:39], s83 offen lds
    s_mov_b32 s98, 0x01000302
    v_add_u32_e64 v24, s56, v24
    v_mfma_f32_32x32x16_bf16 v[80:95], v[144:147], v[156:159], v[80:95]
    ds_read_b64_tr_b16 v[132:133], v23 offset:24576
    ds_read_b64_tr_b16 v[134:135], v23 offset:25600
    s_mov_b32 s99, 0x03020504
    v_mfma_f32_32x32x16_bf16 v[112:127], v[148:151], v[156:159], v[112:127]
    ds_read_b128 v[136:139], v248 offset:0
    buffer_load_dwordx4 v11, s[36:39], s83 offen offset:1024 lds
    s_mov_b32 s100, 0x01000100
    s_mov_b32 s52, 0x01000504
    v_mfma_f32_32x32x16_bf16 v[96:111], v[148:151], v[152:155], v[96:111]
    ds_read_b128 v[140:143], v248 offset:4096
    s_mul_i32 s88, s59, 221184
    s_lshl_b32 s57, s3, 10
    s_waitcnt lgkmcnt(6)
    v_mfma_f32_32x32x16_bf16 v[64:79], v[160:163], v[168:171], v[64:79]
    ds_read_b64_tr_b16 v[144:145], v20 offset:28672
    ds_read_b64_tr_b16 v[146:147], v20 offset:29696
    buffer_load_dwordx4 v12, s[36:39], s83 offen offset:2048 lds
    v_lshrrev_b32 v60, 5, v0
    s_add_u32 s88, s88, s57
    v_mfma_f32_32x32x16_bf16 v[80:95], v[160:163], v[172:175], v[80:95]
    ds_read_b64_tr_b16 v[148:149], v23 offset:28672
    ds_read_b64_tr_b16 v[150:151], v23 offset:29696
    s_lshr_b32 s56, s3, 1
    s_add_u32 s88, s88, 7602176
    v_mfma_f32_32x32x16_bf16 v[112:127], v[164:167], v[172:175], v[112:127]
    ds_read_b128 v[152:155], v251 offset:0
    buffer_load_dwordx4 v13, s[36:39], s83 offen offset:3072 lds
    s_lshl_b32 s56, s56, 31
    s_add_u32 s89, s88, 53248
    v_mfma_f32_32x32x16_bf16 v[96:111], v[164:167], v[168:171], v[96:111]
    ds_read_b128 v[156:159], v251 offset:4096
    s_lshl_b32 s20, s59, 12
    s_or_b32 s89, s89, s56
    s_waitcnt lgkmcnt(6)
    v_mfma_f32_32x32x16_bf16 v[64:79], v[128:131], v[136:139], v[64:79]
    s_waitcnt vmcnt(12)
    s_barrier
    ds_read_b64_tr_b16 v[160:161], v18 offset:16384
    ds_read_b64_tr_b16 v[162:163], v18 offset:17408
    s_add_u32 m0, s65, 81920
    s_cmp_ge_u32 s64, 3
    s_cselect_b32 s83, s69, s67
    s_nop 0
    s_add_u32 s83, s83, 1548288
    buffer_load_dwordx4 v14, s[40:43], s83 offen lds
    s_add_u32 s20, s20, 14680064
    v_lshlrev_b32_e64 v60, 31, v60
    v_mfma_f32_32x32x16_bf16 v[80:95], v[128:131], v[140:143], v[80:95]
    ds_read_b64_tr_b16 v[164:165], v21 offset:16384
    ds_read_b64_tr_b16 v[166:167], v21 offset:17408
    s_add_u32 s56, s3, 1
    s_and_b32 s56, s56, 3
    v_mfma_f32_32x32x16_bf16 v[112:127], v[132:135], v[140:143], v[112:127]
    ds_read_b128 v[168:171], v240 offset:0
    buffer_load_dwordx4 v15, s[40:43], s83 offen offset:1024 lds
    s_mul_i32 s56, s56, 55296
    v_add_u32_e64 v204, s56, v1
    v_mfma_f32_32x32x16_bf16 v[96:111], v[132:135], v[136:139], v[96:111]
    ds_read_b128 v[172:175], v240 offset:4096
    s_add_u32 s56, s3, 2
    s_waitcnt lgkmcnt(6)
    v_mfma_f32_32x32x16_bf16 v[64:79], v[144:147], v[152:155], v[64:79]
    ds_read_b64_tr_b16 v[128:129], v18 offset:20480
    ds_read_b64_tr_b16 v[130:131], v18 offset:21504
    buffer_load_dwordx4 v16, s[40:43], s83 offen offset:2048 lds
    s_and_b32 s56, s56, 3
    s_mul_i32 s56, s56, 55296
    v_mfma_f32_32x32x16_bf16 v[80:95], v[144:147], v[156:159], v[80:95]
    ds_read_b64_tr_b16 v[132:133], v21 offset:20480
    ds_read_b64_tr_b16 v[134:135], v21 offset:21504
    v_add_u32 v205, s56, v1
    s_add_u32 s56, s3, 3
    v_mfma_f32_32x32x16_bf16 v[112:127], v[148:151], v[156:159], v[112:127]
    ds_read_b128 v[136:139], v243 offset:0
    buffer_load_dwordx4 v17, s[40:43], s83 offen offset:3072 lds
    s_and_b32 s56, s56, 3
    s_mul_i32 s56, s56, 55296
    v_mfma_f32_32x32x16_bf16 v[96:111], v[148:151], v[152:155], v[96:111]
    ds_read_b128 v[140:143], v243 offset:4096
    v_add_u32_e64 v206, s56, v1
    s_add_u32 s56, s3, 4
    s_waitcnt lgkmcnt(6)
    v_mfma_f32_32x32x16_bf16 v[64:79], v[160:163], v[168:171], v[64:79]
    ds_read_b64_tr_b16 v[144:145], v18 offset:24576
    ds_read_b64_tr_b16 v[146:147], v18 offset:25600
    s_add_u32 m0, s65, 98304
    s_cmp_ge_u32 s64, 2
    s_cselect_b32 s83, s95, s66
    s_add_u32 s83, s83, 1024
    buffer_load_dwordx4 v10, s[36:39], s83 offen lds
    s_mul_i32 s79, s3, 2048
    s_add_u32 s79, s79, 8192
    v_min_u32 v224, 15, v0
    v_lshlrev_b32 v224, 7, v224
    buffer_load_dword v224, v224, s[44:47], s79 offen sc1
    s_and_b32 s56, s56, 3
    s_mul_i32 s56, s56, 55296
    v_mfma_f32_32x32x16_bf16 v[80:95], v[160:163], v[172:175], v[80:95]
    ds_read_b64_tr_b16 v[148:149], v21 offset:24576
    ds_read_b64_tr_b16 v[150:151], v21 offset:25600
    v_add_u32 v207, s56, v1
    s_lshl_b32 s21, s59, 2
    v_mfma_f32_32x32x16_bf16 v[112:127], v[164:167], v[172:175], v[112:127]
    ds_read_b128 v[152:155], v246 offset:0
    buffer_load_dwordx4 v11, s[36:39], s83 offen offset:1024 lds
    s_mul_i32 s57, s60, 160
    s_add_u32 s21, s21, s3
    v_mfma_f32_32x32x16_bf16 v[96:111], v[164:167], v[168:171], v[96:111]
    ds_read_b128 v[156:159], v246 offset:4096
    s_mov_b32 s56, 0x199a
    s_mul_i32 s21, s21, 20480
    s_waitcnt lgkmcnt(6)
    v_mfma_f32_32x32x16_bf16 v[64:79], v[128:131], v[136:139], v[64:79]
    ds_read_b64_tr_b16 v[160:161], v18 offset:28672
    ds_read_b64_tr_b16 v[162:163], v18 offset:29696
    buffer_load_dwordx4 v12, s[36:39], s83 offen offset:2048 lds
    v_add_u32 v62, 64, v0
    s_add_u32 s21, s21, s57
    s_nop 0
    v_mfma_f32_32x32x16_bf16 v[80:95], v[128:131], v[140:143], v[80:95]
    ds_read_b64_tr_b16 v[164:165], v21 offset:28672
    ds_read_b64_tr_b16 v[166:167], v21 offset:29696
    v_add_u32 v63, 0x80, v0
    v_mfma_f32_32x32x16_bf16 v[112:127], v[132:135], v[140:143], v[112:127]
    ds_read_b128 v[168:171], v249 offset:0
    buffer_load_dwordx4 v13, s[36:39], s83 offen offset:3072 lds
    v_mul_u32_u24 v58, s56, v0
    v_mul_u32_u24 v59, s56, v62
    v_mfma_f32_32x32x16_bf16 v[96:111], v[132:135], v[136:139], v[96:111]
    ds_read_b128 v[172:175], v249 offset:4096
    v_mul_u32_u24_e64 v61, s56, v63
    v_lshrrev_b32 v58, 16, v58
    s_waitcnt lgkmcnt(6)
    v_mfma_f32_32x32x16_bf16 v[64:79], v[144:147], v[152:155], v[64:79]
    s_waitcnt vmcnt(13)
    s_barrier
    ds_read_b64_tr_b16 v[128:129], v18 offset:49152
    ds_read_b64_tr_b16 v[130:131], v18 offset:50176
    s_add_u32 m0, s65, 114688
    s_cmp_ge_u32 s64, 2
    s_cselect_b32 s83, s69, s67
    s_add_u32 s83, s83, 1769472
    buffer_load_dwordx4 v14, s[40:43], s83 offen lds
    v_lshrrev_b32 v59, 16, v59
    v_lshrrev_b32 v61, 16, v61
    v_mfma_f32_32x32x16_bf16 v[80:95], v[144:147], v[156:159], v[80:95]
    ds_read_b64_tr_b16 v[132:133], v21 offset:49152
    ds_read_b64_tr_b16 v[134:135], v21 offset:50176
    v_mul_u32_u24 v58, 1120, v58
    v_mul_u32_u24 v59, 1120, v59
    v_mfma_f32_32x32x16_bf16 v[112:127], v[148:151], v[156:159], v[112:127]
    ds_read_b128 v[136:139], v240 offset:32768
    buffer_load_dwordx4 v15, s[40:43], s83 offen offset:1024 lds
    v_mul_u32_u24 v61, 1120, v61
    v_add_u32_e64 v208, v1, v58
    v_mfma_f32_32x32x16_bf16 v[96:111], v[148:151], v[152:155], v[96:111]
    ds_read_b128 v[140:143], v240 offset:36864
    v_lshl_add_u32 v209, v62, 4, v59
    v_lshl_add_u32 v210, v63, 4, v61
    s_waitcnt lgkmcnt(6)
    s_nop 0
    v_mfma_f32_32x32x16_bf16 v[64:79], v[160:163], v[168:171], v[64:79]
    ds_read_b64_tr_b16 v[144:145], v18 offset:53248
    ds_read_b64_tr_b16 v[146:147], v18 offset:54272
    buffer_load_dwordx4 v16, s[40:43], s83 offen offset:2048 lds
    v_lshrrev_b32 v61, 3, v0
    v_or_b32 v210, v210, v60
    v_mfma_f32_32x32x16_bf16 v[80:95], v[160:163], v[172:175], v[80:95]
    ds_read_b64_tr_b16 v[148:149], v21 offset:53248
    ds_read_b64_tr_b16 v[150:151], v21 offset:54272
    v_and_b32_e64 v62, 7, v0
    s_mul_i32 s24, s60, 80
    v_mfma_f32_32x32x16_bf16 v[112:127], v[164:167], v[172:175], v[112:127]
    ds_read_b128 v[152:155], v243 offset:32768
    buffer_load_dwordx4 v17, s[40:43], s83 offen offset:3072 lds
    v_lshlrev_b32 v62, 4, v62
    s_mul_i32 s56, s3, 20
    v_mfma_f32_32x32x16_bf16 v[96:111], v[164:167], v[168:171], v[96:111]
    ds_read_b128 v[156:159], v243 offset:36864
    v_lshl_add_u32 v211, v61, 12, v62
    s_waitcnt lgkmcnt(6)
    v_mfma_f32_32x32x16_bf16 v[64:79], v[128:131], v[136:139], v[64:79]
    ds_read_b64_tr_b16 v[160:161], v18 offset:57344
    ds_read_b64_tr_b16 v[162:163], v18 offset:58368
    s_add_u32 m0, s65, 131072
    s_cmp_ge_u32 s64, 1
    s_cselect_b32 s83, s95, s66
    s_add_u32 s83, s83, 1152
    buffer_load_dwordx4 v10, s[36:39], s83 offen lds
    s_add_u32 s24, s24, s56
    v_mul_u32_u24 v61, 160, v61
    v_mfma_f32_32x32x16_bf16 v[80:95], v[128:131], v[140:143], v[80:95]
    ds_read_b64_tr_b16 v[164:165], v21 offset:57344
    ds_read_b64_tr_b16 v[166:167], v21 offset:58368
    s_lshl_b32 s25, s24, 7
    v_add_u32 v212, 0x8000, v211
    v_mfma_f32_32x32x16_bf16 v[112:127], v[132:135], v[140:143], v[112:127]
    ds_read_b128 v[168:171], v246 offset:32768
    buffer_load_dwordx4 v11, s[36:39], s83 offen offset:1024 lds
    s_lshl_b32 s24, s24, 12
    v_add_u32 v213, 0x10000, v211
    v_mfma_f32_32x32x16_bf16 v[96:111], v[132:135], v[136:139], v[96:111]
    ds_read_b128 v[172:175], v246 offset:36864
    s_lshl_b32 s56, s59, 7
    v_and_b32 v62, 3, v0
    s_waitcnt lgkmcnt(6)
    v_mfma_f32_32x32x16_bf16 v[64:79], v[144:147], v[152:155], v[64:79]
    ds_read_b64_tr_b16 v[128:129], v18 offset:61440
    ds_read_b64_tr_b16 v[130:131], v18 offset:62464
    buffer_load_dwordx4 v12, s[36:39], s83 offen offset:2048 lds
    s_add_u32 s24, s24, s56
    v_or_b32_e64 v213, v213, v60
    v_mfma_f32_32x32x16_bf16 v[80:95], v[144:147], v[156:159], v[80:95]
    ds_read_b64_tr_b16 v[132:133], v21 offset:61440
    ds_read_b64_tr_b16 v[134:135], v21 offset:62464
    s_add_u32 s24, s24, 2752512
    v_lshlrev_b32_e64 v63, 5, v62
    v_mfma_f32_32x32x16_bf16 v[112:127], v[148:151], v[156:159], v[112:127]
    ds_read_b128 v[136:139], v249 offset:32768
    buffer_load_dwordx4 v13, s[36:39], s83 offen offset:3072 lds
    s_add_u32 s25, s25, 14811136
    v_bfe_u32 v60, v0, 2, 1
    v_mfma_f32_32x32x16_bf16 v[96:111], v[148:151], v[152:155], v[96:111]
    ds_read_b128 v[140:143], v249 offset:36864
    s_mul_i32 s56, s3, 3200
    v_lshl_add_u32 v63, v60, 4, v63
    s_waitcnt lgkmcnt(6)
    v_mfma_f32_32x32x16_bf16 v[64:79], v[160:163], v[168:171], v[64:79]
    s_waitcnt vmcnt(11)
    v_cmp_eq_u32 vcc, s76, v224
    s_nop 0
    s_cmp_eq_u64 vcc, -1
    s_cbranch_scc1 Lok_4
    s_mov_b32 s96, 0
Lsp_5:
    s_sleep 2
    v_min_u32 v224, 15, v0
    v_lshlrev_b32 v224, 7, v224
    buffer_load_dword v224, v224, s[44:47], s79 offen sc1
    s_waitcnt vmcnt(0)
    v_cmp_eq_u32 vcc, s76, v224
    s_nop 0
    s_cmp_eq_u64 vcc, -1
    s_cbranch_scc1 Lok_4
    s_add_u32 s96, s96, 1
    s_cmp_lt_u32 s96, 20000
    s_cbranch_scc1 Lsp_5
Lok_4:
    s_barrier
    ds_read_b64_tr_b16 v[144:145], v19 offset:16384
    ds_read_b64_tr_b16 v[146:147], v19 offset:17408
    s_add_u32 m0, s65, 147456
    s_cmp_ge_u32 s64, 1
    s_cselect_b32 s83, s69, s67
    s_add_u32 s83, s83, 1990656
    buffer_load_dwordx4 v14, s[40:43], s83 offen lds
    s_add_u32 s56, s56, 126976
    v_min_u32_e64 v223, 19, v0
    v_mfma_f32_32x32x16_bf16 v[80:95], v[160:163], v[172:175], v[80:95]
    ds_read_b64_tr_b16 v[148:149], v22 offset:16384
    ds_read_b64_tr_b16 v[150:151], v22 offset:17408
    v_add3_u32 v214, v61, v63, s56
    v_mfma_f32_32x32x16_bf16 v[112:127], v[164:167], v[172:175], v[112:127]
    ds_read_b128 v[152:155], v241 offset:0
    buffer_load_dwordx4 v15, s[40:43], s83 offen offset:1024 lds
    s_mul_i32 s56, s3, 15360
    v_lshlrev_b32_e64 v223, 7, v223
    v_mfma_f32_32x32x16_bf16 v[96:111], v[164:167], v[168:171], v[96:111]
    ds_read_b128 v[156:159], v241 offset:4096
    s_add_u32 s56, s56, 65536
    v_and_b32 v60, 15, v0
    s_waitcnt lgkmcnt(6)
    v_mfma_f32_32x32x16_bf16 v[64:79], v[128:131], v[136:139], v[64:79]
    ds_read_b64_tr_b16 v[160:161], v19 offset:20480
    ds_read_b64_tr_b16 v[162:163], v19 offset:21504
    buffer_load_dwordx4 v16, s[40:43], s83 offen offset:2048 lds
    v_add_u32_e64 v218, s56, v1
    s_mul_i32 s61, s3, 3072
    v_mfma_f32_32x32x16_bf16 v[80:95], v[128:131], v[140:143], v[80:95]
    ds_read_b64_tr_b16 v[164:165], v22 offset:20480
    ds_read_b64_tr_b16 v[166:167], v22 offset:21504
    v_lshrrev_b32_e64 v61, 4, v0
    s_add_u32 s61, s61, 139776
    v_mfma_f32_32x32x16_bf16 v[112:127], v[132:135], v[140:143], v[112:127]
    ds_read_b128 v[168:171], v244 offset:0
    buffer_load_dwordx4 v17, s[40:43], s83 offen offset:3072 lds
    v_mul_u32_u24 v60, 160, v60
    s_mul_i32 s56, s3, 2560
    v_mfma_f32_32x32x16_bf16 v[96:111], v[132:135], v[136:139], v[96:111]
    ds_read_b128 v[172:175], v244 offset:4096
    v_lshl_add_u32 v215, v61, 4, v60
    s_add_u32 s53, s56, 152064
    s_waitcnt lgkmcnt(6)
    s_nop 0
    v_mfma_f32_32x32x16_bf16 v[64:79], v[144:147], v[152:155], v[64:79]
    ds_read_b64_tr_b16 v[128:129], v19 offset:24576
    ds_read_b64_tr_b16 v[130:131], v19 offset:25600
    buffer_load_dwordx4 a[0:3], v1, s[44:47], s90 offen sc1
    v_lshl_add_u32 v222, v61, 3, v60
    v_bfe_u32 v60, v0, 2, 2
    v_mfma_f32_32x32x16_bf16 v[80:95], v[144:147], v[156:159], v[80:95]
    ds_read_b64_tr_b16 v[132:133], v22 offset:24576
    ds_read_b64_tr_b16 v[134:135], v22 offset:25600
    v_add_u32 v215, s61, v215
    v_add_u32 v222, s53, v222
    v_mfma_f32_32x32x16_bf16 v[112:127], v[148:151], v[156:159], v[112:127]
    ds_read_b128 v[136:139], v247 offset:0
    buffer_load_dwordx4 a[4:7], v1, s[44:47], s90 offen offset:1024 sc1
    v_lshl_add_u32 v63, v61, 3, v60
    s_lshl_b32 s56, s3, 5
    v_mfma_f32_32x32x16_bf16 v[96:111], v[148:151], v[152:155], v[96:111]
    ds_read_b128 v[140:143], v247 offset:4096
    v_mul_u32_u24 v63, 160, v63
    s_waitcnt lgkmcnt(6)
    v_mfma_f32_32x32x16_bf16 v[64:79], v[160:163], v[168:171], v[64:79]
    ds_read_b64_tr_b16 v[144:145], v19 offset:28672
    ds_read_b64_tr_b16 v[146:147], v19 offset:29696
    buffer_load_dwordx4 a[8:11], v1, s[44:47], s90 offen offset:2048 sc1
    s_add_u32 s56, s56, 126976
    v_lshl_add_u32 v63, v62, 3, v63
    v_mfma_f32_32x32x16_bf16 v[80:95], v[160:163], v[172:175], v[80:95]
    ds_read_b64_tr_b16 v[148:149], v22 offset:28672
    ds_read_b64_tr_b16 v[150:151], v22 offset:29696
    v_lshrrev_b32 v60, 5, v0
    v_add_u32 v216, s56, v63
    v_mfma_f32_32x32x16_bf16 v[112:127], v[164:167], v[172:175], v[112:127]
    ds_read_b128 v[152:155], v250 offset:0
    buffer_load_dwordx4 a[12:15], v1, s[44:47], s90 offen offset:3072 sc1
    v_mul_u32_u24 v60, 2560, v60
    s_lshl_b32 s56, s86, 2
    v_mfma_f32_32x32x16_bf16 v[96:111], v[164:167], v[168:171], v[96:111]
    ds_read_b128 v[156:159], v250 offset:4096
    v_sub_u32 v217, v216, v60
    s_add_u32 s56, s56, s3
    s_waitcnt lgkmcnt(6)
    v_mfma_f32_32x32x16_bf16 v[64:79], v[128:131], v[136:139], v[64:79]
    s_waitcnt vmcnt(12)
    s_barrier
    ds_read_b64_tr_b16 v[160:161], v19 offset:49152
    ds_read_b64_tr_b16 v[162:163], v19 offset:50176
    buffer_load_dwordx4 a[16:19], v2, s[44:47], s90 offen sc1
    v_lshlrev_b32 v226, 4, v62
    s_lshl_b32 s28, s56, 12
    v_bfe_u32 v60, v0, 2, 3
    s_lshl_b32 s29, s56, 7
    v_lshl_add_u32 v226, v60, 7, v226
    s_add_u32 s28, s28, 2752512
    v_lshrrev_b32 v60, 5, v0
    s_add_u32 s29, s29, 14811136
    v_lshl_add_u32 v226, v60, 6, v226
    s_sub_u32 s56, s3, 1
    s_and_b32 s56, s56, 3
    s_mul_i32 s56, s56, 15360
    s_add_u32 s56, s56, 65536
    v_add_u32_e64 v219, s56, v1
    s_sub_u32 s56, s3, 2
    s_and_b32 s56, s56, 3
    s_mul_i32 s56, s56, 15360
    s_add_u32 s56, s56, 70656
    v_add_u32_e64 v220, s56, v1
    s_sub_u32 s56, s3, 3
    s_and_b32 s56, s56, 3
    s_mul_i32 s56, s56, 15360
    s_add_u32 s56, s56, 75776
    v_add_u32_e64 v221, s56, v1
    v_mfma_f32_32x32x16_bf16 v[80:95], v[128:131], v[140:143], v[80:95]
    ds_read_b64_tr_b16 v[164:165], v22 offset:49152
    ds_read_b64_tr_b16 v[166:167], v22 offset:50176
    v_cmp_eq_u32 s[54:55], 0, v0
    v_mov_b32_e64 v60, 0
    v_mfma_f32_32x32x16_bf16 v[112:127], v[132:135], v[140:143], v[112:127]
    ds_read_b128 v[168:171], v241 offset:32768
    v_mov_b32_e64 v61, 0
    v_cndmask_b32 v39, 0, v39, s[54:55]
    v_mov_b32_e64 v62, 0
    v_mfma_f32_32x32x16_bf16 v[96:111], v[132:135], v[136:139], v[96:111]
    ds_read_b128 v[172:175], v241 offset:36864
    s_add_u32 s92, s90, 20480
    buffer_load_dwordx4 a[20:23], v1, s[44:47], s92 offen sc1
    v_add_f32_e64 v26, v26, v39
    v_mov_b32 v63, 0
    s_waitcnt lgkmcnt(6)
    v_mfma_f32_32x32x16_bf16 v[64:79], v[144:147], v[152:155], v[64:79]
    ds_read_b64_tr_b16 v[128:129], v19 offset:53248
    ds_read_b64_tr_b16 v[130:131], v19 offset:54272
    ds_write_b128 v47, v[60:63]
    v_cvt_pk_bf16_f32 v54, v26, v27
    v_cvt_pk_bf16_f32 v55, v28, v29
    v_mfma_f32_32x32x16_bf16 v[80:95], v[144:147], v[156:159], v[80:95]
    ds_read_b64_tr_b16 v[132:133], v22 offset:53248
    ds_read_b64_tr_b16 v[134:135], v22 offset:54272
    buffer_load_dwordx4 a[24:27], v1, s[44:47], s92 offen offset:1024 sc1
    v_cvt_pk_bf16_f32 v56, v30, v31
    v_cvt_pk_bf16_f32 v57, v32, v33
    v_cvt_pk_bf16_f32 v58, v34, v35
    v_mfma_f32_32x32x16_bf16 v[112:127], v[148:151], v[156:159], v[112:127]
    ds_read_b128 v[136:139], v244 offset:32768
    buffer_load_dwordx4 v[184:187], v4, s[44:47], s82 offen sc1
    v_cvt_pk_bf16_f32 v59, v36, v37
    ds_write_b128 v44, v[60:63]
    v_mfma_f32_32x32x16_bf16 v[96:111], v[148:151], v[152:155], v[96:111]
    ds_read_b128 v[140:143], v244 offset:36864
    buffer_load_dwordx4 a[28:31], v1, s[44:47], s92 offen offset:2048 sc1
    ds_write_b64 v40, v[54:55] offset:16
    ds_write_b16 v48, v56
    ds_write_b16_d16_hi v41, v56 offset:2
    s_waitcnt lgkmcnt(11)
    s_nop 0
    v_mfma_f32_32x32x16_bf16 v[64:79], v[160:163], v[168:171], v[64:79]
    ds_read_b64_tr_b16 v[144:145], v19 offset:57344
    ds_read_b64_tr_b16 v[146:147], v19 offset:58368
    ds_write_b16 v42, v57
    ds_write_b16_d16_hi v42, v57 offset:2
    v_mfma_f32_32x32x16_bf16 v[80:95], v[160:163], v[172:175], v[80:95]
    ds_read_b64_tr_b16 v[148:149], v22 offset:57344
    ds_read_b64_tr_b16 v[150:151], v22 offset:58368
    buffer_load_dwordx4 a[32:35], v1, s[44:47], s92 offen offset:3072 sc1
    buffer_load_dwordx4 v[188:191], v4, s[44:47], s82 offen offset:512 sc1
    ds_read_b64 v[8:9], v45
    ds_read_b64 v[10:11], v45 offset:8
    ds_read_u16 v12, v46
    v_mfma_f32_32x32x16_bf16 v[112:127], v[164:167], v[172:175], v[112:127]
    ds_read_b128 v[152:155], v247 offset:32768
    ds_read_u16 v13, v44 offset:784
    ds_write_b16 v53, v58
    ds_write_b16_d16_hi v43, v58 offset:32
    v_mfma_f32_32x32x16_bf16 v[96:111], v[164:167], v[168:171], v[96:111]
    ds_read_b128 v[156:159], v247 offset:36864
    buffer_load_dwordx4 a[36:39], v2, s[44:47], s92 offen sc1
    ds_write_b16 v43, v59 offset:64
    ds_write_b16_d16_hi v43, v59 offset:96
    s_waitcnt lgkmcnt(15)
    s_nop 0
    v_mfma_f32_32x32x16_bf16 v[64:79], v[128:131], v[136:139], v[64:79]
    ds_read_b64_tr_b16 v[160:161], v19 offset:61440
    ds_read_b64_tr_b16 v[162:163], v19 offset:62464
    buffer_load_dwordx4 v[176:179], v5, s[44:47], s80 offen sc1
    ds_write_b128 v52, v[60:63]
    s_waitcnt lgkmcnt(8)
    s_nop 0
    v_perm_b32 v28, v11, v11, s98
    v_perm_b32 v29, v10, v10, s98
    v_mfma_f32_32x32x16_bf16 v[80:95], v[128:131], v[140:143], v[80:95]
    ds_read_b64_tr_b16 v[164:165], v22 offset:61440
    ds_read_b64_tr_b16 v[166:167], v22 offset:62464
    v_perm_b32 v30, v9, v9, s98
    v_perm_b32 v31, v8, v8, s98
    v_mfma_f32_32x32x16_bf16 v[112:127], v[132:135], v[140:143], v[112:127]
    ds_read_b128 v[168:171], v250 offset:32768
    s_add_u32 s92, s90, 40960
    buffer_load_dwordx4 a[40:43], v1, s[44:47], s92 offen sc1
    v_perm_b32 v32, v11, v10, s99
    v_perm_b32 v33, v10, v9, s99
    v_perm_b32 v34, v9, v8, s99
    v_mfma_f32_32x32x16_bf16 v[96:111], v[132:135], v[136:139], v[96:111]
    ds_read_b128 v[172:175], v250 offset:36864
    buffer_load_dwordx4 v[180:183], v5, s[44:47], s80 offen offset:512 sc1
    v_perm_b32 v35, v8, v12, s52
    s_mov_b32 exec_lo, 0
    v_perm_b32 v28, v10, v9, s99
    v_perm_b32 v29, v9, v9, s100
    v_perm_b32 v30, v9, v8, s99
    v_perm_b32 v31, v8, v8, s100
    s_mov_b64 exec, -1
    s_waitcnt lgkmcnt(9)
    v_mfma_f32_32x32x16_bf16 v[64:79], v[144:147], v[152:155], v[64:79]
    s_waitcnt vmcnt(15)
    s_barrier
    s_nop 0
    ds_read_b64_tr_b16 v[128:129], v20 offset:16384
    ds_read_b64_tr_b16 v[130:131], v20 offset:17408
    buffer_load_dwordx4 a[44:47], v1, s[44:47], s92 offen offset:1024 sc1
    v_mfma_f32_32x32x16_bf16 v[80:95], v[144:147], v[156:159], v[80:95]
    ds_read_b64_tr_b16 v[132:133], v23 offset:16384
    ds_read_b64_tr_b16 v[134:135], v23 offset:17408
    ds_write_b128 v49, v[28:31]
    v_mfma_f32_32x32x16_bf16 v[112:127], v[148:151], v[156:159], v[112:127]
    ds_read_b128 v[136:139], v242 offset:0
    buffer_load_dwordx4 a[48:51], v1, s[44:47], s92 offen offset:2048 sc1
    s_mov_b32 exec_lo, 0
    v_perm_b32 v32, v9, v9, s98
    v_perm_b32 v33, v9, v9, s100
    v_perm_b32 v34, v8, v8, s98
    s_mov_b64 exec, -1
    v_mfma_f32_32x32x16_bf16 v[96:111], v[148:151], v[152:155], v[96:111]
    ds_read_b128 v[140:143], v242 offset:4096
    s_waitcnt lgkmcnt(7)
    s_nop 0
    v_mfma_f32_32x32x16_bf16 v[64:79], v[160:163], v[168:171], v[64:79]
    ds_read_b64_tr_b16 v[144:145], v20 offset:20480
    ds_read_b64_tr_b16 v[146:147], v20 offset:21504
    buffer_load_dwordx4 a[52:55], v1, s[44:47], s92 offen offset:3072 sc1
    ds_write_b128 v49, v[32:35] offset:1216
    v_perm_b32 v14, v13, v13, s100
    v_lshlrev_b32_e64 v13, 16, v13
    v_mfma_f32_32x32x16_bf16 v[80:95], v[160:163], v[172:175], v[80:95]
    ds_read_b64_tr_b16 v[148:149], v23 offset:20480
    ds_read_b64_tr_b16 v[150:151], v23 offset:21504
    v_cmp_gt_u32 s[54:55], 2, v0
    s_nop 1
    s_nop 0
    v_cndmask_b32 v63, 0, v14, s[54:55]
    v_mfma_f32_32x32x16_bf16 v[112:127], v[164:167], v[172:175], v[112:127]
    ds_read_b128 v[152:155], v245 offset:0
    buffer_load_dwordx4 a[56:59], v2, s[44:47], s92 offen sc1
    v_cmp_eq_u32 s[54:55], 0, v0
    s_nop 1
    v_cndmask_b32 v62, v63, v13, s[54:55]
    ds_write_b128 v50, v[60:63]
    v_mfma_f32_32x32x16_bf16 v[96:111], v[164:167], v[168:171], v[96:111]
    ds_read_b128 v[156:159], v245 offset:4096
    s_waitcnt lgkmcnt(8)
    v_mfma_f32_32x32x16_bf16 v[64:79], v[128:131], v[136:139], v[64:79]
    ds_read_b64_tr_b16 v[160:161], v20 offset:24576
    ds_read_b64_tr_b16 v[162:163], v20 offset:25600
    s_add_u32 s92, s90, 61440
    buffer_load_dwordx4 a[60:63], v1, s[44:47], s92 offen sc1
    v_mfma_f32_32x32x16_bf16 v[80:95], v[128:131], v[140:143], v[80:95]
    ds_read_b64_tr_b16 v[164:165], v23 offset:24576
    ds_read_b64_tr_b16 v[166:167], v23 offset:25600
    v_mfma_f32_32x32x16_bf16 v[112:127], v[132:135], v[140:143], v[112:127]
    ds_read_b128 v[168:171], v248 offset:0
    v_mfma_f32_32x32x16_bf16 v[96:111], v[132:135], v[136:139], v[96:111]
    ds_read_b128 v[172:175], v248 offset:4096
    buffer_load_dwordx4 a[64:67], v1, s[44:47], s92 offen offset:1024 sc1
    s_waitcnt lgkmcnt(6)
    v_mfma_f32_32x32x16_bf16 v[64:79], v[144:147], v[152:155], v[64:79]
    ds_read_b64_tr_b16 v[128:129], v20 offset:28672
    ds_read_b64_tr_b16 v[130:131], v20 offset:29696
    s_waitcnt vmcnt(6)
    v_cmp_eq_u32_e64 vcc, s76, v179
    v_cmp_eq_u32 s[56:57], s76, v183
    s_nop 0
    s_and_b32 vcc_lo, vcc_lo, s56
    s_mov_b32 vcc_hi, -1
    v_cmp_eq_u32 s[56:57], s76, v185
    s_nop 0
    s_and_b64 vcc, vcc, s[56:57]
    v_cmp_eq_u32 s[56:57], s76, v189
    s_nop 0
    s_and_b64 vcc, vcc, s[56:57]
    s_cmp_eq_u64 vcc, -1
    s_cbranch_scc1 Lok_6
    s_mov_b32 s96, 0
Lsp_7:
    s_sleep 2
    buffer_load_dwordx4 v[184:187], v4, s[44:47], s82 offen sc1
    buffer_load_dwordx4 v[188:191], v4, s[44:47], s82 offen offset:512 sc1
    buffer_load_dwordx4 v[176:179], v5, s[44:47], s80 offen sc1
    buffer_load_dwordx4 v[180:183], v5, s[44:47], s80 offen offset:512 sc1
    s_waitcnt vmcnt(0)
    v_cmp_eq_u32_e64 vcc, s76, v179
    v_cmp_eq_u32 s[56:57], s76, v183
    s_nop 0
    s_and_b32 vcc_lo, vcc_lo, s56
    s_mov_b32 vcc_hi, -1
    v_cmp_eq_u32 s[56:57], s76, v185
    s_nop 0
    s_and_b64 vcc, vcc, s[56:57]
    v_cmp_eq_u32 s[56:57], s76, v189
    s_nop 0
    s_and_b64 vcc, vcc, s[56:57]
    s_cmp_eq_u64 vcc, -1
    s_cbranch_scc1 Lok_6
    s_add_u32 s96, s96, 1
    s_cmp_lt_u32 s96, 20000
    s_cbranch_scc1 Lsp_7
Lok_6:
    v_mov_b32 v179, 0
    v_mov_b32_e64 v183, 0
    v_mul_f32 v192, 0xc0135761, v187
    v_mul_f32 v194, v187, v187
    v_lshlrev_b32 v196, 16, v186
    v_and_b32 v197, 0xffff0000, v186
    v_mul_f32 v194, v194, v192
    v_add_f32 v196, v196, v197
    v_mul_f32 v194, 0x3d372713, v194
    v_mov_b32 v187, 0
    v_mov_b32 v185, v184
    v_mul_f32 v198, 0xc0135761, v191
    v_mul_f32 v200, v191, v191
    v_lshlrev_b32 v202, 16, v190
    v_and_b32 v203, 0xffff0000, v190
    v_mul_f32 v200, v200, v198
    v_add_f32 v202, v202, v203
    v_mul_f32 v200, 0x3d372713, v200
    v_mov_b32 v191, 0
    v_mov_b32 v189, v188
    v_mfma_f32_32x32x16_bf16 v[80:95], v[144:147], v[156:159], v[80:95]
    ds_read_b64_tr_b16 v[132:133], v23 offset:28672
    ds_read_b64_tr_b16 v[134:135], v23 offset:29696
    buffer_load_dwordx4 a[68:71], v1, s[44:47], s92 offen offset:2048 sc1
    v_mfma_f32_32x32x16_bf16 v[112:127], v[148:151], v[156:159], v[112:127]
    ds_read_b128 v[136:139], v251 offset:0
    v_mfma_f32_32x32x16_bf16 v[96:111], v[148:151], v[152:155], v[96:111]
    ds_read_b128 v[140:143], v251 offset:4096
    buffer_load_dwordx4 a[72:75], v1, s[44:47], s92 offen offset:3072 sc1
    v_mfma_f32_32x32x16_bf16 v[64:79], v[176:179], v[184:187], v[64:79]
    s_waitcnt lgkmcnt(6)
    s_nop 0
    v_mfma_f32_32x32x16_bf16 v[64:79], v[160:163], v[168:171], v[64:79]
    s_mov_b32 s79, 4096
    v_min_u32 v224, 31, v0
    v_lshlrev_b32 v224, 7, v224
    buffer_load_dword v224, v224, s[44:47], s79 offen sc1
    v_mfma_f32_32x32x16_bf16 v[80:95], v[176:179], v[188:191], v[80:95]
    v_mfma_f32_32x32x16_bf16 v[80:95], v[160:163], v[172:175], v[80:95]
    buffer_load_dwordx4 a[76:79], v2, s[44:47], s92 offen sc1
    v_mfma_f32_32x32x16_bf16 v[96:111], v[180:183], v[184:187], v[96:111]
    v_mfma_f32_32x32x16_bf16 v[112:127], v[164:167], v[172:175], v[112:127]
    v_mfma_f32_32x32x16_bf16 v[112:127], v[180:183], v[188:191], v[112:127]
    v_mfma_f32_32x32x16_bf16 v[96:111], v[164:167], v[168:171], v[96:111]
    s_add_u32 s92, s90, 81920
    buffer_load_dwordx4 a[80:83], v1, s[44:47], s92 offen sc1
    s_waitcnt lgkmcnt(0)
    v_mfma_f32_32x32x16_bf16 v[64:79], v[128:131], v[136:139], v[64:79]
    v_mfma_f32_32x32x16_bf16 v[80:95], v[128:131], v[140:143], v[80:95]
    v_mfma_f32_32x32x16_bf16 v[112:127], v[132:135], v[140:143], v[112:127]
    v_mfma_f32_32x32x16_bf16 v[96:111], v[132:135], v[136:139], v[96:111]
    s_cmp_eq_u32 s93, 0
    s_cbranch_scc1 L_gc
    s_nop 6
    v_pk_mul_f32 v[160:161], v[64:65], v[64:65]
    v_pk_mul_f32 v[162:163], v[66:67], v[66:67]
    v_pk_mul_f32 v[164:165], v[68:69], v[68:69]
    v_pk_mul_f32 v[166:167], v[70:71], v[70:71]
    v_pk_fma_f32 v[160:161], v[160:161], v[194:195], v[192:193] op_sel_hi:[1,0,0]
    v_pk_fma_f32 v[162:163], v[162:163], v[194:195], v[192:193] op_sel_hi:[1,0,0]
    v_pk_fma_f32 v[164:165], v[164:165], v[194:195], v[192:193] op_sel_hi:[1,0,0]
    v_pk_fma_f32 v[166:167], v[166:167], v[194:195], v[192:193] op_sel_hi:[1,0,0]
    v_pk_mul_f32 v[160:161], v[160:161], v[64:65]
    v_pk_mul_f32 v[162:163], v[162:163], v[66:67]
    v_pk_mul_f32 v[164:165], v[164:165], v[68:69]
    v_pk_mul_f32 v[166:167], v[166:167], v[70:71]
    v_exp_f32 v160, v160
    v_exp_f32 v161, v161
    v_exp_f32 v162, v162
    v_exp_f32 v163, v163
    v_exp_f32 v164, v164
    v_exp_f32 v165, v165
    v_exp_f32 v166, v166
    v_exp_f32 v167, v167
    v_pk_fma_f32 v[160:161], v[160:161], v[196:197], v[196:197] op_sel_hi:[1,0,0]
    v_pk_fma_f32 v[162:163], v[162:163], v[196:197], v[196:197] op_sel_hi:[1,0,0]
    v_pk_fma_f32 v[164:165], v[164:165], v[196:197], v[196:197] op_sel_hi:[1,0,0]
    v_pk_fma_f32 v[166:167], v[166:167], v[196:197], v[196:197] op_sel_hi:[1,0,0]
    v_rcp_f32 v160, v160
    v_rcp_f32 v161, v161
    v_rcp_f32 v162, v162
    v_rcp_f32 v163, v163
    v_rcp_f32 v164, v164
    v_rcp_f32 v165, v165
    v_rcp_f32 v166, v166
    v_rcp_f32 v167, v167
    v_pk_mul_f32 v[160:161], v[160:161], v[64:65]
    v_pk_mul_f32 v[162:163], v[162:163], v[66:67]
    v_pk_mul_f32 v[164:165], v[164:165], v[68:69]
    v_pk_mul_f32 v[166:167], v[166:167], v[70:71]
    v_cvt_pk_bf16_f32 v128, v160, v161
    v_cvt_pk_bf16_f32 v129, v162, v163
    v_cvt_pk_bf16_f32 v130, v164, v165
    v_cvt_pk_bf16_f32 v131, v166, v167
    buffer_store_dwordx4 v[128:131], v3, s[44:47], s84 offen sc1
    s_add_u32 s92, s90, 81920
    buffer_load_dwordx4 a[84:87], v1, s[44:47], s92 offen offset:1024 sc1
    v_pk_mul_f32 v[160:161], v[72:73], v[72:73]
    v_pk_mul_f32 v[162:163], v[74:75], v[74:75]
    v_pk_mul_f32 v[164:165], v[76:77], v[76:77]
    v_pk_mul_f32 v[166:167], v[78:79], v[78:79]
    v_pk_fma_f32 v[160:161], v[160:161], v[194:195], v[192:193] op_sel_hi:[1,0,0]
    v_pk_fma_f32 v[162:163], v[162:163], v[194:195], v[192:193] op_sel_hi:[1,0,0]
    v_pk_fma_f32 v[164:165], v[164:165], v[194:195], v[192:193] op_sel_hi:[1,0,0]
    v_pk_fma_f32 v[166:167], v[166:167], v[194:195], v[192:193] op_sel_hi:[1,0,0]
    v_pk_mul_f32 v[160:161], v[160:161], v[72:73]
    v_pk_mul_f32 v[162:163], v[162:163], v[74:75]
    v_pk_mul_f32 v[164:165], v[164:165], v[76:77]
    v_pk_mul_f32 v[166:167], v[166:167], v[78:79]
    v_exp_f32 v160, v160
    v_exp_f32 v161, v161
    v_exp_f32 v162, v162
    v_exp_f32 v163, v163
    v_exp_f32 v164, v164
    v_exp_f32 v165, v165
    v_exp_f32 v166, v166
    v_exp_f32 v167, v167
    v_pk_fma_f32 v[160:161], v[160:161], v[196:197], v[196:197] op_sel_hi:[1,0,0]
    v_pk_fma_f32 v[162:163], v[162:163], v[196:197], v[196:197] op_sel_hi:[1,0,0]
    v_pk_fma_f32 v[164:165], v[164:165], v[196:197], v[196:197] op_sel_hi:[1,0,0]
    v_pk_fma_f32 v[166:167], v[166:167], v[196:197], v[196:197] op_sel_hi:[1,0,0]
    v_rcp_f32 v160, v160
    v_rcp_f32 v161, v161
    v_rcp_f32 v162, v162
    v_rcp_f32 v163, v163
    v_rcp_f32 v164, v164
    v_rcp_f32 v165, v165
    v_rcp_f32 v166, v166
    v_rcp_f32 v167, v167
    v_pk_mul_f32 v[160:161], v[160:161], v[72:73]
    v_pk_mul_f32 v[162:163], v[162:163], v[74:75]
    v_pk_mul_f32 v[164:165], v[164:165], v[76:77]
    v_pk_mul_f32 v[166:167], v[166:167], v[78:79]
    v_cvt_pk_bf16_f32 v132, v160, v161
    v_cvt_pk_bf16_f32 v133, v162, v163
    v_cvt_pk_bf16_f32 v134, v164, v165
    v_cvt_pk_bf16_f32 v135, v166, v167
    buffer_store_dwordx4 v[132:135], v3, s[44:47], s84 offen offset:512 sc1
    v_pk_mul_f32 v[160:161], v[80:81], v[80:81]
    v_pk_mul_f32 v[162:163], v[82:83], v[82:83]
    v_pk_mul_f32 v[164:165], v[84:85], v[84:85]
    v_pk_mul_f32 v[166:167], v[86:87], v[86:87]
    v_pk_fma_f32 v[160:161], v[160:161], v[200:201], v[198:199] op_sel_hi:[1,0,0]
    v_pk_fma_f32 v[162:163], v[162:163], v[200:201], v[198:199] op_sel_hi:[1,0,0]
    v_pk_fma_f32 v[164:165], v[164:165], v[200:201], v[198:199] op_sel_hi:[1,0,0]
    v_pk_fma_f32 v[166:167], v[166:167], v[200:201], v[198:199] op_sel_hi:[1,0,0]
    v_pk_mul_f32 v[160:161], v[160:161], v[80:81]
    v_pk_mul_f32 v[162:163], v[162:163], v[82:83]
    v_pk_mul_f32 v[164:165], v[164:165], v[84:85]
    v_pk_mul_f32 v[166:167], v[166:167], v[86:87]
    v_exp_f32 v160, v160
    v_exp_f32 v161, v161
    v_exp_f32 v162, v162
    v_exp_f32 v163, v163
    v_exp_f32 v164, v164
    v_exp_f32 v165, v165
    v_exp_f32 v166, v166
    v_exp_f32 v167, v167
    v_pk_fma_f32 v[160:161], v[160:161], v[202:203], v[202:203] op_sel_hi:[1,0,0]
    v_pk_fma_f32 v[162:163], v[162:163], v[202:203], v[202:203] op_sel_hi:[1,0,0]
    v_pk_fma_f32 v[164:165], v[164:165], v[202:203], v[202:203] op_sel_hi:[1,0,0]
    v_pk_fma_f32 v[166:167], v[166:167], v[202:203], v[202:203] op_sel_hi:[1,0,0]
    v_rcp_f32 v160, v160
    v_rcp_f32 v161, v161
    v_rcp_f32 v162, v162
    v_rcp_f32 v163, v163
    v_rcp_f32 v164, v164
    v_rcp_f32 v165, v165
    v_rcp_f32 v166, v166
    v_rcp_f32 v167, v167
    v_pk_mul_f32 v[160:161], v[160:161], v[80:81]
    v_pk_mul_f32 v[162:163], v[162:163], v[82:83]
    v_pk_mul_f32 v[164:165], v[164:165], v[84:85]
    v_pk_mul_f32 v[166:167], v[166:167], v[86:87]
    v_cvt_pk_bf16_f32 v136, v160, v161
    v_cvt_pk_bf16_f32 v137, v162, v163
    v_cvt_pk_bf16_f32 v138, v164, v165
    v_cvt_pk_bf16_f32 v139, v166, v167
    buffer_store_dwordx4 v[136:139], v3, s[44:47], s85 offen sc1
    buffer_load_dwordx4 a[88:91], v1, s[44:47], s92 offen offset:2048 sc1
    v_pk_mul_f32 v[160:161], v[88:89], v[88:89]
    v_pk_mul_f32 v[162:163], v[90:91], v[90:91]
    v_pk_mul_f32 v[164:165], v[92:93], v[92:93]
    v_pk_mul_f32 v[166:167], v[94:95], v[94:95]
    v_pk_fma_f32 v[160:161], v[160:161], v[200:201], v[198:199] op_sel_hi:[1,0,0]
    v_pk_fma_f32 v[162:163], v[162:163], v[200:201], v[198:199] op_sel_hi:[1,0,0]
    v_pk_fma_f32 v[164:165], v[164:165], v[200:201], v[198:199] op_sel_hi:[1,0,0]
    v_pk_fma_f32 v[166:167], v[166:167], v[200:201], v[198:199] op_sel_hi:[1,0,0]
    v_pk_mul_f32 v[160:161], v[160:161], v[88:89]
    v_pk_mul_f32 v[162:163], v[162:163], v[90:91]
    v_pk_mul_f32 v[164:165], v[164:165], v[92:93]
    v_pk_mul_f32 v[166:167], v[166:167], v[94:95]
    v_exp_f32 v160, v160
    v_exp_f32 v161, v161
    v_exp_f32 v162, v162
    v_exp_f32 v163, v163
    v_exp_f32 v164, v164
    v_exp_f32 v165, v165
    v_exp_f32 v166, v166
    v_exp_f32 v167, v167
    v_pk_fma_f32 v[160:161], v[160:161], v[202:203], v[202:203] op_sel_hi:[1,0,0]
    v_pk_fma_f32 v[162:163], v[162:163], v[202:203], v[202:203] op_sel_hi:[1,0,0]
    v_pk_fma_f32 v[164:165], v[164:165], v[202:203], v[202:203] op_sel_hi:[1,0,0]
    v_pk_fma_f32 v[166:167], v[166:167], v[202:203], v[202:203] op_sel_hi:[1,0,0]
    v_rcp_f32 v160, v160
    v_rcp_f32 v161, v161
    v_rcp_f32 v162, v162
    v_rcp_f32 v163, v163
    v_rcp_f32 v164, v164
    v_rcp_f32 v165, v165
    v_rcp_f32 v166, v166
    v_rcp_f32 v167, v167
    v_pk_mul_f32 v[160:161], v[160:161], v[88:89]
    v_pk_mul_f32 v[162:163], v[162:163], v[90:91]
    v_pk_mul_f32 v[164:165], v[164:165], v[92:93]
    v_pk_mul_f32 v[166:167], v[166:167], v[94:95]
    v_cvt_pk_bf16_f32 v140, v160, v161
    v_cvt_pk_bf16_f32 v141, v162, v163
    v_cvt_pk_bf16_f32 v142, v164, v165
    v_cvt_pk_bf16_f32 v143, v166, v167
    buffer_store_dwordx4 v[140:143], v3, s[44:47], s85 offen offset:512 sc1
    v_pk_mul_f32 v[160:161], v[96:97], v[96:97]
    v_pk_mul_f32 v[162:163], v[98:99], v[98:99]
    v_pk_mul_f32 v[164:165], v[100:101], v[100:101]
    v_pk_mul_f32 v[166:167], v[102:103], v[102:103]
    v_pk_fma_f32 v[160:161], v[160:161], v[194:195], v[192:193] op_sel_hi:[1,0,0]
    v_pk_fma_f32 v[162:163], v[162:163], v[194:195], v[192:193] op_sel_hi:[1,0,0]
    v_pk_fma_f32 v[164:165], v[164:165], v[194:195], v[192:193] op_sel_hi:[1,0,0]
    v_pk_fma_f32 v[166:167], v[166:167], v[194:195], v[192:193] op_sel_hi:[1,0,0]
    v_pk_mul_f32 v[160:161], v[160:161], v[96:97]
    v_pk_mul_f32 v[162:163], v[162:163], v[98:99]
    v_pk_mul_f32 v[164:165], v[164:165], v[100:101]
    v_pk_mul_f32 v[166:167], v[166:167], v[102:103]
    v_exp_f32 v160, v160
    v_exp_f32 v161, v161
    v_exp_f32 v162, v162
    v_exp_f32 v163, v163
    v_exp_f32 v164, v164
    v_exp_f32 v165, v165
    v_exp_f32 v166, v166
    v_exp_f32 v167, v167
    v_pk_fma_f32 v[160:161], v[160:161], v[196:197], v[196:197] op_sel_hi:[1,0,0]
    v_pk_fma_f32 v[162:163], v[162:163], v[196:197], v[196:197] op_sel_hi:[1,0,0]
    v_pk_fma_f32 v[164:165], v[164:165], v[196:197], v[196:197] op_sel_hi:[1,0,0]
    v_pk_fma_f32 v[166:167], v[166:167], v[196:197], v[196:197] op_sel_hi:[1,0,0]
    v_rcp_f32 v160, v160
    v_rcp_f32 v161, v161
    v_rcp_f32 v162, v162
    v_rcp_f32 v163, v163
    v_rcp_f32 v164, v164
    v_rcp_f32 v165, v165
    v_rcp_f32 v166, v166
    v_rcp_f32 v167, v167
    v_pk_mul_f32 v[160:161], v[160:161], v[96:97]
    v_pk_mul_f32 v[162:163], v[162:163], v[98:99]
    v_pk_mul_f32 v[164:165], v[164:165], v[100:101]
    v_pk_mul_f32 v[166:167], v[166:167], v[102:103]
    v_cvt_pk_bf16_f32 v144, v160, v161
    v_cvt_pk_bf16_f32 v145, v162, v163
    v_cvt_pk_bf16_f32 v146, v164, v165
    v_cvt_pk_bf16_f32 v147, v166, v167
    buffer_store_dwordx4 v[144:147], v3, s[44:47], s84 offen offset:1024 sc1
    buffer_load_dwordx4 a[92:95], v1, s[44:47], s92 offen offset:3072 sc1
    v_pk_mul_f32 v[160:161], v[104:105], v[104:105]
    v_pk_mul_f32 v[162:163], v[106:107], v[106:107]
    v_pk_mul_f32 v[164:165], v[108:109], v[108:109]
    v_pk_mul_f32 v[166:167], v[110:111], v[110:111]
    v_pk_fma_f32 v[160:161], v[160:161], v[194:195], v[192:193] op_sel_hi:[1,0,0]
    v_pk_fma_f32 v[162:163], v[162:163], v[194:195], v[192:193] op_sel_hi:[1,0,0]
    v_pk_fma_f32 v[164:165], v[164:165], v[194:195], v[192:193] op_sel_hi:[1,0,0]
    v_pk_fma_f32 v[166:167], v[166:167], v[194:195], v[192:193] op_sel_hi:[1,0,0]
    v_pk_mul_f32 v[160:161], v[160:161], v[104:105]
    v_pk_mul_f32 v[162:163], v[162:163], v[106:107]
    v_pk_mul_f32 v[164:165], v[164:165], v[108:109]
    v_pk_mul_f32 v[166:167], v[166:167], v[110:111]
    v_exp_f32 v160, v160
    v_exp_f32 v161, v161
    v_exp_f32 v162, v162
    v_exp_f32 v163, v163
    v_exp_f32 v164, v164
    v_exp_f32 v165, v165
    v_exp_f32 v166, v166
    v_exp_f32 v167, v167
    v_pk_fma_f32 v[160:161], v[160:161], v[196:197], v[196:197] op_sel_hi:[1,0,0]
    v_pk_fma_f32 v[162:163], v[162:163], v[196:197], v[196:197] op_sel_hi:[1,0,0]
    v_pk_fma_f32 v[164:165], v[164:165], v[196:197], v[196:197] op_sel_hi:[1,0,0]
    v_pk_fma_f32 v[166:167], v[166:167], v[196:197], v[196:197] op_sel_hi:[1,0,0]
    v_rcp_f32 v160, v160
    v_rcp_f32 v161, v161
    v_rcp_f32 v162, v162
    v_rcp_f32 v163, v163
    v_rcp_f32 v164, v164
    v_rcp_f32 v165, v165
    v_rcp_f32 v166, v166
    v_rcp_f32 v167, v167
    v_pk_mul_f32 v[160:161], v[160:161], v[104:105]
    v_pk_mul_f32 v[162:163], v[162:163], v[106:107]
    v_pk_mul_f32 v[164:165], v[164:165], v[108:109]
    v_pk_mul_f32 v[166:167], v[166:167], v[110:111]
    v_cvt_pk_bf16_f32 v148, v160, v161
    v_cvt_pk_bf16_f32 v149, v162, v163
    v_cvt_pk_bf16_f32 v150, v164, v165
    v_cvt_pk_bf16_f32 v151, v166, v167
    buffer_store_dwordx4 v[148:151], v3, s[44:47], s84 offen offset:1536 sc1
    v_pk_mul_f32 v[160:161], v[112:113], v[112:113]
    v_pk_mul_f32 v[162:163], v[114:115], v[114:115]
    v_pk_mul_f32 v[164:165], v[116:117], v[116:117]
    v_pk_mul_f32 v[166:167], v[118:119], v[118:119]
    v_pk_fma_f32 v[160:161], v[160:161], v[200:201], v[198:199] op_sel_hi:[1,0,0]
    v_pk_fma_f32 v[162:163], v[162:163], v[200:201], v[198:199] op_sel_hi:[1,0,0]
    v_pk_fma_f32 v[164:165], v[164:165], v[200:201], v[198:199] op_sel_hi:[1,0,0]
    v_pk_fma_f32 v[166:167], v[166:167], v[200:201], v[198:199] op_sel_hi:[1,0,0]
    v_pk_mul_f32 v[160:161], v[160:161], v[112:113]
    v_pk_mul_f32 v[162:163], v[162:163], v[114:115]
    v_pk_mul_f32 v[164:165], v[164:165], v[116:117]
    v_pk_mul_f32 v[166:167], v[166:167], v[118:119]
    v_exp_f32 v160, v160
    v_exp_f32 v161, v161
    v_exp_f32 v162, v162
    v_exp_f32 v163, v163
    v_exp_f32 v164, v164
    v_exp_f32 v165, v165
    v_exp_f32 v166, v166
    v_exp_f32 v167, v167
    v_pk_fma_f32 v[160:161], v[160:161], v[202:203], v[202:203] op_sel_hi:[1,0,0]
    v_pk_fma_f32 v[162:163], v[162:163], v[202:203], v[202:203] op_sel_hi:[1,0,0]
    v_pk_fma_f32 v[164:165], v[164:165], v[202:203], v[202:203] op_sel_hi:[1,0,0]
    v_pk_fma_f32 v[166:167], v[166:167], v[202:203], v[202:203] op_sel_hi:[1,0,0]
    v_rcp_f32 v160, v160
    v_rcp_f32 v161, v161
    v_rcp_f32 v162, v162
    v_rcp_f32 v163, v163
    v_rcp_f32 v164, v164
    v_rcp_f32 v165, v165
    v_rcp_f32 v166, v166
    v_rcp_f32 v167, v167
    v_pk_mul_f32 v[160:161], v[160:161], v[112:113]
    v_pk_mul_f32 v[162:163], v[162:163], v[114:115]
    v_pk_mul_f32 v[164:165], v[164:165], v[116:117]
    v_pk_mul_f32 v[166:167], v[166:167], v[118:119]
    v_cvt_pk_bf16_f32 v152, v160, v161
    v_cvt_pk_bf16_f32 v153, v162, v163
    v_cvt_pk_bf16_f32 v154, v164, v165
    v_cvt_pk_bf16_f32 v155, v166, v167
    buffer_store_dwordx4 v[152:155], v3, s[44:47], s85 offen offset:1024 sc1
    buffer_load_dwordx4 a[96:99], v2, s[44:47], s92 offen sc1
    v_pk_mul_f32 v[160:161], v[120:121], v[120:121]
    v_pk_mul_f32 v[162:163], v[122:123], v[122:123]
    v_pk_mul_f32 v[164:165], v[124:125], v[124:125]
    v_pk_mul_f32 v[166:167], v[126:127], v[126:127]
    v_pk_fma_f32 v[160:161], v[160:161], v[200:201], v[198:199] op_sel_hi:[1,0,0]
    v_pk_fma_f32 v[162:163], v[162:163], v[200:201], v[198:199] op_sel_hi:[1,0,0]
    v_pk_fma_f32 v[164:165], v[164:165], v[200:201], v[198:199] op_sel_hi:[1,0,0]
    v_pk_fma_f32 v[166:167], v[166:167], v[200:201], v[198:199] op_sel_hi:[1,0,0]
    v_pk_mul_f32 v[160:161], v[160:161], v[120:121]
    v_pk_mul_f32 v[162:163], v[162:163], v[122:123]
    v_pk_mul_f32 v[164:165], v[164:165], v[124:125]
    v_pk_mul_f32 v[166:167], v[166:167], v[126:127]
    v_exp_f32 v160, v160
    v_exp_f32 v161, v161
    v_exp_f32 v162, v162
    v_exp_f32 v163, v163
    v_exp_f32 v164, v164
    v_exp_f32 v165, v165
    v_exp_f32 v166, v166
    v_exp_f32 v167, v167
    v_pk_fma_f32 v[160:161], v[160:161], v[202:203], v[202:203] op_sel_hi:[1,0,0]
    v_pk_fma_f32 v[162:163], v[162:163], v[202:203], v[202:203] op_sel_hi:[1,0,0]
    v_pk_fma_f32 v[164:165], v[164:165], v[202:203], v[202:203] op_sel_hi:[1,0,0]
    v_pk_fma_f32 v[166:167], v[166:167], v[202:203], v[202:203] op_sel_hi:[1,0,0]
    v_rcp_f32 v160, v160
    v_rcp_f32 v161, v161
    v_rcp_f32 v162, v162
    v_rcp_f32 v163, v163
    v_rcp_f32 v164, v164
    v_rcp_f32 v165, v165
    v_rcp_f32 v166, v166
    v_rcp_f32 v167, v167
    v_pk_mul_f32 v[160:161], v[160:161], v[120:121]
    v_pk_mul_f32 v[162:163], v[162:163], v[122:123]
    v_pk_mul_f32 v[164:165], v[164:165], v[124:125]
    v_pk_mul_f32 v[166:167], v[166:167], v[126:127]
    v_cvt_pk_bf16_f32 v156, v160, v161
    v_cvt_pk_bf16_f32 v157, v162, v163
    v_cvt_pk_bf16_f32 v158, v164, v165
    v_cvt_pk_bf16_f32 v159, v166, v167
    buffer_store_dwordx4 v[156:159], v3, s[44:47], s85 offen offset:1536 sc1
    s_branch L_skipconv
L_gc:
    s_lshl_b32 s81, s86, 14
    s_lshl_b32 s56, s3, 12
    s_add_u32 s81, s81, s56
    s_add_u32 s81, s81, 131072
    v_pk_mul_f32 v[160:161], v[64:65], v[64:65]
    v_pk_mul_f32 v[162:163], v[66:67], v[66:67]
    v_pk_mul_f32 v[164:165], v[68:69], v[68:69]
    v_pk_mul_f32 v[166:167], v[70:71], v[70:71]
    v_pk_fma_f32 v[160:161], v[160:161], v[194:195], v[192:193] op_sel_hi:[1,0,0]
    v_pk_fma_f32 v[162:163], v[162:163], v[194:195], v[192:193] op_sel_hi:[1,0,0]
    v_pk_fma_f32 v[164:165], v[164:165], v[194:195], v[192:193] op_sel_hi:[1,0,0]
    v_pk_fma_f32 v[166:167], v[166:167], v[194:195], v[192:193] op_sel_hi:[1,0,0]
    v_pk_mul_f32 v[160:161], v[160:161], v[64:65]
    v_pk_mul_f32 v[162:163], v[162:163], v[66:67]
    v_pk_mul_f32 v[164:165], v[164:165], v[68:69]
    v_pk_mul_f32 v[166:167], v[166:167], v[70:71]
    v_exp_f32 v160, v160
    v_exp_f32 v161, v161
    v_exp_f32 v162, v162
    v_exp_f32 v163, v163
    v_exp_f32 v164, v164
    v_exp_f32 v165, v165
    v_exp_f32 v166, v166
    v_exp_f32 v167, v167
    v_pk_fma_f32 v[160:161], v[160:161], v[196:197], v[196:197] op_sel_hi:[1,0,0]
    v_pk_fma_f32 v[162:163], v[162:163], v[196:197], v[196:197] op_sel_hi:[1,0,0]
    v_pk_fma_f32 v[164:165], v[164:165], v[196:197], v[196:197] op_sel_hi:[1,0,0]
    v_pk_fma_f32 v[166:167], v[166:167], v[196:197], v[196:197] op_sel_hi:[1,0,0]
    v_rcp_f32 v160, v160
    v_rcp_f32 v161, v161
    v_rcp_f32 v162, v162
    v_rcp_f32 v163, v163
    v_rcp_f32 v164, v164
    v_rcp_f32 v165, v165
    v_rcp_f32 v166, v166
    v_rcp_f32 v167, v167
    v_pk_mul_f32 v[160:161], v[160:161], v[64:65]
    v_pk_mul_f32 v[162:163], v[162:163], v[66:67]
    v_pk_mul_f32 v[164:165], v[164:165], v[68:69]
    v_pk_mul_f32 v[166:167], v[166:167], v[70:71]
    v_cvt_pk_bf16_f32 v128, v160, v161
    v_cvt_pk_bf16_f32 v129, v162, v163
    v_cvt_pk_bf16_f32 v130, v164, v165
    v_cvt_pk_bf16_f32 v131, v166, v167
    buffer_store_dwordx4 v[128:131], v3, s[44:47], s84 offen sc1
    v_pk_mul_f32 v[160:161], v[72:73], v[72:73]
    v_pk_mul_f32 v[162:163], v[74:75], v[74:75]
    v_pk_mul_f32 v[164:165], v[76:77], v[76:77]
    v_pk_mul_f32 v[166:167], v[78:79], v[78:79]
    v_pk_fma_f32 v[160:161], v[160:161], v[194:195], v[192:193] op_sel_hi:[1,0,0]
    v_pk_fma_f32 v[162:163], v[162:163], v[194:195], v[192:193] op_sel_hi:[1,0,0]
    v_pk_fma_f32 v[164:165], v[164:165], v[194:195], v[192:193] op_sel_hi:[1,0,0]
    v_pk_fma_f32 v[166:167], v[166:167], v[194:195], v[192:193] op_sel_hi:[1,0,0]
    v_pk_mul_f32 v[160:161], v[160:161], v[72:73]
    v_pk_mul_f32 v[162:163], v[162:163], v[74:75]
    v_pk_mul_f32 v[164:165], v[164:165], v[76:77]
    v_pk_mul_f32 v[166:167], v[166:167], v[78:79]
    v_exp_f32 v160, v160
    v_exp_f32 v161, v161
    v_exp_f32 v162, v162
    v_exp_f32 v163, v163
    v_exp_f32 v164, v164
    v_exp_f32 v165, v165
    v_exp_f32 v166, v166
    v_exp_f32 v167, v167
    v_pk_fma_f32 v[160:161], v[160:161], v[196:197], v[196:197] op_sel_hi:[1,0,0]
    v_pk_fma_f32 v[162:163], v[162:163], v[196:197], v[196:197] op_sel_hi:[1,0,0]
    v_pk_fma_f32 v[164:165], v[164:165], v[196:197], v[196:197] op_sel_hi:[1,0,0]
    v_pk_fma_f32 v[166:167], v[166:167], v[196:197], v[196:197] op_sel_hi:[1,0,0]
    v_rcp_f32 v160, v160
    v_rcp_f32 v161, v161
    v_rcp_f32 v162, v162
    v_rcp_f32 v163, v163
    v_rcp_f32 v164, v164
    v_rcp_f32 v165, v165
    v_rcp_f32 v166, v166
    v_rcp_f32 v167, v167
    v_pk_mul_f32 v[160:161], v[160:161], v[72:73]
    v_pk_mul_f32 v[162:163], v[162:163], v[74:75]
    v_pk_mul_f32 v[164:165], v[164:165], v[76:77]
    v_pk_mul_f32 v[166:167], v[166:167], v[78:79]
    v_cvt_pk_bf16_f32 v132, v160, v161
    v_cvt_pk_bf16_f32 v133, v162, v163
    v_cvt_pk_bf16_f32 v134, v164, v165
    v_cvt_pk_bf16_f32 v135, v166, v167
    buffer_store_dwordx4 v[132:135], v3, s[44:47], s84 offen offset:512 sc1
    s_waitcnt vmcnt(4)
    v_cmp_eq_u32 vcc, s76, v224
    s_nop 0
    s_cmp_eq_u64 vcc, -1
    s_cbranch_scc1 Lok_8
    s_mov_b32 s96, 0
Lsp_9:
    s_sleep 2
    v_min_u32 v224, 31, v0
    v_lshlrev_b32_e64 v224, 7, v224
    buffer_load_dword v224, v224, s[44:47], s79 offen sc1
    s_waitcnt vmcnt(0)
    v_cmp_eq_u32 vcc, s76, v224
    s_nop 0
    s_cmp_eq_u64 vcc, -1
    s_cbranch_scc1 Lok_8
    s_add_u32 s96, s96, 1
    s_cmp_lt_u32 s96, 20000
    s_cbranch_scc1 Lsp_9
Lok_8:
    s_nop 0
    v_pk_mul_f32 v[160:161], v[80:81], v[80:81]
    buffer_load_dwordx4 a[240:243], v1, s[44:47], s81 offen sc1
    v_pk_mul_f32 v[162:163], v[82:83], v[82:83]
    v_pk_mul_f32 v[164:165], v[84:85], v[84:85]
    v_pk_mul_f32 v[166:167], v[86:87], v[86:87]
    v_pk_fma_f32 v[160:161], v[160:161], v[200:201], v[198:199] op_sel_hi:[1,0,0]
    v_pk_fma_f32 v[162:163], v[162:163], v[200:201], v[198:199] op_sel_hi:[1,0,0]
    v_pk_fma_f32 v[164:165], v[164:165], v[200:201], v[198:199] op_sel_hi:[1,0,0]
    v_pk_fma_f32 v[166:167], v[166:167], v[200:201], v[198:199] op_sel_hi:[1,0,0]
    v_pk_mul_f32 v[160:161], v[160:161], v[80:81]
    v_pk_mul_f32 v[162:163], v[162:163], v[82:83]
    v_pk_mul_f32 v[164:165], v[164:165], v[84:85]
    v_pk_mul_f32 v[166:167], v[166:167], v[86:87]
    v_exp_f32 v160, v160
    v_exp_f32 v161, v161
    v_exp_f32 v162, v162
    v_exp_f32 v163, v163
    v_exp_f32 v164, v164
    v_exp_f32 v165, v165
    v_exp_f32_e64 v166, v166
    buffer_load_dwordx4 a[244:247], v1, s[44:47], s81 offen offset:1024 sc1
    v_exp_f32_e64 v167, v167
    v_pk_fma_f32 v[160:161], v[160:161], v[202:203], v[202:203] op_sel_hi:[1,0,0]
    v_pk_fma_f32 v[162:163], v[162:163], v[202:203], v[202:203] op_sel_hi:[1,0,0]
    v_pk_fma_f32 v[164:165], v[164:165], v[202:203], v[202:203] op_sel_hi:[1,0,0]
    v_pk_fma_f32 v[166:167], v[166:167], v[202:203], v[202:203] op_sel_hi:[1,0,0]
    v_rcp_f32 v160, v160
    v_rcp_f32 v161, v161
    v_rcp_f32 v162, v162
    v_rcp_f32 v163, v163
    v_rcp_f32 v164, v164
    v_rcp_f32 v165, v165
    v_rcp_f32 v166, v166
    v_rcp_f32 v167, v167
    v_pk_mul_f32 v[160:161], v[160:161], v[80:81]
    v_pk_mul_f32 v[162:163], v[162:163], v[82:83]
    v_pk_mul_f32 v[164:165], v[164:165], v[84:85]
    v_pk_mul_f32 v[166:167], v[166:167], v[86:87]
    v_cvt_pk_bf16_f32 v136, v160, v161
    buffer_load_dwordx4 a[248:251], v1, s[44:47], s81 offen offset:2048 sc1
    v_cvt_pk_bf16_f32 v137, v162, v163
    v_cvt_pk_bf16_f32 v138, v164, v165
    v_cvt_pk_bf16_f32 v139, v166, v167
    buffer_store_dwordx4 v[136:139], v3, s[44:47], s85 offen sc1
    v_pk_mul_f32 v[160:161], v[88:89], v[88:89]
    v_pk_mul_f32 v[162:163], v[90:91], v[90:91]
    v_pk_mul_f32 v[164:165], v[92:93], v[92:93]
    v_pk_mul_f32 v[166:167], v[94:95], v[94:95]
    v_pk_fma_f32 v[160:161], v[160:161], v[200:201], v[198:199] op_sel_hi:[1,0,0]
    v_pk_fma_f32 v[162:163], v[162:163], v[200:201], v[198:199] op_sel_hi:[1,0,0]
    v_pk_fma_f32 v[164:165], v[164:165], v[200:201], v[198:199] op_sel_hi:[1,0,0]
    v_pk_fma_f32 v[166:167], v[166:167], v[200:201], v[198:199] op_sel_hi:[1,0,0]
    v_pk_mul_f32 v[160:161], v[160:161], v[88:89]
    v_pk_mul_f32 v[162:163], v[162:163], v[90:91]
    v_pk_mul_f32 v[164:165], v[164:165], v[92:93]
    v_pk_mul_f32 v[166:167], v[166:167], v[94:95]
    v_exp_f32 v160, v160
    v_exp_f32 v161, v161
    buffer_load_dwordx4 a[252:255], v1, s[44:47], s81 offen offset:3072 sc1
    v_exp_f32 v162, v162
    v_exp_f32 v163, v163
    v_exp_f32 v164, v164
    v_exp_f32 v165, v165
    v_exp_f32 v166, v166
    v_exp_f32 v167, v167
    v_pk_fma_f32 v[160:161], v[160:161], v[202:203], v[202:203] op_sel_hi:[1,0,0]
    v_pk_fma_f32 v[162:163], v[162:163], v[202:203], v[202:203] op_sel_hi:[1,0,0]
    v_pk_fma_f32 v[164:165], v[164:165], v[202:203], v[202:203] op_sel_hi:[1,0,0]
    v_pk_fma_f32 v[166:167], v[166:167], v[202:203], v[202:203] op_sel_hi:[1,0,0]
    v_rcp_f32 v160, v160
    v_rcp_f32 v161, v161
    v_rcp_f32 v162, v162
    v_rcp_f32 v163, v163
    v_rcp_f32 v164, v164
    v_rcp_f32 v165, v165
    v_rcp_f32 v166, v166
    v_rcp_f32 v167, v167
    v_pk_mul_f32 v[160:161], v[160:161], v[88:89]
    v_pk_mul_f32 v[162:163], v[162:163], v[90:91]
    v_pk_mul_f32 v[164:165], v[164:165], v[92:93]
    v_pk_mul_f32 v[166:167], v[166:167], v[94:95]
    v_cvt_pk_bf16_f32 v140, v160, v161
    v_cvt_pk_bf16_f32 v141, v162, v163
    v_cvt_pk_bf16_f32 v142, v164, v165
    v_cvt_pk_bf16_f32 v143, v166, v167
    buffer_store_dwordx4 v[140:143], v3, s[44:47], s85 offen offset:512 sc1
    v_pk_mul_f32 v[160:161], v[96:97], v[96:97]
    v_pk_mul_f32 v[162:163], v[98:99], v[98:99]
    v_pk_mul_f32 v[164:165], v[100:101], v[100:101]
    v_pk_mul_f32 v[166:167], v[102:103], v[102:103]
    v_pk_fma_f32 v[160:161], v[160:161], v[194:195], v[192:193] op_sel_hi:[1,0,0]
    s_add_u32 s92, s90, 81920
    buffer_load_dwordx4 a[84:87], v1, s[44:47], s92 offen offset:1024 sc1
    v_pk_fma_f32 v[162:163], v[162:163], v[194:195], v[192:193] op_sel_hi:[1,0,0]
    v_pk_fma_f32 v[164:165], v[164:165], v[194:195], v[192:193] op_sel_hi:[1,0,0]
    v_pk_fma_f32 v[166:167], v[166:167], v[194:195], v[192:193] op_sel_hi:[1,0,0]
    v_pk_mul_f32 v[160:161], v[160:161], v[96:97]
    v_pk_mul_f32 v[162:163], v[162:163], v[98:99]
    v_pk_mul_f32 v[164:165], v[164:165], v[100:101]
    v_pk_mul_f32 v[166:167], v[166:167], v[102:103]
    v_exp_f32 v160, v160
    v_exp_f32 v161, v161
    v_exp_f32 v162, v162
    v_exp_f32 v163, v163
    v_exp_f32 v164, v164
    v_exp_f32 v165, v165
    v_exp_f32 v166, v166
    v_exp_f32 v167, v167
    v_pk_fma_f32 v[160:161], v[160:161], v[196:197], v[196:197] op_sel_hi:[1,0,0]
    v_pk_fma_f32 v[162:163], v[162:163], v[196:197], v[196:197] op_sel_hi:[1,0,0]
    v_pk_fma_f32 v[164:165], v[164:165], v[196:197], v[196:197] op_sel_hi:[1,0,0]
    v_pk_fma_f32 v[166:167], v[166:167], v[196:197], v[196:197] op_sel_hi:[1,0,0]
    v_rcp_f32 v160, v160
    v_rcp_f32 v161, v161
    v_rcp_f32 v162, v162
    v_rcp_f32 v163, v163
    v_rcp_f32 v164, v164
    v_rcp_f32 v165, v165
    v_rcp_f32 v166, v166
    v_rcp_f32 v167, v167
    v_pk_mul_f32 v[160:161], v[160:161], v[96:97]
    v_pk_mul_f32 v[162:163], v[162:163], v[98:99]
    v_pk_mul_f32 v[164:165], v[164:165], v[100:101]
    v_pk_mul_f32 v[166:167], v[166:167], v[102:103]
    v_cvt_pk_bf16_f32 v144, v160, v161
    v_cvt_pk_bf16_f32 v145, v162, v163
    v_cvt_pk_bf16_f32 v146, v164, v165
    v_cvt_pk_bf16_f32 v147, v166, v167
    buffer_store_dwordx4 v[144:147], v3, s[44:47], s84 offen offset:1024 sc1
    v_pk_mul_f32 v[160:161], v[104:105], v[104:105]
    v_pk_mul_f32 v[162:163], v[106:107], v[106:107]
    v_pk_mul_f32 v[164:165], v[108:109], v[108:109]
    v_pk_mul_f32 v[166:167], v[110:111], v[110:111]
    v_pk_fma_f32 v[160:161], v[160:161], v[194:195], v[192:193] op_sel_hi:[1,0,0]
    v_pk_fma_f32 v[162:163], v[162:163], v[194:195], v[192:193] op_sel_hi:[1,0,0]
    v_pk_fma_f32 v[164:165], v[164:165], v[194:195], v[192:193] op_sel_hi:[1,0,0]
    v_pk_fma_f32 v[166:167], v[166:167], v[194:195], v[192:193] op_sel_hi:[1,0,0]
    v_pk_mul_f32 v[160:161], v[160:161], v[104:105]
    buffer_load_dwordx4 a[88:91], v1, s[44:47], s92 offen offset:2048 sc1
    v_pk_mul_f32 v[162:163], v[162:163], v[106:107]
    v_pk_mul_f32 v[164:165], v[164:165], v[108:109]
    v_pk_mul_f32 v[166:167], v[166:167], v[110:111]
    v_exp_f32 v160, v160
    v_exp_f32 v161, v161
    v_exp_f32 v162, v162
    v_exp_f32 v163, v163
    v_exp_f32 v164, v164
    v_exp_f32 v165, v165
    v_exp_f32 v166, v166
    v_exp_f32 v167, v167
    v_pk_fma_f32 v[160:161], v[160:161], v[196:197], v[196:197] op_sel_hi:[1,0,0]
    v_pk_fma_f32 v[162:163], v[162:163], v[196:197], v[196:197] op_sel_hi:[1,0,0]
    v_pk_fma_f32 v[164:165], v[164:165], v[196:197], v[196:197] op_sel_hi:[1,0,0]
    v_pk_fma_f32 v[166:167], v[166:167], v[196:197], v[196:197] op_sel_hi:[1,0,0]
    v_rcp_f32 v160, v160
    v_rcp_f32 v161, v161
    v_rcp_f32 v162, v162
    v_rcp_f32 v163, v163
    v_rcp_f32 v164, v164
    v_rcp_f32 v165, v165
    v_rcp_f32 v166, v166
    v_rcp_f32 v167, v167
    v_pk_mul_f32 v[160:161], v[160:161], v[104:105]
    v_pk_mul_f32 v[162:163], v[162:163], v[106:107]
    v_pk_mul_f32 v[164:165], v[164:165], v[108:109]
    v_pk_mul_f32 v[166:167], v[166:167], v[110:111]
    v_cvt_pk_bf16_f32 v148, v160, v161
    v_cvt_pk_bf16_f32 v149, v162, v163
    v_cvt_pk_bf16_f32 v150, v164, v165
    v_cvt_pk_bf16_f32 v151, v166, v167
    buffer_store_dwordx4 v[148:151], v3, s[44:47], s84 offen offset:1536 sc1
    v_pk_mul_f32 v[160:161], v[112:113], v[112:113]
    v_pk_mul_f32 v[162:163], v[114:115], v[114:115]
    v_pk_mul_f32 v[164:165], v[116:117], v[116:117]
    v_pk_mul_f32 v[166:167], v[118:119], v[118:119]
    v_pk_fma_f32 v[160:161], v[160:161], v[200:201], v[198:199] op_sel_hi:[1,0,0]
    v_pk_fma_f32 v[162:163], v[162:163], v[200:201], v[198:199] op_sel_hi:[1,0,0]
    v_pk_fma_f32 v[164:165], v[164:165], v[200:201], v[198:199] op_sel_hi:[1,0,0]
    v_pk_fma_f32 v[166:167], v[166:167], v[200:201], v[198:199] op_sel_hi:[1,0,0]
    v_pk_mul_f32 v[160:161], v[160:161], v[112:113]
    v_pk_mul_f32 v[162:163], v[162:163], v[114:115]
    v_pk_mul_f32 v[164:165], v[164:165], v[116:117]
    v_pk_mul_f32 v[166:167], v[166:167], v[118:119]
    v_exp_f32 v160, v160
    v_exp_f32 v161, v161
    buffer_load_dwordx4 a[92:95], v1, s[44:47], s92 offen offset:3072 sc1
    v_exp_f32 v162, v162
    v_exp_f32 v163, v163
    v_exp_f32 v164, v164
    v_exp_f32 v165, v165
    v_exp_f32 v166, v166
    v_exp_f32 v167, v167
    v_pk_fma_f32 v[160:161], v[160:161], v[202:203], v[202:203] op_sel_hi:[1,0,0]
    v_pk_fma_f32 v[162:163], v[162:163], v[202:203], v[202:203] op_sel_hi:[1,0,0]
    v_pk_fma_f32 v[164:165], v[164:165], v[202:203], v[202:203] op_sel_hi:[1,0,0]
    v_pk_fma_f32 v[166:167], v[166:167], v[202:203], v[202:203] op_sel_hi:[1,0,0]
    v_rcp_f32 v160, v160
    v_rcp_f32 v161, v161
    v_rcp_f32 v162, v162
    v_rcp_f32 v163, v163
    v_rcp_f32 v164, v164
    v_rcp_f32 v165, v165
    v_rcp_f32 v166, v166
    v_rcp_f32 v167, v167
    v_pk_mul_f32 v[160:161], v[160:161], v[112:113]
    v_pk_mul_f32 v[162:163], v[162:163], v[114:115]
    v_pk_mul_f32 v[164:165], v[164:165], v[116:117]
    v_pk_mul_f32 v[166:167], v[166:167], v[118:119]
    v_cvt_pk_bf16_f32 v152, v160, v161
    v_cvt_pk_bf16_f32 v153, v162, v163
    v_cvt_pk_bf16_f32 v154, v164, v165
    v_cvt_pk_bf16_f32 v155, v166, v167
    buffer_store_dwordx4 v[152:155], v3, s[44:47], s85 offen offset:1024 sc1
    v_pk_mul_f32 v[160:161], v[120:121], v[120:121]
    v_pk_mul_f32 v[162:163], v[122:123], v[122:123]
    v_pk_mul_f32 v[164:165], v[124:125], v[124:125]
    v_pk_mul_f32 v[166:167], v[126:127], v[126:127]
    v_pk_fma_f32 v[160:161], v[160:161], v[200:201], v[198:199] op_sel_hi:[1,0,0]
    v_pk_fma_f32 v[162:163], v[162:163], v[200:201], v[198:199] op_sel_hi:[1,0,0]
    v_pk_fma_f32 v[164:165], v[164:165], v[200:201], v[198:199] op_sel_hi:[1,0,0]
    v_pk_fma_f32 v[166:167], v[166:167], v[200:201], v[198:199] op_sel_hi:[1,0,0]
    v_pk_mul_f32 v[160:161], v[160:161], v[120:121]
    v_pk_mul_f32 v[162:163], v[162:163], v[122:123]
    v_pk_mul_f32 v[164:165], v[164:165], v[124:125]
    v_pk_mul_f32 v[166:167], v[166:167], v[126:127]
    v_exp_f32 v160, v160
    v_exp_f32 v161, v161
    v_exp_f32 v162, v162
    v_exp_f32 v163, v163
    v_exp_f32 v164, v164
    v_exp_f32 v165, v165
    buffer_load_dwordx4 a[96:99], v2, s[44:47], s92 offen sc1
    v_exp_f32 v166, v166
    v_exp_f32 v167, v167
    v_pk_fma_f32 v[160:161], v[160:161], v[202:203], v[202:203] op_sel_hi:[1,0,0]
    v_pk_fma_f32 v[162:163], v[162:163], v[202:203], v[202:203] op_sel_hi:[1,0,0]
    v_pk_fma_f32 v[164:165], v[164:165], v[202:203], v[202:203] op_sel_hi:[1,0,0]
    v_pk_fma_f32 v[166:167], v[166:167], v[202:203], v[202:203] op_sel_hi:[1,0,0]
    v_rcp_f32 v160, v160
    v_rcp_f32 v161, v161
    v_rcp_f32 v162, v162
    v_rcp_f32 v163, v163
    v_rcp_f32 v164, v164
    v_rcp_f32 v165, v165
    v_rcp_f32 v166, v166
    v_rcp_f32 v167, v167
    v_pk_mul_f32 v[160:161], v[160:161], v[120:121]
    v_pk_mul_f32 v[162:163], v[162:163], v[122:123]
    v_pk_mul_f32 v[164:165], v[164:165], v[124:125]
    v_pk_mul_f32 v[166:167], v[166:167], v[126:127]
    v_cvt_pk_bf16_f32 v156, v160, v161
    v_cvt_pk_bf16_f32 v157, v162, v163
    v_cvt_pk_bf16_f32 v158, v164, v165
    v_cvt_pk_bf16_f32 v159, v166, v167
    buffer_store_dwordx4 v[156:159], v3, s[44:47], s85 offen offset:1536 sc1
    s_waitcnt vmcnt(9)
    ds_write_b128 v24, a[240:243] offset:0
    ds_write_b128 v24, a[244:247] offset:256
    ds_write_b128 v24, a[248:251] offset:512
    ds_write_b128 v24, a[252:255] offset:768
    v_lshlrev_b32 v72, 16, v25
    v_lshlrev_b32 v73, 16, v25
    v_lshlrev_b32 v74, 16, v25
    v_lshlrev_b32_e64 v75, 16, v25
    s_waitcnt lgkmcnt(0)
    s_barrier
    ds_read2_b32 v[40:41], v228 offset0:128 offset1:129
    ds_read2_b32 v[42:43], v228 offset0:130 offset1:131
    ds_read_b128 v[36:39], v231 offset:4128
    ds_read2_b32 v[44:45], v227 offset0:128 offset1:129
    ds_read2_b32 v[46:47], v227 offset0:130 offset1:131
    ds_read_b128 v[32:35], v231 offset:3616
    ds_read_b128 v[28:31], v231 offset:3104
    ds_read2_b32 v[76:77], v227 offset0:0 offset1:1
    ds_read2_b32 v[78:79], v227 offset0:2 offset1:3
    ds_read_b128 v[24:27], v231 offset:2592
    ds_read_b128 v[20:23], v231 offset:2080
    ds_read_b128 v[16:19], v231 offset:1568
    ds_read_b128 v[12:15], v231 offset:1056
    ds_read_b128 v[8:11], v231 offset:544
    s_mul_i32 s56, s3, 15360
    v_and_b32_e64 v5, 15, v0
    s_add_u32 s56, s56, 65536
    v_lshrrev_b32 v4, 4, v0
    v_mul_u32_u24 v6, 40, v5
    v_lshl_add_u32 v6, v4, 3, v6
    v_add_u32 v6, s56, v6
    s_waitcnt lgkmcnt(11)
    v_mfma_f32_16x16x32_bf16 v[108:111], v[40:43], v[36:39], v[72:75]
    ds_read_b128 v[36:39], v231 offset:4064
    s_add_u32 s92, s90, 102400
    buffer_load_dwordx4 a[100:103], v1, s[44:47], s92 offen sc1
    s_waitcnt lgkmcnt(9)
    s_nop 0
    v_mfma_f32_16x16x32_bf16 v[104:107], v[40:43], v[32:35], v[72:75]
    v_mfma_f32_16x16x32_bf16 v[108:111], v[44:47], v[32:35], v[108:111]
    ds_read_b128 v[32:35], v231 offset:3552
    ds_read2_b32 v[48:49], v228 offset0:112 offset1:113
    ds_read2_b32 v[50:51], v228 offset0:114 offset1:115
    s_waitcnt lgkmcnt(11)
    v_mfma_f32_16x16x32_bf16 v[100:103], v[40:43], v[28:31], v[72:75]
    v_mfma_f32_16x16x32_bf16 v[104:107], v[44:47], v[28:31], v[104:107]
    s_add_u32 s92, s90, 102400
    buffer_load_dwordx4 a[104:107], v1, s[44:47], s92 offen offset:1024 sc1
    s_waitcnt lgkmcnt(9)
    v_mfma_f32_16x16x32_bf16 v[108:111], v[76:79], v[28:31], v[108:111]
    ds_read_b128 v[28:31], v231 offset:3040
    s_waitcnt lgkmcnt(9)
    s_nop 0
    v_mfma_f32_16x16x32_bf16 v[96:99], v[40:43], v[24:27], v[72:75]
    v_mfma_f32_16x16x32_bf16 v[100:103], v[44:47], v[24:27], v[100:103]
    v_mfma_f32_16x16x32_bf16 v[104:107], v[76:79], v[24:27], v[104:107]
    ds_read_b128 v[24:27], v231 offset:2528
    ds_read2_b32 v[52:53], v227 offset0:112 offset1:113
    ds_read2_b32 v[54:55], v227 offset0:114 offset1:115
    s_waitcnt lgkmcnt(11)
    s_nop 0
    v_mfma_f32_16x16x32_bf16 v[92:95], v[40:43], v[20:23], v[72:75]
    s_add_u32 s92, s90, 102400
    buffer_load_dwordx4 a[108:111], v1, s[44:47], s92 offen offset:2048 sc1
    v_mfma_f32_16x16x32_bf16 v[96:99], v[44:47], v[20:23], v[96:99]
    v_mfma_f32_16x16x32_bf16 v[100:103], v[76:79], v[20:23], v[100:103]
    ds_read_b128 v[20:23], v231 offset:2016
    s_waitcnt lgkmcnt(11)
    s_nop 0
    v_mfma_f32_16x16x32_bf16 v[88:91], v[40:43], v[16:19], v[72:75]
    v_mfma_f32_16x16x32_bf16 v[92:95], v[44:47], v[16:19], v[92:95]
    s_add_u32 s92, s90, 102400
    buffer_load_dwordx4 a[112:115], v1, s[44:47], s92 offen offset:3072 sc1
    v_mfma_f32_16x16x32_bf16 v[96:99], v[76:79], v[16:19], v[96:99]
    ds_read_b128 v[16:19], v231 offset:1504
    s_waitcnt lgkmcnt(11)
    v_mfma_f32_16x16x32_bf16 v[84:87], v[40:43], v[12:15], v[72:75]
    v_mfma_f32_16x16x32_bf16 v[88:91], v[44:47], v[12:15], v[88:91]
    v_mfma_f32_16x16x32_bf16 v[92:95], v[76:79], v[12:15], v[92:95]
    ds_read_b128 v[12:15], v231 offset:992
    s_waitcnt lgkmcnt(11)
    v_mfma_f32_16x16x32_bf16 v[80:83], v[40:43], v[8:11], v[72:75]
    s_add_u32 s92, s90, 102400
    buffer_load_dwordx4 a[116:119], v2, s[44:47], s92 offen sc1
    v_mfma_f32_16x16x32_bf16 v[84:87], v[44:47], v[8:11], v[84:87]
    v_mfma_f32_16x16x32_bf16 v[88:91], v[76:79], v[8:11], v[88:91]
    ds_read_b128 v[8:11], v231 offset:480
    s_waitcnt lgkmcnt(4)
    s_nop 0
    v_mfma_f32_16x16x32_bf16 v[108:111], v[48:51], v[36:39], v[108:111]
    ds_read_b128 v[36:39], v231 offset:4000
    v_mfma_f32_16x16x32_bf16 v[104:107], v[48:51], v[32:35], v[104:107]
    v_bfe_u32 v192, v0, 2, 2
    v_and_b32_e64 v193, 3, v0
    v_mfma_f32_16x16x32_bf16 v[108:111], v[52:55], v[32:35], v[108:111]
    s_add_u32 s92, s90, 122880
    buffer_load_dwordx4 a[120:123], v1, s[44:47], s92 offen sc1
    v_mfma_f32_16x16x32_bf16 v[56:59], a[224:227], v[32:35], 0
    ds_read_b128 v[32:35], v231 offset:3488
    ds_read2_b32 v[40:41], v228 offset0:96 offset1:97
    ds_read2_b32 v[42:43], v228 offset0:98 offset1:99
    s_waitcnt vmcnt(6)
    v_mov_b32 v224, s76
    v_mov_b32 v225, 0
    s_mov_b64 exec, 1
    buffer_store_dword v224, v225, s[44:47], s97 offen sc1
    s_mov_b64 exec, -1
    s_nop 0
    v_mfma_f32_16x16x32_bf16 v[100:103], v[48:51], v[28:31], v[100:103]
    v_lshrrev_b32 v194, 4, v0
    v_and_b32 v195, 1, v192
    v_mfma_f32_16x16x32_bf16 v[104:107], v[52:55], v[28:31], v[104:107]
    v_sub_u32_e64 v4, v193, v192
    v_mul_u32_u24 v7, 4560, v195
    v_mfma_f32_16x16x32_bf16 v[60:63], a[224:227], v[28:31], 0
    ds_read_b128 v[28:31], v231 offset:2976
    s_add_u32 s92, s90, 122880
    buffer_load_dwordx4 a[124:127], v1, s[44:47], s92 offen offset:1024 sc1
    v_mfma_f32_16x16x32_bf16 v[96:99], v[48:51], v[24:27], v[96:99]
    v_ashrrev_i32_e64 v196, 31, v4
    v_mul_u32_u24 v197, 80, v194
    v_mfma_f32_16x16x32_bf16 v[100:103], v[52:55], v[24:27], v[100:103]
    v_cvt_pk_bf16_f32 v200, v56, v57
    v_add_u32_e64 v4, v4, v196
    v_mfma_f32_16x16x32_bf16 v[64:67], a[224:227], v[24:27], 0
    ds_read_b128 v[24:27], v231 offset:2464
    ds_read2_b32 v[44:45], v227 offset0:96 offset1:97
    ds_read2_b32 v[46:47], v227 offset0:98 offset1:99
    v_cvt_pk_bf16_f32 v201, v58, v59
    s_waitcnt lgkmcnt(8)
    s_nop 0
    v_mfma_f32_16x16x32_bf16 v[92:95], v[48:51], v[20:23], v[92:95]
    ds_write_b64 v6, v[200:201] offset:3840
    v_add3_u32 v7, v7, v197, s56
    v_mfma_f32_16x16x32_bf16 v[96:99], v[52:55], v[20:23], v[96:99]
    v_cvt_pk_bf16_f32 v202, v60, v61
    s_add_u32 s92, s90, 122880
    buffer_load_dwordx4 a[128:131], v1, s[44:47], s92 offen offset:2048 sc1
    v_mfma_f32_16x16x32_bf16 v[68:71], a[224:227], v[20:23], 0
    ds_read_b128 v[20:23], v231 offset:1952
    v_cvt_pk_bf16_f32 v203, v62, v63
    v_mfma_f32_16x16x32_bf16 v[88:91], v[48:51], v[16:19], v[88:91]
    ds_write_b64 v6, v[202:203] offset:3200
    v_lshlrev_b32_e64 v196, 1, v195
    v_mfma_f32_16x16x32_bf16 v[92:95], v[52:55], v[16:19], v[92:95]
    v_cvt_pk_bf16_f32 v200, v64, v65
    v_lshl_add_u32 v4, v4, 3, v7
    v_mfma_f32_16x16x32_bf16 v[56:59], a[224:227], v[16:19], 0
    ds_read_b128 v[16:19], v231 offset:1440
    v_cvt_pk_bf16_f32 v201, v66, v67
    s_add_u32 s92, s90, 122880
    buffer_load_dwordx4 a[132:135], v1, s[44:47], s92 offen offset:3072 sc1
    v_mfma_f32_16x16x32_bf16 v[84:87], v[48:51], v[12:15], v[84:87]
    ds_write_b64 v6, v[200:201] offset:2560
    v_sub_u32_e64 v193, v193, v196
    v_mfma_f32_16x16x32_bf16 v[88:91], v[52:55], v[12:15], v[88:91]
    v_cvt_pk_bf16_f32 v202, v68, v69
    v_add_u32 v4, 80, v4
    v_mfma_f32_16x16x32_bf16 v[60:63], a[224:227], v[12:15], 0
    ds_read_b128 v[12:15], v231 offset:928
    v_cvt_pk_bf16_f32 v203, v70, v71
    v_mfma_f32_16x16x32_bf16 v[80:83], v[48:51], v[8:11], v[80:83]
    ds_write_b64 v6, v[202:203] offset:1920
    v_add_u32_e64 v193, -1, v193
    v_mfma_f32_16x16x32_bf16 v[84:87], v[52:55], v[8:11], v[84:87]
    v_cvt_pk_bf16_f32 v200, v56, v57
    s_add_u32 s92, s90, 122880
    buffer_load_dwordx4 a[136:139], v2, s[44:47], s92 offen sc1
    v_mfma_f32_16x16x32_bf16 v[64:67], a[224:227], v[8:11], 0
    ds_read_b128 v[8:11], v231 offset:416
    v_cvt_pk_bf16_f32 v201, v58, v59
    s_waitcnt lgkmcnt(8)
    s_nop 0
    v_mfma_f32_16x16x32_bf16 v[108:111], v[40:43], v[36:39], v[108:111]
    ds_read_b128 v[36:39], v231 offset:3936
    ds_write_b64 v6, v[200:201] offset:1280
    v_mfma_f32_16x16x32_bf16 v[104:107], v[40:43], v[32:35], v[104:107]
    v_cvt_pk_bf16_f32 v202, v60, v61
    v_lshrrev_b32_e64 v192, 1, v192
    v_mfma_f32_16x16x32_bf16 v[108:111], v[44:47], v[32:35], v[108:111]
    v_cvt_pk_bf16_f32 v203, v62, v63
    v_ashrrev_i32_e64 v196, 31, v193
    v_mfma_f32_16x16x32_bf16 v[68:71], a[228:231], v[32:35], 0
    ds_read_b128 v[32:35], v231 offset:3424
    ds_read2_b32 v[48:49], v228 offset0:80 offset1:81
    ds_read2_b32 v[50:51], v228 offset0:82 offset1:83
    ds_write_b64 v6, v[202:203] offset:640
    s_add_u32 s92, s90, 143360
    buffer_load_dwordx4 a[140:143], v1, s[44:47], s92 offen sc1
    v_mfma_f32_16x16x32_bf16 v[100:103], v[40:43], v[28:31], v[100:103]
    v_cvt_pk_bf16_f32 v200, v64, v65
    v_lshlrev_b32_e64 v194, 2, v194
    v_mfma_f32_16x16x32_bf16 v[104:107], v[44:47], v[28:31], v[104:107]
    v_cvt_pk_bf16_f32 v201, v66, v67
    v_mfma_f32_16x16x32_bf16 v[56:59], a[228:231], v[28:31], 0
    ds_read_b128 v[28:31], v231 offset:2912
    ds_write_b64 v6, v[200:201] offset:0
    v_mfma_f32_16x16x32_bf16 v[96:99], v[40:43], v[24:27], v[96:99]
    s_add_u32 s92, s90, 143360
    buffer_load_dwordx4 a[144:147], v1, s[44:47], s92 offen offset:1024 sc1
    v_mfma_f32_16x16x32_bf16 v[100:103], v[44:47], v[24:27], v[100:103]
    v_cvt_pk_bf16_f32 v202, v68, v69
    v_add_u32_e64 v193, v193, v196
    v_mfma_f32_16x16x32_bf16 v[60:63], a[228:231], v[24:27], 0
    ds_read_b128 v[24:27], v231 offset:2400
    ds_read2_b32 v[52:53], v227 offset0:80 offset1:81
    ds_read2_b32 v[54:55], v227 offset0:82 offset1:83
    v_cvt_pk_bf16_f32 v203, v70, v71
    s_waitcnt lgkmcnt(11)
    s_nop 0
    v_mfma_f32_16x16x32_bf16 v[92:95], v[40:43], v[20:23], v[92:95]
    ds_write_b64 v6, v[202:203] offset:8320
    v_sub_u32_e64 v194, v194, v192
    v_mfma_f32_16x16x32_bf16 v[96:99], v[44:47], v[20:23], v[96:99]
    v_cvt_pk_bf16_f32 v200, v56, v57
    v_mul_u32_u24 v5, 3280, v195
    v_mfma_f32_16x16x32_bf16 v[64:67], a[228:231], v[20:23], 0
    ds_read_b128 v[20:23], v231 offset:1888
    v_cvt_pk_bf16_f32 v201, v58, v59
    s_add_u32 s92, s90, 143360
    buffer_load_dwordx4 a[148:151], v1, s[44:47], s92 offen offset:2048 sc1
    v_mfma_f32_16x16x32_bf16 v[88:91], v[40:43], v[16:19], v[88:91]
    ds_write_b64 v6, v[200:201] offset:7680
    v_mul_i32_i24_e64 v194, 40, v194
    v_mfma_f32_16x16x32_bf16 v[92:95], v[44:47], v[16:19], v[92:95]
    v_cvt_pk_bf16_f32 v202, v60, v61
    v_lshl_add_u32 v5, v193, 3, v5
    v_mfma_f32_16x16x32_bf16 v[68:71], a[228:231], v[16:19], 0
    ds_read_b128 v[16:19], v231 offset:1376
    v_cvt_pk_bf16_f32 v203, v62, v63
    v_mfma_f32_16x16x32_bf16 v[84:87], v[40:43], v[12:15], v[84:87]
    ds_write_b64 v6, v[202:203] offset:7040
    s_add_u32 s92, s90, 143360
    buffer_load_dwordx4 a[152:155], v1, s[44:47], s92 offen offset:3072 sc1
    v_mfma_f32_16x16x32_bf16 v[88:91], v[44:47], v[12:15], v[88:91]
    v_cvt_pk_bf16_f32 v200, v64, v65
    s_lshl_b32 s57, s3, 14
    s_nop 0
    v_mfma_f32_16x16x32_bf16 v[56:59], a[228:231], v[12:15], 0
    ds_read_b128 v[12:15], v231 offset:864
    v_cvt_pk_bf16_f32 v201, v66, v67
    v_mfma_f32_16x16x32_bf16 v[80:83], v[40:43], v[8:11], v[80:83]
    ds_write_b64 v6, v[200:201] offset:6400
    v_add3_u32 v5, v5, v194, s56
    v_mfma_f32_16x16x32_bf16 v[84:87], v[44:47], v[8:11], v[84:87]
    v_cvt_pk_bf16_f32 v202, v68, v69
    v_mov_b32_e64 v7, s57
    v_mfma_f32_16x16x32_bf16 v[60:63], a[228:231], v[8:11], 0
    ds_read_b128 v[8:11], v231 offset:352
    v_cvt_pk_bf16_f32 v203, v70, v71
    s_add_u32 s92, s90, 143360
    buffer_load_dwordx4 a[156:159], v2, s[44:47], s92 offen sc1
    s_waitcnt lgkmcnt(8)
    s_nop 0
    v_mfma_f32_16x16x32_bf16 v[108:111], v[48:51], v[36:39], v[108:111]
    ds_read_b128 v[36:39], v231 offset:3872
    ds_write_b64 v6, v[202:203] offset:5760
    v_mfma_f32_16x16x32_bf16 v[104:107], v[48:51], v[32:35], v[104:107]
    v_cvt_pk_bf16_f32 v200, v56, v57
    v_add_u32 v5, 9240, v5
    v_mfma_f32_16x16x32_bf16 v[108:111], v[52:55], v[32:35], v[108:111]
    ds_read_b128 v[32:35], v231 offset:3360
    ds_read2_b32 v[40:41], v228 offset0:64 offset1:65
    ds_read2_b32 v[42:43], v228 offset0:66 offset1:67
    v_cvt_pk_bf16_f32 v201, v58, v59
    v_mfma_f32_16x16x32_bf16 v[100:103], v[48:51], v[28:31], v[100:103]
    ds_write_b64 v6, v[200:201] offset:5120
    ds_read_u16 v7, v7 offset:9088
    v_mfma_f32_16x16x32_bf16 v[104:107], v[52:55], v[28:31], v[104:107]
    ds_read_b128 v[28:31], v231 offset:2848
    v_cvt_pk_bf16_f32 v202, v60, v61
    s_add_u32 s92, s90, 163840
    buffer_load_dwordx4 a[160:163], v1, s[44:47], s92 offen sc1
    v_mfma_f32_16x16x32_bf16 v[96:99], v[48:51], v[24:27], v[96:99]
    v_cvt_pk_bf16_f32 v203, v62, v63
    v_accvgpr_read_b32 v72, a220
    v_mfma_f32_16x16x32_bf16 v[100:103], v[52:55], v[24:27], v[100:103]
    ds_write_b64 v6, v[202:203] offset:4480
    v_accvgpr_read_b32 v73, a221
    v_mfma_f32_16x16x32_bf16 v[64:67], a[232:235], v[24:27], 0
    ds_read_b128 v[24:27], v231 offset:2336
    ds_read2_b32 v[44:45], v227 offset0:64 offset1:65
    ds_read2_b32 v[46:47], v227 offset0:66 offset1:67
    s_waitcnt lgkmcnt(12)
    s_nop 0
    v_mfma_f32_16x16x32_bf16 v[92:95], v[48:51], v[20:23], v[92:95]
    s_add_u32 s92, s90, 163840
    buffer_load_dwordx4 a[164:167], v1, s[44:47], s92 offen offset:1024 sc1
    v_mfma_f32_16x16x32_bf16 v[96:99], v[52:55], v[20:23], v[96:99]
    v_accvgpr_read_b32 v74, a222
    v_accvgpr_read_b32 v75, a223
    v_mfma_f32_16x16x32_bf16 v[68:71], a[232:235], v[20:23], 0
    ds_read_b128 v[20:23], v231 offset:1824
    v_accvgpr_read_b32 v192, a208
    v_mfma_f32_16x16x32_bf16 v[88:91], v[48:51], v[16:19], v[88:91]
    v_accvgpr_read_b32 v193, a209
    v_accvgpr_read_b32 v194, a210
    v_mfma_f32_16x16x32_bf16 v[92:95], v[52:55], v[16:19], v[92:95]
    v_cvt_pk_bf16_f32 v200, v64, v65
    v_accvgpr_read_b32 v195, a211
    v_mfma_f32_16x16x32_bf16 v[56:59], a[232:235], v[16:19], 0
    ds_read_b128 v[16:19], v231 offset:1312
    v_cvt_pk_bf16_f32 v201, v66, v67
    s_add_u32 s92, s90, 163840
    buffer_load_dwordx4 a[168:171], v1, s[44:47], s92 offen offset:2048 sc1
    v_mfma_f32_16x16x32_bf16 v[84:87], v[48:51], v[12:15], v[84:87]
    ds_write_b64 v6, v[200:201] offset:11520
    v_accvgpr_read_b32 v196, a212
    v_mfma_f32_16x16x32_bf16 v[88:91], v[52:55], v[12:15], v[88:91]
    v_cvt_pk_bf16_f32 v202, v68, v69
    v_accvgpr_read_b32 v197, a213
    v_accvgpr_read_b32 v198, a214
    v_accvgpr_read_b32 v199, a215
    s_waitcnt lgkmcnt(8)
    v_lshl_add_u32 v7, v7, 16, v7
    v_and_b32 v72, v7, v72
    v_and_b32 v73, v7, v73
    v_and_b32 v74, v7, v74
    v_and_b32 v75, v7, v75
    s_cmp_lg_u32 s3, 0
    s_cbranch_scc1 Lw0_10
    v_min_u32 v224, 27, v0
    v_lshlrev_b32_e64 v224, 7, v224
    buffer_load_dword v224, v224, s[44:47], s20 offen sc1
Lw0_10:
    v_mfma_f32_16x16x32_bf16 v[60:63], a[232:235], v[12:15], 0
    ds_read_b128 v[12:15], v231 offset:800
    v_cvt_pk_bf16_f32 v203, v70, v71
    v_mfma_f32_16x16x32_bf16 v[80:83], v[48:51], v[8:11], v[80:83]
    ds_write_b64 v6, v[202:203] offset:10880
    s_add_u32 s92, s90, 163840
    buffer_load_dwordx4 a[172:175], v1, s[44:47], s92 offen offset:3072 sc1
    v_mfma_f32_16x16x32_bf16 v[84:87], v[52:55], v[8:11], v[84:87]
    v_cvt_pk_bf16_f32 v200, v56, v57
    v_mfma_f32_16x16x32_bf16 v[64:67], a[232:235], v[8:11], 0
    ds_read_b128 v[8:11], v231 offset:288
    v_cvt_pk_bf16_f32 v201, v58, v59
    s_waitcnt lgkmcnt(6)
    s_nop 0
    v_mfma_f32_16x16x32_bf16 v[108:111], v[40:43], v[36:39], v[108:111]
    ds_read_b128 v[36:39], v231 offset:3808
    ds_write_b64 v6, v[200:201] offset:10240
    v_mfma_f32_16x16x32_bf16 v[104:107], v[40:43], v[32:35], v[104:107]
    v_cvt_pk_bf16_f32 v202, v60, v61
    v_mfma_f32_16x16x32_bf16 v[108:111], v[44:47], v[32:35], v[108:111]
    ds_read_b128 v[32:35], v231 offset:3296
    ds_read2_b32 v[48:49], v228 offset0:48 offset1:49
    ds_read2_b32 v[50:51], v228 offset0:50 offset1:51
    v_cvt_pk_bf16_f32 v203, v62, v63
    s_add_u32 s92, s90, 163840
    buffer_load_dwordx4 a[176:179], v2, s[44:47], s92 offen sc1
    v_mfma_f32_16x16x32_bf16 v[100:103], v[40:43], v[28:31], v[100:103]
    ds_write_b64 v6, v[202:203] offset:9600
    v_mfma_f32_16x16x32_bf16 v[104:107], v[44:47], v[28:31], v[104:107]
    ds_read_b128 v[28:31], v231 offset:2784
    v_cvt_pk_bf16_f32 v200, v64, v65
    v_mfma_f32_16x16x32_bf16 v[96:99], v[40:43], v[24:27], v[96:99]
    v_cvt_pk_bf16_f32 v201, v66, v67
    v_mfma_f32_16x16x32_bf16 v[100:103], v[44:47], v[24:27], v[100:103]
    ds_write_b64 v6, v[200:201] offset:8960
    s_add_u32 s92, s90, 184320
    buffer_load_dwordx4 a[180:183], v1, s[44:47], s92 offen sc1
    v_mfma_f32_16x16x32_bf16 v[68:71], a[236:239], v[24:27], 0
    ds_read_b128 v[24:27], v231 offset:2272
    ds_read2_b32 v[52:53], v227 offset0:48 offset1:49
    ds_read2_b32 v[54:55], v227 offset0:50 offset1:51
    s_waitcnt lgkmcnt(11)
    s_nop 0
    v_mfma_f32_16x16x32_bf16 v[92:95], v[40:43], v[20:23], v[92:95]
    v_mfma_f32_16x16x32_bf16 v[96:99], v[44:47], v[20:23], v[96:99]
    v_mfma_f32_16x16x32_bf16 v[56:59], a[236:239], v[20:23], 0
    ds_read_b128 v[20:23], v231 offset:1760
    v_mfma_f32_16x16x32_bf16 v[88:91], v[40:43], v[16:19], v[88:91]
    s_add_u32 s92, s90, 184320
    buffer_load_dwordx4 a[184:187], v1, s[44:47], s92 offen offset:1024 sc1
    v_mfma_f32_16x16x32_bf16 v[92:95], v[44:47], v[16:19], v[92:95]
    v_cvt_pk_bf16_f32 v202, v68, v69
    v_mfma_f32_16x16x32_bf16 v[60:63], a[236:239], v[16:19], 0
    ds_read_b128 v[16:19], v231 offset:1248
    v_cvt_pk_bf16_f32 v203, v70, v71
    v_mfma_f32_16x16x32_bf16 v[84:87], v[40:43], v[12:15], v[84:87]
    ds_write_b64 v6, v[202:203] offset:14720
    v_mfma_f32_16x16x32_bf16 v[88:91], v[44:47], v[12:15], v[88:91]
    v_cvt_pk_bf16_f32 v200, v56, v57
    v_mfma_f32_16x16x32_bf16 v[64:67], a[236:239], v[12:15], 0
    ds_read_b128 v[12:15], v231 offset:736
    v_cvt_pk_bf16_f32 v201, v58, v59
    s_add_u32 s92, s90, 184320
    buffer_load_dwordx4 a[188:191], v1, s[44:47], s92 offen offset:2048 sc1
    v_mfma_f32_16x16x32_bf16 v[80:83], v[40:43], v[8:11], v[80:83]
    ds_write_b64 v6, v[200:201] offset:14080
    v_mfma_f32_16x16x32_bf16 v[84:87], v[44:47], v[8:11], v[84:87]
    v_cvt_pk_bf16_f32 v202, v60, v61
    v_mfma_f32_16x16x32_bf16 v[68:71], a[236:239], v[8:11], 0
    ds_read_b128 v[8:11], v231 offset:224
    v_cvt_pk_bf16_f32 v203, v62, v63
    s_waitcnt lgkmcnt(6)
    s_nop 0
    v_mfma_f32_16x16x32_bf16 v[108:111], v[48:51], v[36:39], v[108:111]
    ds_read_b128 v[36:39], v231 offset:3744
    ds_write_b64 v6, v[202:203] offset:13440
    s_add_u32 s92, s90, 184320
    buffer_load_dwordx4 a[192:195], v1, s[44:47], s92 offen offset:3072 sc1
    v_mfma_f32_16x16x32_bf16 v[104:107], v[48:51], v[32:35], v[104:107]
    v_cvt_pk_bf16_f32 v200, v64, v65
    v_mfma_f32_16x16x32_bf16 v[108:111], v[52:55], v[32:35], v[108:111]
    ds_read_b128 v[32:35], v231 offset:3232
    ds_read2_b32 v[40:41], v228 offset0:32 offset1:33
    ds_read2_b32 v[42:43], v228 offset0:34 offset1:35
    v_cvt_pk_bf16_f32 v201, v66, v67
    v_mfma_f32_16x16x32_bf16 v[100:103], v[48:51], v[28:31], v[100:103]
    ds_write_b64 v6, v[200:201] offset:12800
    v_mfma_f32_16x16x32_bf16 v[104:107], v[52:55], v[28:31], v[104:107]
    ds_read_b128 v[28:31], v231 offset:2720
    v_cvt_pk_bf16_f32 v202, v68, v69
    v_mfma_f32_16x16x32_bf16 v[96:99], v[48:51], v[24:27], v[96:99]
    v_cvt_pk_bf16_f32 v203, v70, v71
    s_add_u32 s92, s90, 184320
    buffer_load_dwordx4 a[196:199], v2, s[44:47], s92 offen sc1
    v_mfma_f32_16x16x32_bf16 v[100:103], v[52:55], v[24:27], v[100:103]
    ds_read_b128 v[24:27], v231 offset:2208
    ds_read2_b32 v[44:45], v227 offset0:32 offset1:33
    ds_read2_b32 v[46:47], v227 offset0:34 offset1:35
    ds_write_b64 v6, v[202:203] offset:12160
    s_waitcnt lgkmcnt(11)
    s_nop 0
    v_mfma_f32_16x16x32_bf16 v[92:95], v[48:51], v[20:23], v[92:95]
    v_mfma_f32_16x16x32_bf16 v[96:99], v[52:55], v[20:23], v[96:99]
    ds_read_b128 v[20:23], v231 offset:1696
    v_mfma_f32_16x16x32_bf16 v[88:91], v[48:51], v[16:19], v[88:91]
    s_add_u32 s92, s90, 204800
    buffer_load_dwordx4 a[200:203], v1, s[44:47], s92 offen sc1
    v_mfma_f32_16x16x32_bf16 v[92:95], v[52:55], v[16:19], v[92:95]
    ds_read_b128 v[16:19], v231 offset:1184
    v_mfma_f32_16x16x32_bf16 v[84:87], v[48:51], v[12:15], v[84:87]
    v_mfma_f32_16x16x32_bf16 v[88:91], v[52:55], v[12:15], v[88:91]
    ds_read_b128 v[12:15], v231 offset:672
    v_mfma_f32_16x16x32_bf16 v[80:83], v[48:51], v[8:11], v[80:83]
    v_mfma_f32_16x16x32_bf16 v[84:87], v[52:55], v[8:11], v[84:87]
    ds_read_b128 v[8:11], v231 offset:160
    s_add_u32 s92, s90, 204800
    buffer_load_dwordx4 a[204:207], v1, s[44:47], s92 offen offset:1024 sc1
    s_waitcnt lgkmcnt(5)
    v_mfma_f32_16x16x32_bf16 v[108:111], v[40:43], v[36:39], v[108:111]
    ds_read_b128 v[36:39], v231 offset:3680
    s_cmp_lg_u32 s3, 0
    s_cbranch_scc1 Lw0_11
    s_waitcnt vmcnt(9)
    v_cmp_eq_u32 vcc, s76, v224
    s_nop 0
    s_cmp_eq_u64 vcc, -1
    s_cbranch_scc1 Lok_12
    s_mov_b32 s96, 0
Lsp_13:
    s_sleep 2
    v_min_u32 v224, 27, v0
    v_lshlrev_b32 v224, 7, v224
    buffer_load_dword v224, v224, s[44:47], s20 offen sc1
    s_waitcnt vmcnt(0)
    v_cmp_eq_u32 vcc, s76, v224
    s_nop 0
    s_cmp_eq_u64 vcc, -1
    s_cbranch_scc1 Lok_12
    s_add_u32 s96, s96, 1
    s_cmp_lt_u32 s96, 20000
    s_cbranch_scc1 Lsp_13
Lok_12:
Lw0_11:
    s_barrier
    v_mfma_f32_16x16x32_bf16 v[104:107], v[40:43], v[32:35], v[104:107]
    v_mfma_f32_16x16x32_bf16 v[108:111], v[44:47], v[32:35], v[108:111]
    ds_read_b128 v[32:35], v231 offset:3168
    ds_read2_b32 v[48:49], v228 offset0:16 offset1:17
    ds_read2_b32 v[50:51], v228 offset0:18 offset1:19
    v_mfma_f32_16x16x32_bf16 v[100:103], v[40:43], v[28:31], v[100:103]
    ds_read2_b32 v[56:57], v230 offset0:0 offset1:1
    ds_read2_b32 v[58:59], v230 offset0:2 offset1:3
    v_mfma_f32_16x16x32_bf16 v[104:107], v[44:47], v[28:31], v[104:107]
    ds_read_b128 v[28:31], v231 offset:2656
    buffer_load_dwordx4 v[112:115], v204, s[44:47], s88 offen sc1
    v_mfma_f32_16x16x32_bf16 v[96:99], v[40:43], v[24:27], v[96:99]
    v_mfma_f32_16x16x32_bf16 v[100:103], v[44:47], v[24:27], v[100:103]
    ds_read_b128 v[24:27], v231 offset:2144
    ds_read2_b32 v[52:53], v227 offset0:16 offset1:17
    ds_read2_b32 v[54:55], v227 offset0:18 offset1:19
    ds_read2_b32 v[60:61], v230 offset0:16 offset1:17
    ds_read2_b32 v[62:63], v230 offset0:18 offset1:19
    s_waitcnt lgkmcnt(12)
    s_nop 0
    v_mfma_f32_16x16x32_bf16 v[92:95], v[40:43], v[20:23], v[92:95]
    buffer_load_dwordx4 v[116:119], v205, s[44:47], s88 offen sc1
    v_mfma_f32_16x16x32_bf16 v[96:99], v[44:47], v[20:23], v[96:99]
    ds_read_b128 v[20:23], v231 offset:1632
    v_mfma_f32_16x16x32_bf16 v[88:91], v[40:43], v[16:19], v[88:91]
    ds_read2_b32 v[64:65], v230 offset0:32 offset1:33
    ds_read2_b32 v[66:67], v230 offset0:34 offset1:35
    v_mfma_f32_16x16x32_bf16 v[92:95], v[44:47], v[16:19], v[92:95]
    ds_read_b128 v[16:19], v231 offset:1120
    buffer_load_dwordx4 v[120:123], v206, s[44:47], s88 offen sc1
    v_mfma_f32_16x16x32_bf16 v[84:87], v[40:43], v[12:15], v[84:87]
    v_mfma_f32_16x16x32_bf16 v[88:91], v[44:47], v[12:15], v[88:91]
    ds_read_b128 v[12:15], v231 offset:608
    ds_read2_b32 v[68:69], v230 offset0:48 offset1:49
    ds_read2_b32 v[70:71], v230 offset0:50 offset1:51
    v_mfma_f32_16x16x32_bf16 v[80:83], v[40:43], v[8:11], v[80:83]
    buffer_load_dwordx4 v[124:127], v207, s[44:47], s88 offen sc1
    v_mfma_f32_16x16x32_bf16 v[84:87], v[44:47], v[8:11], v[84:87]
    ds_read_b128 v[8:11], v231 offset:96
    s_waitcnt lgkmcnt(10)
    s_nop 0
    v_mfma_f32_16x16x32_bf16 v[108:111], v[48:51], v[36:39], v[108:111]
    ds_read_b128 v[36:39], v231 offset:48
    v_mfma_f32_16x16x32_bf16 v[104:107], v[48:51], v[32:35], v[104:107]
    ds_read_b64_tr_b16 v[40:41], v5 offset:80
    ds_read_b64_tr_b16 v[42:43], v5 offset:0
    s_add_u32 s91, s88, 4096
    buffer_load_dwordx4 v[128:131], v204, s[44:47], s91 offen sc1
    v_mfma_f32_16x16x32_bf16 v[108:111], v[52:55], v[32:35], v[108:111]
    ds_read_b128 v[32:35], v231 offset:560
    v_mfma_f32_16x16x32_bf16 v[100:103], v[48:51], v[28:31], v[100:103]
    v_mfma_f32_16x16x32_bf16 v[104:107], v[52:55], v[28:31], v[104:107]
    ds_read_b128 v[28:31], v231 offset:1072
    v_mfma_f32_16x16x32_bf16 v[96:99], v[48:51], v[24:27], v[96:99]
    ds_read_b64_tr_b16 v[44:45], v5 offset:720
    ds_read_b64_tr_b16 v[46:47], v5 offset:640
    buffer_load_dwordx4 v[132:135], v205, s[44:47], s91 offen sc1
    v_mfma_f32_16x16x32_bf16 v[100:103], v[52:55], v[24:27], v[100:103]
    ds_read_b128 v[24:27], v231 offset:1584
    s_waitcnt lgkmcnt(8)
    s_nop 0
    v_mfma_f32_16x16x32_bf16 v[92:95], v[48:51], v[20:23], v[92:95]
    v_mfma_f32_16x16x32_bf16 v[96:99], v[52:55], v[20:23], v[96:99]
    ds_read_b128 v[20:23], v231 offset:2096
    buffer_load_dwordx4 v[136:139], v206, s[44:47], s91 offen sc1
    v_mfma_f32_16x16x32_bf16 v[88:91], v[48:51], v[16:19], v[88:91]
    v_mfma_f32_16x16x32_bf16 v[92:95], v[52:55], v[16:19], v[92:95]
    v_mfma_f32_16x16x32_bf16 v[84:87], v[48:51], v[12:15], v[84:87]
    buffer_load_dwordx4 v[140:143], v207, s[44:47], s91 offen sc1
    v_mfma_f32_16x16x32_bf16 v[88:91], v[52:55], v[12:15], v[88:91]
    v_mfma_f32_16x16x32_bf16 v[80:83], v[48:51], v[8:11], v[80:83]
    v_mfma_f32_16x16x32_bf16 v[84:87], v[52:55], v[8:11], v[84:87]
    s_add_u32 s91, s88, 8192
    buffer_load_dwordx4 v[144:147], v204, s[44:47], s91 offen sc1
    s_waitcnt lgkmcnt(8)
    v_mfma_f32_16x16x32_bf16 v[92:95], v[72:75], v[36:39], v[92:95]
    ds_read_b64_tr_b16 v[48:49], v5 offset:1360
    ds_read_b64_tr_b16 v[50:51], v5 offset:1280
    s_waitcnt lgkmcnt(7)
    v_mfma_f32_16x16x32_bf16 v[96:99], v[72:75], v[32:35], v[96:99]
    ds_read_b64 v[16:17], v229 offset:320
    ds_read_b64 v[18:19], v229 offset:328
    s_waitcnt lgkmcnt(8)
    v_mfma_f32_16x16x32_bf16 v[100:103], v[72:75], v[28:31], v[100:103]
    ds_read_b64_tr_b16 v[52:53], v5 offset:2000
    ds_read_b64_tr_b16 v[54:55], v5 offset:1920
    buffer_load_dwordx4 v[148:151], v205, s[44:47], s91 offen sc1
    s_waitcnt lgkmcnt(7)
    v_mfma_f32_16x16x32_bf16 v[104:107], v[72:75], v[24:27], v[104:107]
    ds_read_b64 v[12:13], v229 offset:256
    ds_read_b64 v[14:15], v229 offset:264
    s_waitcnt lgkmcnt(8)
    s_nop 0
    v_mfma_f32_16x16x32_bf16 v[108:111], v[72:75], v[20:23], v[108:111]
    ds_read_b64 v[8:9], v229 offset:192
    ds_read_b64 v[10:11], v229 offset:200
    v_mfma_f32_16x16x32_bf16 v[96:99], v[40:43], v[56:59], v[96:99]
    buffer_load_dwordx4 v[152:155], v206, s[44:47], s91 offen sc1
    v_mfma_f32_16x16x32_bf16 v[100:103], v[40:43], v[60:63], v[100:103]
    ds_read_b64 v[36:37], v229 offset:0
    ds_read_b64 v[38:39], v229 offset:8
    v_cvt_pk_bf16_f32 v76, v80, v81
    v_cvt_pk_bf16_f32 v77, v82, v83
    v_mfma_f32_16x16x32_bf16 v[104:107], v[40:43], v[64:67], v[104:107]
    ds_read_b64 v[32:33], v229 offset:64
    ds_read_b64 v[34:35], v229 offset:72
    v_cvt_pk_bf16_f32 v78, v84, v85
    v_cvt_pk_bf16_f32 v79, v86, v87
    v_mfma_f32_16x16x32_bf16 v[108:111], v[40:43], v[68:71], v[108:111]
    ds_read_b64 v[28:29], v229 offset:128
    ds_read_b64 v[30:31], v229 offset:136
    ds_read_b64_tr_b16 v[40:41], v4 offset:40
    ds_read_b64_tr_b16 v[42:43], v4 offset:0
    v_permlane16_swap_b32 v76, v78
    v_permlane16_swap_b32 v77, v79
    v_mfma_f32_16x16x32_bf16 v[100:103], v[44:47], v[56:59], v[100:103]
    buffer_load_dwordx4 v[156:159], v207, s[44:47], s91 offen sc1
    buffer_store_dwordx4 v[76:79], v226, s[44:47], s28 offen sc1
    v_mfma_f32_16x16x32_bf16 v[104:107], v[44:47], v[60:63], v[104:107]
    v_mfma_f32_16x16x32_bf16 v[108:111], v[44:47], v[64:67], v[108:111]
    ds_read_b64_tr_b16 v[44:45], v4 offset:360
    ds_read_b64_tr_b16 v[46:47], v4 offset:320
    s_waitcnt lgkmcnt(15)
    s_nop 0
    v_mfma_f32_16x16x32_bf16 v[104:107], v[48:51], v[56:59], v[104:107]
    s_add_u32 s91, s88, 12288
    buffer_load_dwordx4 v[160:163], v204, s[44:47], s91 offen sc1
    v_mfma_f32_16x16x32_bf16 v[108:111], v[48:51], v[60:63], v[108:111]
    ds_read_b64_tr_b16 v[48:49], v4 offset:680
    ds_read_b64_tr_b16 v[50:51], v4 offset:640
    s_waitcnt lgkmcnt(15)
    v_mfma_f32_16x16x32_bf16 v[108:111], v[52:55], v[56:59], v[108:111]
    ds_read_b64_tr_b16 v[52:53], v4 offset:1000
    ds_read_b64_tr_b16 v[54:55], v4 offset:960
    s_waitcnt lgkmcnt(6)
    v_mfma_f32_16x16x32_bf16 v[88:91], v[40:43], v[32:35], v[88:91]
    buffer_load_dwordx4 v[164:167], v205, s[44:47], s91 offen sc1
    v_mfma_f32_16x16x32_bf16 v[92:95], v[40:43], v[8:11], v[92:95]
    v_mfma_f32_16x16x32_bf16 v[96:99], v[40:43], v[16:19], v[96:99]
    ds_read_b64_tr_b16 v[40:41], v4 offset:1320
    ds_read_b64_tr_b16 v[42:43], v4 offset:1280
    s_waitcnt lgkmcnt(6)
    s_nop 0
    v_mfma_f32_16x16x32_bf16 v[88:91], v[44:47], v[36:39], v[88:91]
    buffer_load_dwordx4 v[168:171], v206, s[44:47], s91 offen sc1
    v_mfma_f32_16x16x32_bf16 v[92:95], v[44:47], v[28:31], v[92:95]
    v_mfma_f32_16x16x32_bf16 v[96:99], v[44:47], v[12:15], v[96:99]
    ds_read_b64_tr_b16 v[44:45], v4 offset:1640
    ds_read_b64_tr_b16 v[46:47], v4 offset:1600
    s_waitcnt lgkmcnt(6)
    s_nop 0
    v_mfma_f32_16x16x32_bf16 v[92:95], v[48:51], v[32:35], v[92:95]
    buffer_load_dwordx4 v[172:175], v207, s[44:47], s91 offen sc1
    v_mfma_f32_16x16x32_bf16 v[96:99], v[48:51], v[8:11], v[96:99]
    v_mfma_f32_16x16x32_bf16 v[100:103], v[48:51], v[16:19], v[100:103]
    ds_read_b64_tr_b16 v[48:49], v4 offset:1960
    ds_read_b64_tr_b16 v[50:51], v4 offset:1920
    s_waitcnt lgkmcnt(6)
    s_nop 0
    v_mfma_f32_16x16x32_bf16 v[92:95], v[52:55], v[36:39], v[92:95]
    s_add_u32 s91, s88, 16384
    buffer_load_dwordx4 v[176:179], v204, s[44:47], s91 offen sc1
    v_mfma_f32_16x16x32_bf16 v[96:99], v[52:55], v[28:31], v[96:99]
    v_mfma_f32_16x16x32_bf16 v[100:103], v[52:55], v[12:15], v[100:103]
    ds_read_b64_tr_b16 v[52:53], v4 offset:2280
    ds_read_b64_tr_b16 v[54:55], v4 offset:2240
    s_waitcnt lgkmcnt(6)
    s_nop 0
    v_mfma_f32_16x16x32_bf16 v[96:99], v[40:43], v[32:35], v[96:99]
    v_mfma_f32_16x16x32_bf16 v[100:103], v[40:43], v[8:11], v[100:103]
    buffer_load_dwordx4 v[180:183], v205, s[44:47], s91 offen sc1
    v_mfma_f32_16x16x32_bf16 v[104:107], v[40:43], v[16:19], v[104:107]
    ds_read_b64_tr_b16 v[40:41], v4 offset:2600
    ds_read_b64_tr_b16 v[42:43], v4 offset:2560
    s_waitcnt lgkmcnt(6)
    s_nop 0
    v_mfma_f32_16x16x32_bf16 v[96:99], v[44:47], v[36:39], v[96:99]
    v_mfma_f32_16x16x32_bf16 v[100:103], v[44:47], v[28:31], v[100:103]
    s_add_u32 s92, s90, 204800
    buffer_load_dwordx4 a[208:211], v1, s[44:47], s92 offen offset:2048 sc1
    v_cvt_pk_bf16_f32 v60, v88, v89
    v_cvt_pk_bf16_f32 v61, v90, v91
    v_mfma_f32_16x16x32_bf16 v[104:107], v[44:47], v[12:15], v[104:107]
    ds_read_b64_tr_b16 v[44:45], v4 offset:2920
    ds_read_b64_tr_b16 v[46:47], v4 offset:2880
    v_cvt_pk_bf16_f32 v62, v92, v93
    v_cvt_pk_bf16_f32 v63, v94, v95
    s_waitcnt lgkmcnt(6)
    v_mfma_f32_16x16x32_bf16 v[100:103], v[48:51], v[32:35], v[100:103]
    v_permlane16_swap_b32 v60, v62
    v_permlane16_swap_b32 v61, v63
    s_nop 0
    v_mfma_f32_16x16x32_bf16 v[104:107], v[48:51], v[8:11], v[104:107]
    buffer_load_dwordx4 a[212:215], v1, s[44:47], s92 offen offset:3072 sc1
    buffer_store_dwordx4 v[60:63], v226, s[44:47], s28 offen offset:1024 sc1
    v_mfma_f32_16x16x32_bf16 v[108:111], v[48:51], v[16:19], v[108:111]
    ds_read_b64_tr_b16 v[48:49], v4 offset:3240
    ds_read_b64_tr_b16 v[50:51], v4 offset:3200
    s_waitcnt lgkmcnt(6)
    s_nop 0
    v_mfma_f32_16x16x32_bf16 v[100:103], v[52:55], v[36:39], v[100:103]
    v_mfma_f32_16x16x32_bf16 v[104:107], v[52:55], v[28:31], v[104:107]
    buffer_load_dwordx4 a[216:219], v2, s[44:47], s92 offen sc1
    v_mfma_f32_16x16x32_bf16 v[108:111], v[52:55], v[12:15], v[108:111]
    ds_read_b64_tr_b16 v[52:53], v4 offset:3560
    ds_read_b64_tr_b16 v[54:55], v4 offset:3520
    s_waitcnt lgkmcnt(6)
    v_mfma_f32_16x16x32_bf16 v[104:107], v[40:43], v[32:35], v[104:107]
    v_mfma_f32_16x16x32_bf16 v[108:111], v[40:43], v[8:11], v[108:111]
    s_add_u32 s92, s90, 225280
    buffer_load_dwordx4 a[220:223], v1, s[44:47], s92 offen sc1
    s_waitcnt lgkmcnt(4)
    v_mfma_f32_16x16x32_bf16 v[104:107], v[44:47], v[36:39], v[104:107]
    v_mfma_f32_16x16x32_bf16 v[108:111], v[44:47], v[28:31], v[108:111]
    s_waitcnt lgkmcnt(2)
    v_mfma_f32_16x16x32_bf16 v[108:111], v[48:51], v[32:35], v[108:111]
    v_cvt_pk_bf16_f32 v64, v96, v97
    v_cvt_pk_bf16_f32 v65, v98, v99
    s_waitcnt lgkmcnt(0)
    v_mfma_f32_16x16x32_bf16 v[108:111], v[52:55], v[36:39], v[108:111]
    v_cvt_pk_bf16_f32 v66, v100, v101
    v_cvt_pk_bf16_f32 v67, v102, v103
    s_nop 0
    v_permlane16_swap_b32 v64, v66
    v_permlane16_swap_b32 v65, v67
    s_nop 0
    buffer_store_dwordx4 v[64:67], v226, s[44:47], s28 offen offset:2048 sc1
    v_cvt_pk_bf16_f32 v68, v104, v105
    v_cvt_pk_bf16_f32 v69, v106, v107
    v_cvt_pk_bf16_f32 v70, v108, v109
    v_cvt_pk_bf16_f32 v71, v110, v111
    s_nop 0
    v_permlane16_swap_b32 v68, v70
    v_permlane16_swap_b32 v69, v71
    buffer_store_dwordx4 v[68:71], v226, s[44:47], s28 offen offset:3072 sc1
    s_nop 1
    s_branch L_g2
L_skipconv:
    s_waitcnt vmcnt(0)
    v_mov_b32_e64 v224, s76
    v_mov_b32 v225, 0
    s_mov_b64 exec, 1
    buffer_store_dword v224, v225, s[44:47], s97 offen sc1
    s_mov_b64 exec, -1
    v_and_b32 v200, 15, v0
    v_bfe_u32 v201, v0, 4, 1
    v_cmp_gt_u32 s[54:55], 32, v0
    v_lshlrev_b32_e64 v201, 3, v201
    v_mov_b32 v203, 0x3f80
    v_sub_u32 v200, v200, v201
    v_and_b32 v201, 1, v200
    v_ashrrev_i32 v200, 1, v200
    v_lshlrev_b32 v201, 4, v201
    v_lshlrev_b32_e64 v203, v201, v203
    v_cmp_eq_u32 s[100:101], 0, v200
    s_nop 1
    v_cndmask_b32 v202, 0, v203, s[100:101]
    v_cndmask_b32 v192, 0, v202, s[54:55]
    v_sub_u32 v196, v202, v192
    v_cmp_eq_u32 s[100:101], 1, v200
    s_nop 1
    v_cndmask_b32 v202, 0, v203, s[100:101]
    v_cndmask_b32 v193, 0, v202, s[54:55]
    v_sub_u32 v197, v202, v193
    v_cmp_eq_u32 s[100:101], 2, v200
    s_nop 1
    v_cndmask_b32 v202, 0, v203, s[100:101]
    v_cndmask_b32 v194, 0, v202, s[54:55]
    v_sub_u32 v198, v202, v194
    v_cmp_eq_u32 s[100:101], 3, v200
    s_nop 1
    s_nop 0
    v_cndmask_b32 v202, 0, v203, s[100:101]
    v_cndmask_b32 v195, 0, v202, s[54:55]
    v_sub_u32_e64 v199, v202, v195
    s_add_u32 s92, s90, 102400
    buffer_load_dwordx4 a[100:103], v1, s[44:47], s92 offen sc1
    buffer_load_dwordx4 a[104:107], v1, s[44:47], s92 offen offset:1024 sc1
    buffer_load_dwordx4 a[108:111], v1, s[44:47], s92 offen offset:2048 sc1
    buffer_load_dwordx4 a[112:115], v1, s[44:47], s92 offen offset:3072 sc1
    buffer_load_dwordx4 a[116:119], v2, s[44:47], s92 offen sc1
    s_add_u32 s92, s90, 122880
    buffer_load_dwordx4 a[120:123], v1, s[44:47], s92 offen sc1
    buffer_load_dwordx4 a[124:127], v1, s[44:47], s92 offen offset:1024 sc1
    buffer_load_dwordx4 a[128:131], v1, s[44:47], s92 offen offset:2048 sc1
    buffer_load_dwordx4 a[132:135], v1, s[44:47], s92 offen offset:3072 sc1
    buffer_load_dwordx4 a[136:139], v2, s[44:47], s92 offen sc1
    s_add_u32 s92, s90, 143360
    buffer_load_dwordx4 a[140:143], v1, s[44:47], s92 offen sc1
    buffer_load_dwordx4 a[144:147], v1, s[44:47], s92 offen offset:1024 sc1
    buffer_load_dwordx4 a[148:151], v1, s[44:47], s92 offen offset:2048 sc1
    buffer_load_dwordx4 a[152:155], v1, s[44:47], s92 offen offset:3072 sc1
    buffer_load_dwordx4 a[156:159], v2, s[44:47], s92 offen sc1
    s_add_u32 s92, s90, 163840
    buffer_load_dwordx4 a[160:163], v1, s[44:47], s92 offen sc1
    buffer_load_dwordx4 a[164:167], v1, s[44:47], s92 offen offset:1024 sc1
    buffer_load_dwordx4 a[168:171], v1, s[44:47], s92 offen offset:2048 sc1
    buffer_load_dwordx4 a[172:175], v1, s[44:47], s92 offen offset:3072 sc1
    buffer_load_dwordx4 a[176:179], v2, s[44:47], s92 offen sc1
    s_add_u32 s92, s90, 184320
    buffer_load_dwordx4 a[180:183], v1, s[44:47], s92 offen sc1
    buffer_load_dwordx4 a[184:187], v1, s[44:47], s92 offen offset:1024 sc1
    buffer_load_dwordx4 a[188:191], v1, s[44:47], s92 offen offset:2048 sc1
    buffer_load_dwordx4 a[192:195], v1, s[44:47], s92 offen offset:3072 sc1
    buffer_load_dwordx4 a[196:199], v2, s[44:47], s92 offen sc1
    s_add_u32 s92, s90, 204800
    buffer_load_dwordx4 a[200:203], v1, s[44:47], s92 offen sc1
    buffer_load_dwordx4 a[204:207], v1, s[44:47], s92 offen offset:1024 sc1
    buffer_load_dwordx4 a[208:211], v1, s[44:47], s92 offen offset:2048 sc1
    buffer_load_dwordx4 a[212:215], v1, s[44:47], s92 offen offset:3072 sc1
    buffer_load_dwordx4 a[216:219], v2, s[44:47], s92 offen sc1
    s_add_u32 s92, s90, 225280
    buffer_load_dwordx4 a[220:223], v1, s[44:47], s92 offen sc1
    s_cmp_lg_u32 s3, 0
    s_cbranch_scc1 Lw0_14
    v_min_u32 v224, 27, v0
    v_lshlrev_b32 v224, 7, v224
    buffer_load_dword v224, v224, s[44:47], s20 offen sc1
    s_waitcnt vmcnt(0)
    v_cmp_eq_u32 vcc, s76, v224
    s_nop 0
    s_cmp_eq_u64 vcc, -1
    s_cbranch_scc1 Lok_15
    s_mov_b32 s96, 0
Lsp_16:
    s_sleep 6
    v_min_u32 v224, 27, v0
    v_lshlrev_b32_e64 v224, 7, v224
    buffer_load_dword v224, v224, s[44:47], s20 offen sc1
    s_waitcnt vmcnt(0)
    v_cmp_eq_u32 vcc, s76, v224
    s_nop 0
    s_cmp_eq_u64 vcc, -1
    s_cbranch_scc1 Lok_15
    s_add_u32 s96, s96, 1
    s_cmp_lt_u32 s96, 20000
    s_cbranch_scc1 Lsp_16
Lok_15:
Lw0_14:
    s_barrier
    buffer_load_dwordx4 v[112:115], v204, s[44:47], s88 offen sc1
    buffer_load_dwordx4 v[116:119], v205, s[44:47], s88 offen sc1
    buffer_load_dwordx4 v[120:123], v206, s[44:47], s88 offen sc1
    buffer_load_dwordx4 v[124:127], v207, s[44:47], s88 offen sc1
    s_add_u32 s91, s88, 4096
    buffer_load_dwordx4 v[128:131], v204, s[44:47], s91 offen sc1
    buffer_load_dwordx4 v[132:135], v205, s[44:47], s91 offen sc1
    buffer_load_dwordx4 v[136:139], v206, s[44:47], s91 offen sc1
    buffer_load_dwordx4 v[140:143], v207, s[44:47], s91 offen sc1
    s_add_u32 s91, s88, 8192
    buffer_load_dwordx4 v[144:147], v204, s[44:47], s91 offen sc1
    buffer_load_dwordx4 v[148:151], v205, s[44:47], s91 offen sc1
    buffer_load_dwordx4 v[152:155], v206, s[44:47], s91 offen sc1
    buffer_load_dwordx4 v[156:159], v207, s[44:47], s91 offen sc1
    s_add_u32 s91, s88, 12288
    buffer_load_dwordx4 v[160:163], v204, s[44:47], s91 offen sc1
    buffer_load_dwordx4 v[164:167], v205, s[44:47], s91 offen sc1
    buffer_load_dwordx4 v[168:171], v206, s[44:47], s91 offen sc1
    buffer_load_dwordx4 v[172:175], v207, s[44:47], s91 offen sc1
    s_add_u32 s91, s88, 16384
    buffer_load_dwordx4 v[176:179], v204, s[44:47], s91 offen sc1
    buffer_load_dwordx4 v[180:183], v205, s[44:47], s91 offen sc1
    s_branch L_g2
L_noconv:
    s_mov_b32 s93, 1
    s_mul_i32 s88, s59, 221184
    s_lshl_b32 s57, s3, 10
    v_lshrrev_b32 v60, 5, v0
    s_add_u32 s88, s88, s57
    s_lshr_b32 s56, s3, 1
    s_add_u32 s88, s88, 7602176
    s_lshl_b32 s56, s56, 31
    s_add_u32 s89, s88, 53248
    s_lshl_b32 s20, s59, 12
    s_or_b32 s89, s89, s56
    s_add_u32 s20, s20, 14680064
    v_lshlrev_b32 v60, 31, v60
    s_add_u32 s56, s3, 1
    s_and_b32 s56, s56, 3
    s_mul_i32 s56, s56, 55296
    v_add_u32_e64 v204, s56, v1
    s_add_u32 s56, s3, 2
    s_and_b32 s56, s56, 3
    s_mul_i32 s56, s56, 55296
    v_add_u32_e64 v205, s56, v1
    s_add_u32 s56, s3, 3
    s_and_b32 s56, s56, 3
    s_mul_i32 s56, s56, 55296
    v_add_u32_e64 v206, s56, v1
    s_add_u32 s56, s3, 4
    s_and_b32 s56, s56, 3
    s_mul_i32 s56, s56, 55296
    v_add_u32 v207, s56, v1
    s_lshl_b32 s21, s59, 2
    s_mul_i32 s57, s60, 160
    s_add_u32 s21, s21, s3
    s_mov_b32 s56, 0x199a
    s_mul_i32 s21, s21, 20480
    v_add_u32 v62, 64, v0
    s_add_u32 s21, s21, s57
    s_nop 0
    v_add_u32 v63, 0x80, v0
    v_mul_u32_u24 v58, s56, v0
    v_mul_u32_u24 v59, s56, v62
    v_mul_u32_u24 v61, s56, v63
    v_lshrrev_b32 v58, 16, v58
    v_lshrrev_b32 v59, 16, v59
    v_lshrrev_b32 v61, 16, v61
    v_mul_u32_u24 v58, 1120, v58
    v_mul_u32_u24 v59, 1120, v59
    v_mul_u32_u24 v61, 1120, v61
    v_add_u32_e64 v208, v1, v58
    v_lshl_add_u32 v209, v62, 4, v59
    v_lshl_add_u32 v210, v63, 4, v61
    v_lshrrev_b32 v61, 3, v0
    v_or_b32 v210, v210, v60
    v_and_b32_e64 v62, 7, v0
    s_mul_i32 s24, s60, 80
    v_lshlrev_b32 v62, 4, v62
    s_mul_i32 s56, s3, 20
    v_lshl_add_u32 v211, v61, 12, v62
    s_add_u32 s24, s24, s56
    v_mul_u32_u24 v61, 160, v61
    s_lshl_b32 s25, s24, 7
    v_add_u32 v212, 0x8000, v211
    s_lshl_b32 s24, s24, 12
    v_add_u32 v213, 0x10000, v211
    s_lshl_b32 s56, s59, 7
    v_and_b32 v62, 3, v0
    s_add_u32 s24, s24, s56
    v_or_b32_e64 v213, v213, v60
    s_add_u32 s24, s24, 2752512
    v_lshlrev_b32_e64 v63, 5, v62
    s_add_u32 s25, s25, 14811136
    v_bfe_u32 v60, v0, 2, 1
    s_mul_i32 s56, s3, 3200
    v_lshl_add_u32 v63, v60, 4, v63
    s_add_u32 s56, s56, 126976
    v_min_u32_e64 v223, 19, v0
    v_add3_u32 v214, v61, v63, s56
    s_mul_i32 s56, s3, 15360
    v_lshlrev_b32_e64 v223, 7, v223
    s_add_u32 s56, s56, 65536
    v_and_b32 v60, 15, v0
    v_add_u32 v218, s56, v1
    s_mul_i32 s61, s3, 3072
    v_lshrrev_b32_e64 v61, 4, v0
    s_add_u32 s61, s61, 139776
    v_mul_u32_u24 v60, 160, v60
    s_mul_i32 s56, s3, 2560
    v_lshl_add_u32 v215, v61, 4, v60
    s_add_u32 s53, s56, 152064
    v_lshl_add_u32 v222, v61, 3, v60
    v_bfe_u32 v60, v0, 2, 2
    v_add_u32 v215, s61, v215
    v_add_u32 v222, s53, v222
    v_lshl_add_u32 v63, v61, 3, v60
    s_lshl_b32 s56, s3, 5
    v_mul_u32_u24 v63, 160, v63
    s_add_u32 s56, s56, 126976
    v_lshl_add_u32 v63, v62, 3, v63
    v_lshrrev_b32 v60, 5, v0
    v_add_u32_e64 v216, s56, v63
    v_mul_u32_u24 v60, 2560, v60
    s_lshl_b32 s56, s86, 2
    v_sub_u32 v217, v216, v60
    s_add_u32 s56, s56, s3
    v_lshlrev_b32 v226, 4, v62
    s_lshl_b32 s28, s56, 12
    v_bfe_u32 v60, v0, 2, 3
    s_lshl_b32 s29, s56, 7
    v_lshl_add_u32 v226, v60, 7, v226
    s_add_u32 s28, s28, 2752512
    v_lshrrev_b32_e64 v60, 5, v0
    s_add_u32 s29, s29, 14811136
    v_lshl_add_u32 v226, v60, 6, v226
    s_sub_u32 s56, s3, 1
    s_and_b32 s56, s56, 3
    s_mul_i32 s56, s56, 15360
    s_add_u32 s56, s56, 65536
    v_add_u32_e64 v219, s56, v1
    s_sub_u32 s56, s3, 2
    s_and_b32 s56, s56, 3
    s_mul_i32 s56, s56, 15360
    s_add_u32 s56, s56, 70656
    v_add_u32_e64 v220, s56, v1
    s_sub_u32 s56, s3, 3
    s_and_b32 s56, s56, 3
    s_mul_i32 s56, s56, 15360
    s_add_u32 s56, s56, 75776
    v_add_u32 v221, s56, v1
    v_and_b32 v200, 15, v0
    v_bfe_u32 v201, v0, 4, 1
    v_cmp_gt_u32 s[54:55], 32, v0
    v_lshlrev_b32_e64 v201, 3, v201
    v_mov_b32 v203, 0x3f80
    v_sub_u32 v200, v200, v201
    v_and_b32 v201, 1, v200
    v_ashrrev_i32 v200, 1, v200
    v_lshlrev_b32 v201, 4, v201
    v_lshlrev_b32_e64 v203, v201, v203
    v_cmp_eq_u32 s[100:101], 0, v200
    s_nop 1
    v_cndmask_b32 v202, 0, v203, s[100:101]
    v_cndmask_b32 v192, 0, v202, s[54:55]
    v_sub_u32 v196, v202, v192
    v_cmp_eq_u32 s[100:101], 1, v200
    s_nop 1
    v_cndmask_b32 v202, 0, v203, s[100:101]
    v_cndmask_b32 v193, 0, v202, s[54:55]
    v_sub_u32 v197, v202, v193
    v_cmp_eq_u32 s[100:101], 2, v200
    s_nop 1
    v_cndmask_b32 v202, 0, v203, s[100:101]
    v_cndmask_b32 v194, 0, v202, s[54:55]
    v_sub_u32 v198, v202, v194
    v_cmp_eq_u32 s[100:101], 3, v200
    s_nop 1
    v_cndmask_b32 v202, 0, v203, s[100:101]
    v_cndmask_b32 v195, 0, v202, s[54:55]
    v_sub_u32 v199, v202, v195
    s_cmp_lg_u32 s3, 0
    s_cbranch_scc1 Lw0_17
    v_min_u32 v224, 27, v0
    v_lshlrev_b32 v224, 7, v224
    buffer_load_dword v224, v224, s[44:47], s20 offen sc1
    s_waitcnt vmcnt(0)
    v_cmp_eq_u32 vcc, s76, v224
    s_nop 0
    s_cmp_eq_u64 vcc, -1
    s_cbranch_scc1 Lok_18
    s_mov_b32 s96, 0
Lsp_19:
    s_sleep 6
    v_min_u32 v224, 27, v0
    v_lshlrev_b32_e64 v224, 7, v224
    buffer_load_dword v224, v224, s[44:47], s20 offen sc1
    s_waitcnt vmcnt(0)
    v_cmp_eq_u32 vcc, s76, v224
    s_nop 0
    s_cmp_eq_u64 vcc, -1
    s_cbranch_scc1 Lok_18
    s_add_u32 s96, s96, 1
    s_cmp_lt_u32 s96, 20000
    s_cbranch_scc1 Lsp_19
Lok_18:
Lw0_17:
    s_barrier
    buffer_load_dwordx4 v[112:115], v204, s[44:47], s88 offen sc1
    buffer_load_dwordx4 v[116:119], v205, s[44:47], s88 offen sc1
    buffer_load_dwordx4 v[120:123], v206, s[44:47], s88 offen sc1
    buffer_load_dwordx4 v[124:127], v207, s[44:47], s88 offen sc1
    s_add_u32 s91, s88, 4096
    buffer_load_dwordx4 v[128:131], v204, s[44:47], s91 offen sc1
    buffer_load_dwordx4 v[132:135], v205, s[44:47], s91 offen sc1
    buffer_load_dwordx4 v[136:139], v206, s[44:47], s91 offen sc1
    buffer_load_dwordx4 v[140:143], v207, s[44:47], s91 offen sc1
    s_add_u32 s91, s88, 8192
    buffer_load_dwordx4 v[144:147], v204, s[44:47], s91 offen sc1
    buffer_load_dwordx4 v[148:151], v205, s[44:47], s91 offen sc1
    buffer_load_dwordx4 v[152:155], v206, s[44:47], s91 offen sc1
    buffer_load_dwordx4 v[156:159], v207, s[44:47], s91 offen sc1
    s_add_u32 s91, s88, 12288
    buffer_load_dwordx4 v[160:163], v204, s[44:47], s91 offen sc1
    buffer_load_dwordx4 v[164:167], v205, s[44:47], s91 offen sc1
    buffer_load_dwordx4 v[168:171], v206, s[44:47], s91 offen sc1
    buffer_load_dwordx4 v[172:175], v207, s[44:47], s91 offen sc1
    s_add_u32 s91, s88, 16384
    buffer_load_dwordx4 v[176:179], v204, s[44:47], s91 offen sc1
    buffer_load_dwordx4 v[180:183], v205, s[44:47], s91 offen sc1
L_g2:
    s_waitcnt vmcnt(16)
    s_nop 0
    v_mfma_f32_16x16x32_bf16 v[8:11], a[0:3], v[112:115], 0
    buffer_load_dwordx4 v[184:187], v206, s[44:47], s91 offen sc1
    v_mfma_f32_16x16x32_bf16 v[12:15], a[4:7], v[112:115], 0
    v_mfma_f32_16x16x32_bf16 v[16:19], a[8:11], v[112:115], 0
    v_mfma_f32_16x16x32_bf16 v[20:23], a[12:15], v[112:115], 0
    v_mfma_f32_16x16x32_bf16 v[24:27], a[16:19], v[112:115], 0
    buffer_load_dwordx4 v[188:191], v207, s[44:47], s91 offen sc1
    v_mfma_f32_16x16x32_bf16 v[28:31], a[0:3], v[116:119], 0
    v_mfma_f32_16x16x32_bf16 v[32:35], a[4:7], v[116:119], 0
    v_mfma_f32_16x16x32_bf16 v[36:39], a[8:11], v[116:119], 0
    v_mfma_f32_16x16x32_bf16 v[40:43], a[12:15], v[116:119], 0
    v_mfma_f32_16x16x32_bf16 v[44:47], a[16:19], v[116:119], 0
    s_add_u32 s91, s88, 20480
    buffer_load_dwordx4 v[112:115], v204, s[44:47], s91 offen sc1
    s_waitcnt vmcnt(17)
    s_nop 0
    v_mfma_f32_16x16x32_bf16 v[48:51], a[0:3], v[120:123], 0
    v_mfma_f32_16x16x32_bf16 v[52:55], a[4:7], v[120:123], 0
    v_mfma_f32_16x16x32_bf16 v[56:59], a[8:11], v[120:123], 0
    v_mfma_f32_16x16x32_bf16 v[60:63], a[12:15], v[120:123], 0
    buffer_load_dwordx4 v[116:119], v205, s[44:47], s91 offen sc1
    v_mfma_f32_16x16x32_bf16 v[64:67], a[16:19], v[120:123], 0
    v_mfma_f32_16x16x32_bf16 v[68:71], a[0:3], v[124:127], 0
    v_mfma_f32_16x16x32_bf16 v[72:75], a[4:7], v[124:127], 0
    v_mfma_f32_16x16x32_bf16 v[76:79], a[8:11], v[124:127], 0
    v_mfma_f32_16x16x32_bf16 v[80:83], a[12:15], v[124:127], 0
    buffer_load_dwordx4 v[120:123], v206, s[44:47], s91 offen sc1
    v_mfma_f32_16x16x32_bf16 v[84:87], a[16:19], v[124:127], 0
    s_waitcnt vmcnt(17)
    s_nop 0
    v_mfma_f32_16x16x32_bf16 v[8:11], a[20:23], v[128:131], v[8:11]
    v_mfma_f32_16x16x32_bf16 v[12:15], a[24:27], v[128:131], v[12:15]
    v_mfma_f32_16x16x32_bf16 v[16:19], a[28:31], v[128:131], v[16:19]
    v_mfma_f32_16x16x32_bf16 v[20:23], a[32:35], v[128:131], v[20:23]
    buffer_load_dwordx4 v[124:127], v207, s[44:47], s91 offen sc1
    v_mfma_f32_16x16x32_bf16 v[24:27], a[36:39], v[128:131], v[24:27]
    v_mfma_f32_16x16x32_bf16 v[28:31], a[20:23], v[132:135], v[28:31]
    v_mfma_f32_16x16x32_bf16 v[32:35], a[24:27], v[132:135], v[32:35]
    v_mfma_f32_16x16x32_bf16 v[36:39], a[28:31], v[132:135], v[36:39]
    s_add_u32 s91, s88, 24576
    buffer_load_dwordx4 v[128:131], v204, s[44:47], s91 offen sc1
    v_mfma_f32_16x16x32_bf16 v[40:43], a[32:35], v[132:135], v[40:43]
    v_mfma_f32_16x16x32_bf16 v[44:47], a[36:39], v[132:135], v[44:47]
    s_waitcnt vmcnt(17)
    s_nop 0
    v_mfma_f32_16x16x32_bf16 v[48:51], a[20:23], v[136:139], v[48:51]
    v_mfma_f32_16x16x32_bf16 v[52:55], a[24:27], v[136:139], v[52:55]
    v_mfma_f32_16x16x32_bf16 v[56:59], a[28:31], v[136:139], v[56:59]
    buffer_load_dwordx4 v[132:135], v205, s[44:47], s91 offen sc1
    v_mfma_f32_16x16x32_bf16 v[60:63], a[32:35], v[136:139], v[60:63]
    v_mfma_f32_16x16x32_bf16 v[64:67], a[36:39], v[136:139], v[64:67]
    v_mfma_f32_16x16x32_bf16 v[68:71], a[20:23], v[140:143], v[68:71]
    v_mfma_f32_16x16x32_bf16 v[72:75], a[24:27], v[140:143], v[72:75]
    buffer_load_dwordx4 v[136:139], v206, s[44:47], s91 offen sc1
    v_mfma_f32_16x16x32_bf16 v[76:79], a[28:31], v[140:143], v[76:79]
    v_mfma_f32_16x16x32_bf16 v[80:83], a[32:35], v[140:143], v[80:83]
    v_mfma_f32_16x16x32_bf16 v[84:87], a[36:39], v[140:143], v[84:87]
    s_waitcnt vmcnt(16)
    s_nop 0
    v_mfma_f32_16x16x32_bf16 v[8:11], a[40:43], v[144:147], v[8:11]
    v_mfma_f32_16x16x32_bf16 v[12:15], a[44:47], v[144:147], v[12:15]
    buffer_load_dwordx4 v[140:143], v207, s[44:47], s91 offen sc1
    v_mfma_f32_16x16x32_bf16 v[16:19], a[48:51], v[144:147], v[16:19]
    v_mfma_f32_16x16x32_bf16 v[20:23], a[52:55], v[144:147], v[20:23]
    v_mfma_f32_16x16x32_bf16 v[24:27], a[56:59], v[144:147], v[24:27]
    v_mfma_f32_16x16x32_bf16 v[28:31], a[40:43], v[148:151], v[28:31]
    v_mfma_f32_16x16x32_bf16 v[32:35], a[44:47], v[148:151], v[32:35]
    s_add_u32 s91, s88, 28672
    buffer_load_dwordx4 v[144:147], v204, s[44:47], s91 offen sc1
    v_mfma_f32_16x16x32_bf16 v[36:39], a[48:51], v[148:151], v[36:39]
    v_mfma_f32_16x16x32_bf16 v[40:43], a[52:55], v[148:151], v[40:43]
    v_mfma_f32_16x16x32_bf16 v[44:47], a[56:59], v[148:151], v[44:47]
    s_waitcnt vmcnt(17)
    v_mfma_f32_16x16x32_bf16 v[48:51], a[40:43], v[152:155], v[48:51]
    buffer_load_dwordx4 v[148:151], v205, s[44:47], s91 offen sc1
    s_cmp_eq_u32 s93, 0
    s_cbranch_scc0 Lyf_20
    s_waitcnt vmcnt(12)
    v_mov_b32_e64 v224, s76
    v_mov_b32 v225, 0
    s_mov_b64 exec, 1
    buffer_store_dword v224, v225, s[44:47], s29 offen sc1
    s_mov_b64 exec, -1
Lyf_20:
    s_nop 0
    v_mfma_f32_16x16x32_bf16 v[52:55], a[44:47], v[152:155], v[52:55]
    v_mfma_f32_16x16x32_bf16 v[56:59], a[48:51], v[152:155], v[56:59]
    v_mfma_f32_16x16x32_bf16 v[60:63], a[52:55], v[152:155], v[60:63]
    v_mfma_f32_16x16x32_bf16 v[64:67], a[56:59], v[152:155], v[64:67]
    v_mfma_f32_16x16x32_bf16 v[68:71], a[40:43], v[156:159], v[68:71]
    buffer_load_dwordx4 v[152:155], v206, s[44:47], s91 offen sc1
    v_mfma_f32_16x16x32_bf16 v[72:75], a[44:47], v[156:159], v[72:75]
    v_mfma_f32_16x16x32_bf16 v[76:79], a[48:51], v[156:159], v[76:79]
    v_mfma_f32_16x16x32_bf16 v[80:83], a[52:55], v[156:159], v[80:83]
    v_mfma_f32_16x16x32_bf16 v[84:87], a[56:59], v[156:159], v[84:87]
    buffer_load_dwordx4 v[156:159], v207, s[44:47], s91 offen sc1
    s_waitcnt vmcnt(15)
    s_nop 0
    v_mfma_f32_16x16x32_bf16 v[8:11], a[60:63], v[160:163], v[8:11]
    v_mfma_f32_16x16x32_bf16 v[12:15], a[64:67], v[160:163], v[12:15]
    v_mfma_f32_16x16x32_bf16 v[16:19], a[68:71], v[160:163], v[16:19]
    v_mfma_f32_16x16x32_bf16 v[20:23], a[72:75], v[160:163], v[20:23]
    v_mfma_f32_16x16x32_bf16 v[24:27], a[76:79], v[160:163], v[24:27]
    s_add_u32 s91, s88, 32768
    buffer_load_dwordx4 v[160:163], v204, s[44:47], s91 offen sc1
    v_mfma_f32_16x16x32_bf16 v[28:31], a[60:63], v[164:167], v[28:31]
    v_mfma_f32_16x16x32_bf16 v[32:35], a[64:67], v[164:167], v[32:35]
    v_mfma_f32_16x16x32_bf16 v[36:39], a[68:71], v[164:167], v[36:39]
    v_mfma_f32_16x16x32_bf16 v[40:43], a[72:75], v[164:167], v[40:43]
    v_mfma_f32_16x16x32_bf16 v[44:47], a[76:79], v[164:167], v[44:47]
    buffer_load_dwordx4 v[164:167], v205, s[44:47], s91 offen sc1
    s_waitcnt vmcnt(18)
    s_nop 0
    v_mfma_f32_16x16x32_bf16 v[48:51], a[60:63], v[168:171], v[48:51]
    v_mfma_f32_16x16x32_bf16 v[52:55], a[64:67], v[168:171], v[52:55]
    v_mfma_f32_16x16x32_bf16 v[56:59], a[68:71], v[168:171], v[56:59]
    v_mfma_f32_16x16x32_bf16 v[60:63], a[72:75], v[168:171], v[60:63]
    s_add_u32 s92, s90, 225280
    buffer_load_dwordx4 a[224:227], v1, s[44:47], s92 offen offset:1024 sc1
    v_mfma_f32_16x16x32_bf16 v[64:67], a[76:79], v[168:171], v[64:67]
    v_mfma_f32_16x16x32_bf16 v[68:71], a[60:63], v[172:175], v[68:71]
    v_mfma_f32_16x16x32_bf16 v[72:75], a[64:67], v[172:175], v[72:75]
    v_mfma_f32_16x16x32_bf16 v[76:79], a[68:71], v[172:175], v[76:79]
    v_mfma_f32_16x16x32_bf16 v[80:83], a[72:75], v[172:175], v[80:83]
    buffer_load_dwordx4 v[168:171], v206, s[44:47], s91 offen sc1
    v_mfma_f32_16x16x32_bf16 v[84:87], a[76:79], v[172:175], v[84:87]
    s_waitcnt vmcnt(18)
    s_nop 0
    v_mfma_f32_16x16x32_bf16 v[8:11], a[80:83], v[176:179], v[8:11]
    v_mfma_f32_16x16x32_bf16 v[12:15], a[84:87], v[176:179], v[12:15]
    v_mfma_f32_16x16x32_bf16 v[16:19], a[88:91], v[176:179], v[16:19]
    buffer_load_dwordx4 v[172:175], v207, s[44:47], s91 offen sc1
    v_mfma_f32_16x16x32_bf16 v[20:23], a[92:95], v[176:179], v[20:23]
    v_mfma_f32_16x16x32_bf16 v[24:27], a[96:99], v[176:179], v[24:27]
    v_mfma_f32_16x16x32_bf16 v[28:31], a[80:83], v[180:183], v[28:31]
    v_mfma_f32_16x16x32_bf16 v[32:35], a[84:87], v[180:183], v[32:35]
    v_mfma_f32_16x16x32_bf16 v[36:39], a[88:91], v[180:183], v[36:39]
    s_add_u32 s91, s88, 36864
    buffer_load_dwordx4 v[176:179], v204, s[44:47], s91 offen sc1
    v_mfma_f32_16x16x32_bf16 v[40:43], a[92:95], v[180:183], v[40:43]
    v_mfma_f32_16x16x32_bf16 v[44:47], a[96:99], v[180:183], v[44:47]
    s_waitcnt vmcnt(18)
    s_nop 0
    v_mfma_f32_16x16x32_bf16 v[48:51], a[80:83], v[184:187], v[48:51]
    v_mfma_f32_16x16x32_bf16 v[52:55], a[84:87], v[184:187], v[52:55]
    buffer_load_dwordx4 v[180:183], v205, s[44:47], s91 offen sc1
    v_mfma_f32_16x16x32_bf16 v[56:59], a[88:91], v[184:187], v[56:59]
    v_mfma_f32_16x16x32_bf16 v[60:63], a[92:95], v[184:187], v[60:63]
    v_mfma_f32_16x16x32_bf16 v[64:67], a[96:99], v[184:187], v[64:67]
    v_mfma_f32_16x16x32_bf16 v[68:71], a[80:83], v[188:191], v[68:71]
    v_mfma_f32_16x16x32_bf16 v[72:75], a[84:87], v[188:191], v[72:75]
    buffer_load_dwordx4 v[184:187], v206, s[44:47], s91 offen sc1
    v_mfma_f32_16x16x32_bf16 v[76:79], a[88:91], v[188:191], v[76:79]
    v_mfma_f32_16x16x32_bf16 v[80:83], a[92:95], v[188:191], v[80:83]
    v_mfma_f32_16x16x32_bf16 v[84:87], a[96:99], v[188:191], v[84:87]
    s_waitcnt vmcnt(18)
    s_nop 0
    v_mfma_f32_16x16x32_bf16 v[8:11], a[100:103], v[112:115], v[8:11]
    v_mfma_f32_16x16x32_bf16 v[12:15], a[104:107], v[112:115], v[12:15]
    buffer_load_dwordx4 v[188:191], v207, s[44:47], s91 offen sc1
    v_mfma_f32_16x16x32_bf16 v[16:19], a[108:111], v[112:115], v[16:19]
    v_mfma_f32_16x16x32_bf16 v[20:23], a[112:115], v[112:115], v[20:23]
    v_mfma_f32_16x16x32_bf16 v[24:27], a[116:119], v[112:115], v[24:27]
    v_mfma_f32_16x16x32_bf16 v[28:31], a[100:103], v[116:119], v[28:31]
    s_add_u32 s91, s88, 40960
    buffer_load_dwordx4 v[112:115], v204, s[44:47], s91 offen sc1
    v_mfma_f32_16x16x32_bf16 v[32:35], a[104:107], v[116:119], v[32:35]
    v_mfma_f32_16x16x32_bf16 v[36:39], a[108:111], v[116:119], v[36:39]
    v_mfma_f32_16x16x32_bf16 v[40:43], a[112:115], v[116:119], v[40:43]
    v_mfma_f32_16x16x32_bf16 v[44:47], a[116:119], v[116:119], v[44:47]
    s_waitcnt vmcnt(18)
    s_nop 0
    v_mfma_f32_16x16x32_bf16 v[48:51], a[100:103], v[120:123], v[48:51]
    buffer_load_dwordx4 v[116:119], v205, s[44:47], s91 offen sc1
    v_mfma_f32_16x16x32_bf16 v[52:55], a[104:107], v[120:123], v[52:55]
    v_mfma_f32_16x16x32_bf16 v[56:59], a[108:111], v[120:123], v[56:59]
    v_mfma_f32_16x16x32_bf16 v[60:63], a[112:115], v[120:123], v[60:63]
    v_mfma_f32_16x16x32_bf16 v[64:67], a[116:119], v[120:123], v[64:67]
    buffer_load_dwordx4 v[120:123], v206, s[44:47], s91 offen sc1
    v_mfma_f32_16x16x32_bf16 v[68:71], a[100:103], v[124:127], v[68:71]
    v_mfma_f32_16x16x32_bf16 v[72:75], a[104:107], v[124:127], v[72:75]
    v_mfma_f32_16x16x32_bf16 v[76:79], a[108:111], v[124:127], v[76:79]
    v_mfma_f32_16x16x32_bf16 v[80:83], a[112:115], v[124:127], v[80:83]
    v_mfma_f32_16x16x32_bf16 v[84:87], a[116:119], v[124:127], v[84:87]
    buffer_load_dwordx4 v[124:127], v207, s[44:47], s91 offen sc1
    s_waitcnt vmcnt(19)
    s_nop 0
    v_mfma_f32_16x16x32_bf16 v[8:11], a[120:123], v[128:131], v[8:11]
    v_mfma_f32_16x16x32_bf16 v[12:15], a[124:127], v[128:131], v[12:15]
    v_mfma_f32_16x16x32_bf16 v[16:19], a[128:131], v[128:131], v[16:19]
    v_mfma_f32_16x16x32_bf16 v[20:23], a[132:135], v[128:131], v[20:23]
    v_mfma_f32_16x16x32_bf16 v[24:27], a[136:139], v[128:131], v[24:27]
    buffer_load_dwordx4 a[228:231], v1, s[44:47], s92 offen offset:2048 sc1
    v_mfma_f32_16x16x32_bf16 v[28:31], a[120:123], v[132:135], v[28:31]
    v_mfma_f32_16x16x32_bf16 v[32:35], a[124:127], v[132:135], v[32:35]
    v_mfma_f32_16x16x32_bf16 v[36:39], a[128:131], v[132:135], v[36:39]
    v_mfma_f32_16x16x32_bf16 v[40:43], a[132:135], v[132:135], v[40:43]
    buffer_load_dwordx4 a[232:235], v1, s[44:47], s92 offen offset:3072 sc1
    v_mfma_f32_16x16x32_bf16 v[44:47], a[136:139], v[132:135], v[44:47]
    s_waitcnt vmcnt(19)
    s_nop 0
    v_mfma_f32_16x16x32_bf16 v[48:51], a[120:123], v[136:139], v[48:51]
    v_mfma_f32_16x16x32_bf16 v[52:55], a[124:127], v[136:139], v[52:55]
    v_mfma_f32_16x16x32_bf16 v[56:59], a[128:131], v[136:139], v[56:59]
    v_mfma_f32_16x16x32_bf16 v[60:63], a[132:135], v[136:139], v[60:63]
    buffer_load_dwordx4 a[236:239], v2, s[44:47], s92 offen sc1
    v_mfma_f32_16x16x32_bf16 v[64:67], a[136:139], v[136:139], v[64:67]
    v_mfma_f32_16x16x32_bf16 v[68:71], a[120:123], v[140:143], v[68:71]
    v_mfma_f32_16x16x32_bf16 v[72:75], a[124:127], v[140:143], v[72:75]
    v_mfma_f32_16x16x32_bf16 v[76:79], a[128:131], v[140:143], v[76:79]
    s_add_u32 s91, s88, 45056
    buffer_load_dwordx4 v[128:131], v204, s[44:47], s91 offen sc1
    v_mfma_f32_16x16x32_bf16 v[80:83], a[132:135], v[140:143], v[80:83]
    v_mfma_f32_16x16x32_bf16 v[84:87], a[136:139], v[140:143], v[84:87]
    s_waitcnt vmcnt(19)
    s_nop 0
    v_mfma_f32_16x16x32_bf16 v[8:11], a[140:143], v[144:147], v[8:11]
    v_mfma_f32_16x16x32_bf16 v[12:15], a[144:147], v[144:147], v[12:15]
    v_mfma_f32_16x16x32_bf16 v[16:19], a[148:151], v[144:147], v[16:19]
    s_add_u32 s92, s90, 245760
    buffer_load_dwordx4 a[240:243], v1, s[44:47], s92 offen sc1
    v_mfma_f32_16x16x32_bf16 v[20:23], a[152:155], v[144:147], v[20:23]
    v_mfma_f32_16x16x32_bf16 v[24:27], a[156:159], v[144:147], v[24:27]
    v_mfma_f32_16x16x32_bf16 v[28:31], a[140:143], v[148:151], v[28:31]
    v_mfma_f32_16x16x32_bf16 v[32:35], a[144:147], v[148:151], v[32:35]
    v_mfma_f32_16x16x32_bf16 v[36:39], a[148:151], v[148:151], v[36:39]
    buffer_load_dwordx4 a[244:247], v1, s[44:47], s92 offen offset:1024 sc1
    v_mfma_f32_16x16x32_bf16 v[40:43], a[152:155], v[148:151], v[40:43]
    v_mfma_f32_16x16x32_bf16 v[44:47], a[156:159], v[148:151], v[44:47]
    s_waitcnt vmcnt(19)
    v_mfma_f32_16x16x32_bf16 v[48:51], a[140:143], v[152:155], v[48:51]
    s_add_u32 m0, s61, 0
    s_nop 0
    s_nop 0
    buffer_load_dwordx4 v208, s[36:39], s21 offen lds
    v_mfma_f32_16x16x32_bf16 v[52:55], a[144:147], v[152:155], v[52:55]
    buffer_load_dwordx4 a[248:251], v1, s[44:47], s92 offen offset:2048 sc1
    v_mfma_f32_16x16x32_bf16 v[56:59], a[148:151], v[152:155], v[56:59]
    s_add_u32 m0, s61, 1024
    s_nop 0
    buffer_load_dwordx4 v209, s[36:39], s21 offen lds
    v_mfma_f32_16x16x32_bf16 v[60:63], a[152:155], v[152:155], v[60:63]
    v_mfma_f32_16x16x32_bf16 v[64:67], a[156:159], v[152:155], v[64:67]
    s_add_u32 m0, s61, 2048
    s_nop 0
    buffer_load_dwordx4 v210, s[36:39], s21 offen lds
    v_mfma_f32_16x16x32_bf16 v[68:71], a[140:143], v[156:159], v[68:71]
    v_mfma_f32_16x16x32_bf16 v[72:75], a[144:147], v[156:159], v[72:75]
    buffer_load_dwordx4 a[252:255], v1, s[44:47], s92 offen offset:3072 sc1
    v_mfma_f32_16x16x32_bf16 v[76:79], a[148:151], v[156:159], v[76:79]
    v_mfma_f32_16x16x32_bf16 v[80:83], a[152:155], v[156:159], v[80:83]
    v_mfma_f32_16x16x32_bf16 v[84:87], a[156:159], v[156:159], v[84:87]
    s_waitcnt vmcnt(22)
    s_nop 0
    v_mfma_f32_16x16x32_bf16 v[8:11], a[160:163], v[160:163], v[8:11]
    buffer_load_dwordx4 v[232:235], v2, s[44:47], s92 offen sc1
    v_mfma_f32_16x16x32_bf16 v[12:15], a[164:167], v[160:163], v[12:15]
    v_mfma_f32_16x16x32_bf16 v[16:19], a[168:171], v[160:163], v[16:19]
    v_mfma_f32_16x16x32_bf16 v[20:23], a[172:175], v[160:163], v[20:23]
    v_mfma_f32_16x16x32_bf16 v[24:27], a[176:179], v[160:163], v[24:27]
    v_mfma_f32_16x16x32_bf16 v[28:31], a[160:163], v[164:167], v[28:31]
    s_add_u32 s91, s88, 49152
    buffer_load_dwordx4 v[144:147], v204, s[44:47], s91 offen sc1
    buffer_load_dword v224, v223, s[44:47], s25 offen sc1
    v_mfma_f32_16x16x32_bf16 v[32:35], a[164:167], v[164:167], v[32:35]
    v_mfma_f32_16x16x32_bf16 v[36:39], a[168:171], v[164:167], v[36:39]
    v_mfma_f32_16x16x32_bf16 v[40:43], a[172:175], v[164:167], v[40:43]
    v_mfma_f32_16x16x32_bf16 v[44:47], a[176:179], v[164:167], v[44:47]
    s_waitcnt vmcnt(22)
    s_nop 0
    v_mfma_f32_16x16x32_bf16 v[48:51], a[160:163], v[168:171], v[48:51]
    buffer_load_dwordx4 v[236:239], v1, s[44:47], s77 offen sc1
    v_mfma_f32_16x16x32_bf16 v[52:55], a[164:167], v[168:171], v[52:55]
    v_mfma_f32_16x16x32_bf16 v[56:59], a[168:171], v[168:171], v[56:59]
    v_mfma_f32_16x16x32_bf16 v[60:63], a[172:175], v[168:171], v[60:63]
    v_mfma_f32_16x16x32_bf16 v[64:67], a[176:179], v[168:171], v[64:67]
    buffer_load_dwordx4 v[240:243], v1, s[44:47], s77 offen offset:1024 sc1
    v_mfma_f32_16x16x32_bf16 v[68:71], a[160:163], v[172:175], v[68:71]
    v_mfma_f32_16x16x32_bf16 v[72:75], a[164:167], v[172:175], v[72:75]
    v_mfma_f32_16x16x32_bf16 v[76:79], a[168:171], v[172:175], v[76:79]
    v_mfma_f32_16x16x32_bf16 v[80:83], a[172:175], v[172:175], v[80:83]
    v_mfma_f32_16x16x32_bf16 v[84:87], a[176:179], v[172:175], v[84:87]
    buffer_load_dwordx4 v[244:247], v1, s[44:47], s77 offen offset:2048 sc1
    s_waitcnt vmcnt(23)
    s_nop 0
    v_mfma_f32_16x16x32_bf16 v[8:11], a[180:183], v[176:179], v[8:11]
    v_mfma_f32_16x16x32_bf16 v[12:15], a[184:187], v[176:179], v[12:15]
    v_mfma_f32_16x16x32_bf16 v[16:19], a[188:191], v[176:179], v[16:19]
    v_mfma_f32_16x16x32_bf16 v[20:23], a[192:195], v[176:179], v[20:23]
    buffer_load_dwordx4 v[248:251], v1, s[44:47], s77 offen offset:3072 sc1
    v_mfma_f32_16x16x32_bf16 v[24:27], a[196:199], v[176:179], v[24:27]
    v_mfma_f32_16x16x32_bf16 v[28:31], a[180:183], v[180:183], v[28:31]
    v_mfma_f32_16x16x32_bf16 v[32:35], a[184:187], v[180:183], v[32:35]
    v_mfma_f32_16x16x32_bf16 v[36:39], a[188:191], v[180:183], v[36:39]
    v_mfma_f32_16x16x32_bf16 v[40:43], a[192:195], v[180:183], v[40:43]
    buffer_load_dwordx4 v[252:255], v2, s[44:47], s77 offen sc1
    v_mfma_f32_16x16x32_bf16 v[44:47], a[196:199], v[180:183], v[44:47]
    s_waitcnt vmcnt(23)
    s_nop 0
    v_mfma_f32_16x16x32_bf16 v[48:51], a[180:183], v[184:187], v[48:51]
    v_mfma_f32_16x16x32_bf16 v[52:55], a[184:187], v[184:187], v[52:55]
    v_mfma_f32_16x16x32_bf16 v[56:59], a[188:191], v[184:187], v[56:59]
    v_mfma_f32_16x16x32_bf16 v[60:63], a[192:195], v[184:187], v[60:63]
    buffer_load_dwordx4 v[160:163], v204, s[44:47], s89 offen sc1
    v_mfma_f32_16x16x32_bf16 v[64:67], a[196:199], v[184:187], v[64:67]
    v_mfma_f32_16x16x32_bf16 v[68:71], a[180:183], v[188:191], v[68:71]
    v_mfma_f32_16x16x32_bf16 v[72:75], a[184:187], v[188:191], v[72:75]
    v_mfma_f32_16x16x32_bf16 v[76:79], a[188:191], v[188:191], v[76:79]
    s_add_u32 s91, s88, 45056
    buffer_load_dwordx4 v[132:135], v205, s[44:47], s91 offen sc1
    v_mfma_f32_16x16x32_bf16 v[80:83], a[192:195], v[188:191], v[80:83]
    v_mfma_f32_16x16x32_bf16 v[84:87], a[196:199], v[188:191], v[84:87]
    s_waitcnt vmcnt(23)
    s_nop 0
    v_mfma_f32_16x16x32_bf16 v[8:11], a[200:203], v[112:115], v[8:11]
    v_mfma_f32_16x16x32_bf16 v[12:15], a[204:207], v[112:115], v[12:15]
    v_mfma_f32_16x16x32_bf16 v[16:19], a[208:211], v[112:115], v[16:19]
    s_add_u32 s91, s88, 49152
    buffer_load_dwordx4 v[148:151], v205, s[44:47], s91 offen sc1
    v_mfma_f32_16x16x32_bf16 v[20:23], a[212:215], v[112:115], v[20:23]
    v_mfma_f32_16x16x32_bf16 v[24:27], a[216:219], v[112:115], v[24:27]
    v_mfma_f32_16x16x32_bf16 v[28:31], a[200:203], v[116:119], v[28:31]
    v_mfma_f32_16x16x32_bf16 v[32:35], a[204:207], v[116:119], v[32:35]
    buffer_load_dwordx4 v[164:167], v205, s[44:47], s89 offen sc1
    v_mfma_f32_16x16x32_bf16 v[36:39], a[208:211], v[116:119], v[36:39]
    v_mfma_f32_16x16x32_bf16 v[40:43], a[212:215], v[116:119], v[40:43]
    v_mfma_f32_16x16x32_bf16 v[44:47], a[216:219], v[116:119], v[44:47]
    s_waitcnt vmcnt(23)
    v_mfma_f32_16x16x32_bf16 v[48:51], a[200:203], v[120:123], v[48:51]
    s_waitcnt vmcnt(9)
    v_cmp_eq_u32 vcc, s76, v224
    s_nop 0
    s_cmp_eq_u64 vcc, -1
    s_cbranch_scc1 Lok_21
    s_mov_b32 s96, 0
Lsp_22:
    s_sleep 2
    buffer_load_dword v224, v223, s[44:47], s25 offen sc1
    s_waitcnt vmcnt(0)
    v_cmp_eq_u32 vcc, s76, v224
    s_nop 0
    s_cmp_eq_u64 vcc, -1
    s_cbranch_scc1 Lok_21
    s_add_u32 s96, s96, 1
    s_cmp_lt_u32 s96, 20000
    s_cbranch_scc1 Lsp_22
Lok_21:
    s_nop 0
    buffer_load_dwordx4 v[88:91], v211, s[44:47], s24 offen sc1
    buffer_load_dwordx4 v[92:95], v212, s[44:47], s24 offen sc1
    buffer_load_dwordx4 v[96:99], v213, s[44:47], s24 offen sc1
    ds_read_b128 v[100:103], v215 offset:0
    ds_read_b128 v[104:107], v215 offset:64
    ds_read_b128 v[108:111], v215 offset:128
    v_mfma_f32_16x16x32_bf16 v[52:55], a[204:207], v[120:123], v[52:55]
    s_add_u32 s91, s88, 45056
    buffer_load_dwordx4 v[136:139], v206, s[44:47], s91 offen sc1
    v_mfma_f32_16x16x32_bf16 v[56:59], a[208:211], v[120:123], v[56:59]
    v_mfma_f32_16x16x32_bf16 v[60:63], a[212:215], v[120:123], v[60:63]
    v_mfma_f32_16x16x32_bf16 v[64:67], a[216:219], v[120:123], v[64:67]
    v_mfma_f32_16x16x32_bf16 v[68:71], a[200:203], v[124:127], v[68:71]
    v_mfma_f32_16x16x32_bf16 v[72:75], a[204:207], v[124:127], v[72:75]
    s_add_u32 s91, s88, 49152
    buffer_load_dwordx4 v[152:155], v206, s[44:47], s91 offen sc1
    v_mfma_f32_16x16x32_bf16 v[76:79], a[208:211], v[124:127], v[76:79]
    v_mfma_f32_16x16x32_bf16 v[80:83], a[212:215], v[124:127], v[80:83]
    s_waitcnt lgkmcnt(0)
    v_mfma_f32_16x16x32_bf16 v[68:71], v[192:195], v[100:103], v[68:71]
    v_mfma_f32_16x16x32_bf16 v[84:87], a[216:219], v[124:127], v[84:87]
    v_mfma_f32_16x16x32_bf16 v[72:75], v[196:199], v[100:103], v[72:75]
    s_waitcnt vmcnt(8)
    v_mfma_f32_16x16x32_bf16 v[8:11], a[220:223], v[128:131], v[8:11]
    buffer_load_dwordx4 v[168:171], v206, s[44:47], s89 offen sc1
    v_mfma_f32_16x16x32_bf16 v[76:79], v[192:195], v[104:107], v[76:79]
    v_mfma_f32_16x16x32_bf16 v[12:15], a[224:227], v[128:131], v[12:15]
    v_mfma_f32_16x16x32_bf16 v[80:83], v[196:199], v[104:107], v[80:83]
    v_mfma_f32_16x16x32_bf16 v[16:19], a[228:231], v[128:131], v[16:19]
    v_mfma_f32_16x16x32_bf16 v[84:87], v[192:195], v[108:111], v[84:87]
    v_mfma_f32_16x16x32_bf16 v[20:23], a[232:235], v[128:131], v[20:23]
    v_mfma_f32_16x16x32_bf16 v[24:27], a[236:239], v[128:131], v[24:27]
    v_mfma_f32_16x16x32_bf16 v[8:11], a[240:243], v[144:147], v[8:11]
    s_add_u32 s91, s88, 45056
    buffer_load_dwordx4 v[140:143], v207, s[44:47], s91 offen sc1
    v_mfma_f32_16x16x32_bf16 v[12:15], a[244:247], v[144:147], v[12:15]
    v_mfma_f32_16x16x32_bf16 v[16:19], a[248:251], v[144:147], v[16:19]
    v_mfma_f32_16x16x32_bf16 v[20:23], a[252:255], v[144:147], v[20:23]
    v_mfma_f32_16x16x32_bf16 v[24:27], v[232:235], v[144:147], v[24:27]
    s_add_u32 s91, s88, 49152
    buffer_load_dwordx4 v[156:159], v207, s[44:47], s91 offen sc1
    v_mfma_f32_16x16x32_bf16 v[8:11], v[236:239], v[160:163], v[8:11]
    v_mfma_f32_16x16x32_bf16 v[12:15], v[240:243], v[160:163], v[12:15]
    v_mfma_f32_16x16x32_bf16 v[16:19], v[244:247], v[160:163], v[16:19]
    v_mfma_f32_16x16x32_bf16 v[20:23], v[248:251], v[160:163], v[20:23]
    v_mfma_f32_16x16x32_bf16 v[24:27], v[252:255], v[160:163], v[24:27]
    buffer_load_dwordx4 v[172:175], v207, s[44:47], s89 offen sc1
    s_waitcnt vmcnt(9)
    s_nop 0
    v_mfma_f32_16x16x32_bf16 v[28:31], a[220:223], v[132:135], v[28:31]
    v_mfma_f32_16x16x32_bf16 v[32:35], a[224:227], v[132:135], v[32:35]
    v_mfma_f32_16x16x32_bf16 v[36:39], a[228:231], v[132:135], v[36:39]
    v_mfma_f32_16x16x32_bf16 v[40:43], a[232:235], v[132:135], v[40:43]
    v_mfma_f32_16x16x32_bf16 v[44:47], a[236:239], v[132:135], v[44:47]
    ds_write_b128 v218, v[8:11] offset:0
    v_mfma_f32_16x16x32_bf16 v[28:31], a[240:243], v[148:151], v[28:31]
    v_mfma_f32_16x16x32_bf16 v[32:35], a[244:247], v[148:151], v[32:35]
    ds_write_b128 v218, v[12:15] offset:1024
    v_mfma_f32_16x16x32_bf16 v[36:39], a[248:251], v[148:151], v[36:39]
    v_mfma_f32_16x16x32_bf16 v[40:43], a[252:255], v[148:151], v[40:43]
    ds_write_b128 v218, v[16:19] offset:2048
    v_mfma_f32_16x16x32_bf16 v[44:47], v[232:235], v[148:151], v[44:47]
    v_mfma_f32_16x16x32_bf16 v[28:31], v[236:239], v[164:167], v[28:31]
    ds_write_b128 v218, v[20:23] offset:3072
    v_mfma_f32_16x16x32_bf16 v[32:35], v[240:243], v[164:167], v[32:35]
    v_mfma_f32_16x16x32_bf16 v[36:39], v[244:247], v[164:167], v[36:39]
    ds_write_b128 v218, v[24:27] offset:4096
    v_mfma_f32_16x16x32_bf16 v[40:43], v[248:251], v[164:167], v[40:43]
    v_mfma_f32_16x16x32_bf16 v[44:47], v[252:255], v[164:167], v[44:47]
    s_waitcnt vmcnt(3)
    s_nop 0
    v_mfma_f32_16x16x32_bf16 v[48:51], a[220:223], v[136:139], v[48:51]
    v_mfma_f32_16x16x32_bf16 v[52:55], a[224:227], v[136:139], v[52:55]
    v_mfma_f32_16x16x32_bf16 v[56:59], a[228:231], v[136:139], v[56:59]
    v_mfma_f32_16x16x32_bf16 v[60:63], a[232:235], v[136:139], v[60:63]
    v_mfma_f32_16x16x32_bf16 v[64:67], a[236:239], v[136:139], v[64:67]
    ds_write_b128 v218, v[28:31] offset:5120
    v_mfma_f32_16x16x32_bf16 v[48:51], a[240:243], v[152:155], v[48:51]
    v_mfma_f32_16x16x32_bf16 v[52:55], a[244:247], v[152:155], v[52:55]
    ds_write_b128 v218, v[32:35] offset:6144
    v_mfma_f32_16x16x32_bf16 v[56:59], a[248:251], v[152:155], v[56:59]
    v_mfma_f32_16x16x32_bf16 v[60:63], a[252:255], v[152:155], v[60:63]
    ds_write_b128 v218, v[36:39] offset:7168
    v_mfma_f32_16x16x32_bf16 v[64:67], v[232:235], v[152:155], v[64:67]
    v_mfma_f32_16x16x32_bf16 v[48:51], v[236:239], v[168:171], v[48:51]
    ds_write_b128 v218, v[40:43] offset:8192
    v_mfma_f32_16x16x32_bf16 v[52:55], v[240:243], v[168:171], v[52:55]
    v_mfma_f32_16x16x32_bf16 v[56:59], v[244:247], v[168:171], v[56:59]
    ds_write_b128 v218, v[44:47] offset:9216
    v_mfma_f32_16x16x32_bf16 v[60:63], v[248:251], v[168:171], v[60:63]
    v_mfma_f32_16x16x32_bf16 v[64:67], v[252:255], v[168:171], v[64:67]
    s_waitcnt vmcnt(0)
    s_nop 0
    v_mfma_f32_16x16x32_bf16 v[68:71], a[220:223], v[140:143], v[68:71]
    v_mfma_f32_16x16x32_bf16 v[72:75], a[224:227], v[140:143], v[72:75]
    v_mfma_f32_16x16x32_bf16 v[76:79], a[228:231], v[140:143], v[76:79]
    v_mfma_f32_16x16x32_bf16 v[80:83], a[232:235], v[140:143], v[80:83]
    v_mfma_f32_16x16x32_bf16 v[84:87], a[236:239], v[140:143], v[84:87]
    ds_write_b128 v218, v[48:51] offset:10240
    v_mfma_f32_16x16x32_bf16 v[68:71], a[240:243], v[156:159], v[68:71]
    ds_write_b128 v218, v[52:55] offset:11264
    v_mfma_f32_16x16x32_bf16 v[72:75], a[244:247], v[156:159], v[72:75]
    ds_write_b128 v218, v[56:59] offset:12288
    v_mfma_f32_16x16x32_bf16 v[76:79], a[248:251], v[156:159], v[76:79]
    ds_write_b128 v218, v[60:63] offset:13312
    v_mfma_f32_16x16x32_bf16 v[80:83], a[252:255], v[156:159], v[80:83]
    ds_write_b128 v218, v[64:67] offset:14336
    v_mfma_f32_16x16x32_bf16 v[84:87], v[232:235], v[156:159], v[84:87]
    ds_write_b128 v214, v[88:91]
    ds_write_b128 v214, v[92:95] offset:1280
    s_mov_b32 exec_lo, -1
    s_mov_b32 exec_hi, 0
    ds_write_b128 v214, v[96:99] offset:2560
    s_mov_b64 exec, -1
    s_waitcnt lgkmcnt(0)
    s_barrier
    s_nop 0
    ds_read_b64_tr_b16 v[88:89], v216 offset:0
    ds_read_b64_tr_b16 v[90:91], v216 offset:640
    ds_read_b64_tr_b16 v[92:93], v216 offset:5120
    ds_read_b64_tr_b16 v[94:95], v216 offset:5760
    ds_read_b64_tr_b16 v[96:97], v217 offset:10240
    ds_read_b64_tr_b16 v[98:99], v217 offset:10880
    ds_read_b128 v[8:11], v219 offset:0
    ds_read_b128 v[12:15], v219 offset:1024
    ds_read_b128 v[16:19], v219 offset:2048
    ds_read_b128 v[20:23], v219 offset:3072
    ds_read_b128 v[24:27], v219 offset:4096
    ds_read_b128 v[28:31], v220 offset:0
    ds_read_b128 v[32:35], v220 offset:1024
    ds_read_b128 v[36:39], v220 offset:2048
    ds_read_b128 v[40:43], v220 offset:3072
    ds_read_b128 v[44:47], v220 offset:4096
    ds_read_b128 v[48:51], v221 offset:0
    ds_read_b128 v[52:55], v221 offset:1024
    ds_read_b128 v[56:59], v221 offset:2048
    ds_read_b128 v[60:63], v221 offset:3072
    ds_read_b128 v[64:67], v221 offset:4096
    v_mfma_f32_16x16x32_bf16 v[68:71], v[236:239], v[172:175], v[68:71]
    v_mfma_f32_16x16x32_bf16 v[72:75], v[240:243], v[172:175], v[72:75]
    v_mfma_f32_16x16x32_bf16 v[76:79], v[244:247], v[172:175], v[76:79]
    v_mfma_f32_16x16x32_bf16 v[80:83], v[248:251], v[172:175], v[80:83]
    v_mfma_f32_16x16x32_bf16 v[84:87], v[252:255], v[172:175], v[84:87]
    v_add_u32 v214, s53, v1
    s_waitcnt lgkmcnt(15)
    v_mfma_f32_16x16x32_bf16 v[68:71], v[192:195], v[88:91], v[68:71]
    v_mfma_f32_16x16x32_bf16 v[72:75], v[196:199], v[88:91], v[72:75]
    s_waitcnt lgkmcnt(15)
    v_mfma_f32_16x16x32_bf16 v[76:79], v[192:195], v[92:95], v[76:79]
    v_mfma_f32_16x16x32_bf16 v[80:83], v[196:199], v[92:95], v[80:83]
    s_waitcnt lgkmcnt(15)
    v_mfma_f32_16x16x32_bf16 v[84:87], v[192:195], v[96:99], v[84:87]
    s_waitcnt lgkmcnt(5)
    s_nop 0
    v_pk_add_f32 v[8:9], v[8:9], v[28:29]
    v_pk_add_f32 v[10:11], v[10:11], v[30:31]
    v_pk_add_f32 v[12:13], v[12:13], v[32:33]
    v_pk_add_f32 v[14:15], v[14:15], v[34:35]
    v_pk_add_f32 v[16:17], v[16:17], v[36:37]
    v_pk_add_f32 v[18:19], v[18:19], v[38:39]
    v_pk_add_f32 v[20:21], v[20:21], v[40:41]
    v_pk_add_f32 v[22:23], v[22:23], v[42:43]
    v_pk_add_f32 v[24:25], v[24:25], v[44:45]
    v_pk_add_f32 v[26:27], v[26:27], v[46:47]
    s_waitcnt lgkmcnt(0)
    s_nop 0
    v_pk_add_f32 v[8:9], v[8:9], v[48:49]
    v_pk_add_f32 v[10:11], v[10:11], v[50:51]
    v_pk_add_f32 v[12:13], v[12:13], v[52:53]
    v_pk_add_f32 v[14:15], v[14:15], v[54:55]
    v_pk_add_f32 v[16:17], v[16:17], v[56:57]
    v_pk_add_f32 v[18:19], v[18:19], v[58:59]
    v_pk_add_f32 v[20:21], v[20:21], v[60:61]
    v_pk_add_f32 v[22:23], v[22:23], v[62:63]
    v_pk_add_f32 v[24:25], v[24:25], v[64:65]
    v_pk_add_f32 v[26:27], v[26:27], v[66:67]
    v_pk_add_f32 v[8:9], v[8:9], v[68:69]
    v_pk_add_f32 v[10:11], v[10:11], v[70:71]
    v_pk_add_f32 v[12:13], v[12:13], v[72:73]
    v_pk_add_f32 v[14:15], v[14:15], v[74:75]
    v_pk_add_f32 v[16:17], v[16:17], v[76:77]
    v_pk_add_f32 v[18:19], v[18:19], v[78:79]
    v_pk_add_f32 v[20:21], v[20:21], v[80:81]
    v_pk_add_f32 v[22:23], v[22:23], v[82:83]
    v_pk_add_f32 v[24:25], v[24:25], v[84:85]
    v_pk_add_f32 v[26:27], v[26:27], v[86:87]
    v_cvt_pk_bf16_f32 v88, v8, v9
    v_cvt_pk_bf16_f32 v89, v10, v11
    ds_write_b64 v222, v[88:89] offset:0
    v_cvt_pk_bf16_f32 v90, v12, v13
    v_cvt_pk_bf16_f32 v91, v14, v15
    ds_write_b64 v222, v[90:91] offset:32
    v_cvt_pk_bf16_f32 v92, v16, v17
    v_cvt_pk_bf16_f32 v93, v18, v19
    ds_write_b64 v222, v[92:93] offset:64
    v_cvt_pk_bf16_f32 v94, v20, v21
    v_cvt_pk_bf16_f32 v95, v22, v23
    ds_write_b64 v222, v[94:95] offset:96
    v_cvt_pk_bf16_f32 v96, v24, v25
    v_cvt_pk_bf16_f32 v97, v26, v27
    ds_write_b64 v222, v[96:97] offset:128
    ds_read_b128 v[100:103], v214 offset:0
    ds_read_b128 v[104:107], v214 offset:1024
    ds_read_b128 v[108:111], v214 offset:2048
    s_waitcnt lgkmcnt(2)
    buffer_store_dwordx4 v[100:103], v208, s[48:51], s21 offen
    s_waitcnt lgkmcnt(1)
    buffer_store_dwordx4 v[104:107], v209, s[48:51], s21 offen
    s_waitcnt lgkmcnt(0)
    buffer_store_dwordx4 v[108:111], v210, s[48:51], s21 offen
    s_or_b32 s56, s2, s3
    s_cmp_lg_u32 s56, 0
    s_cbranch_scc1 Lep_23
    v_lshrrev_b32 v8, 4, v0
    v_lshlrev_b32 v8, 13, v8
    v_and_b32 v9, 15, v0
    v_min_u32 v9, 13, v9
    v_lshl_add_u32 v8, v9, 8, v8
    s_mov_b32 s78, 4096
    s_mov_b32 s79, 14680064
    buffer_load_dword v12, v8, s[44:47], s79 offen sc1
    s_mov_b32 s79, 14712832
    buffer_load_dword v13, v8, s[44:47], s79 offen sc1
    s_mov_b32 s79, 14745600
    buffer_load_dword v14, v8, s[44:47], s79 offen sc1
    s_mov_b32 s79, 14778368
    buffer_load_dword v15, v8, s[44:47], s79 offen sc1
    v_min_u32 v16, 31, v0
    v_lshlrev_b32 v16, 7, v16
    buffer_load_dword v16, v16, s[44:47], s78 offen sc1
    s_waitcnt vmcnt(0)
    v_cmp_eq_u32 vcc, s76, v16
    v_cmp_eq_u32 s[56:57], s76, v12
    s_nop 0
    s_and_b64 vcc, vcc, s[56:57]
    v_cmp_eq_u32 s[56:57], s76, v13
    s_nop 0
    s_and_b64 vcc, vcc, s[56:57]
    v_cmp_eq_u32 s[56:57], s76, v14
    s_nop 0
    s_and_b64 vcc, vcc, s[56:57]
    v_cmp_eq_u32 s[56:57], s76, v15
    s_nop 0
    s_and_b64 vcc, vcc, s[56:57]
    s_cmp_eq_u64 vcc, -1
    s_cbranch_scc1 Lok_24
    s_mov_b32 s96, 0
Lsp_25:
    s_sleep 2
    s_mov_b32 s79, 14680064
    buffer_load_dword v12, v8, s[44:47], s79 offen sc1
    s_mov_b32 s79, 14712832
    buffer_load_dword v13, v8, s[44:47], s79 offen sc1
    s_mov_b32 s79, 14745600
    buffer_load_dword v14, v8, s[44:47], s79 offen sc1
    s_mov_b32 s79, 14778368
    buffer_load_dword v15, v8, s[44:47], s79 offen sc1
    v_min_u32 v16, 31, v0
    v_lshlrev_b32 v16, 7, v16
    buffer_load_dword v16, v16, s[44:47], s78 offen sc1
    s_waitcnt vmcnt(0)
    v_cmp_eq_u32 vcc, s76, v16
    v_cmp_eq_u32 s[56:57], s76, v12
    s_nop 0
    s_and_b64 vcc, vcc, s[56:57]
    v_cmp_eq_u32 s[56:57], s76, v13
    s_nop 0
    s_and_b64 vcc, vcc, s[56:57]
    v_cmp_eq_u32 s[56:57], s76, v14
    s_nop 0
    s_and_b64 vcc, vcc, s[56:57]
    v_cmp_eq_u32 s[56:57], s76, v15
    s_nop 0
    s_and_b64 vcc, vcc, s[56:57]
    s_cmp_eq_u64 vcc, -1
    s_cbranch_scc1 Lok_24
    s_add_u32 s96, s96, 1
    s_cmp_lt_u32 s96, 20000
    s_cbranch_scc1 Lsp_25
Lok_24:
    v_mov_b32_e64 v8, s76
    v_mov_b32 v9, 0
    s_mov_b64 exec, 1
    buffer_store_dword v8, v9, s[44:47], 0 offen sc1
    s_mov_b64 exec, -1
Lep_23:
L_fin:
    s_endpgm
L_F:
    s_lshl_b32 s61, s34, 2
    s_add_u32 s61, s61, s35
    s_and_b32 s56, s34, 1
    s_lshr_b32 s57, s34, 1
    s_lshl_b32 s57, s57, 2
    s_add_u32 s57, s57, s35
    s_mul_i32 s62, s56, 14
    s_add_u32 s62, s62, s57
    s_sub_u32 s56, 14, s56
    s_cmp_lt_u32 s57, s56
    s_cselect_b32 s62, s62, 0
    s_cselect_b32 s63, 0, 0x80000000
    s_and_b32 s64, s3, 1
    s_lshl_b32 s64, s64, 2
    v_lshrrev_b32 v2, 4, v0
    v_and_b32 v3, 15, v0
    v_xor_b32 v8, v3, v2
    v_xor_b32_e64 v8, s64, v8
    v_mul_u32_u24 v9, 1280, v2
    v_xor_b32_e64 v14, 0, v8
    v_lshl_add_u32 v14, v14, 4, v9
    v_add_u32 v10, 0, v14
    v_xor_b32 v14, 4, v8
    v_lshl_add_u32 v14, v14, 4, v9
    v_add_u32 v11, 5120, v14
    v_xor_b32_e64 v14, 8, v8
    v_lshl_add_u32 v14, v14, 4, v9
    v_add_u32 v12, 10240, v14
    v_xor_b32_e64 v14, 12, v8
    v_lshl_add_u32 v14, v14, 4, v9
    v_add_u32 v13, 15360, v14
    s_lshl_b32 s56, s61, 2
    s_add_u32 s56, s56, s3
    s_mul_i32 s56, s56, 20480
    s_mul_i32 s65, s3, 20480
    s_waitcnt lgkmcnt(0)
    s_mov_b32 s36, s4
    s_mov_b32 s37, s5
    s_mov_b32 s38, 2621440
    s_mov_b32 s39, 0x20000
    s_mov_b32 s40, s20
    s_mov_b32 s41, s21
    s_mov_b32 s42, 2211840
    s_mov_b32 s43, 0x20000
    s_add_u32 m0, s65, 0
    s_add_u32 s57, s56, 0
    buffer_load_dwordx4 v10, s[36:39], s57 offen lds
    s_add_u32 m0, s65, 1024
    s_nop 0
    buffer_load_dwordx4 v11, s[36:39], s57 offen lds
    s_add_u32 m0, s65, 2048
    s_nop 0
    buffer_load_dwordx4 v12, s[36:39], s57 offen lds
    s_add_u32 m0, s65, 3072
    s_nop 0
    buffer_load_dwordx4 v13, s[36:39], s57 offen lds
    s_add_u32 m0, s65, 4096
    s_add_u32 s57, s56, 256
    buffer_load_dwordx4 v10, s[36:39], s57 offen lds
    s_add_u32 m0, s65, 5120
    s_nop 0
    buffer_load_dwordx4 v11, s[36:39], s57 offen lds
    s_add_u32 m0, s65, 6144
    s_nop 0
    buffer_load_dwordx4 v12, s[36:39], s57 offen lds
    s_add_u32 m0, s65, 7168
    s_nop 0
    s_nop 0
    buffer_load_dwordx4 v13, s[36:39], s57 offen lds
    s_add_u32 m0, s65, 8192
    s_add_u32 s57, s56, 512
    buffer_load_dwordx4 v10, s[36:39], s57 offen lds
    s_add_u32 m0, s65, 9216
    s_nop 0
    buffer_load_dwordx4 v11, s[36:39], s57 offen lds
    s_add_u32 m0, s65, 10240
    s_nop 0
    buffer_load_dwordx4 v12, s[36:39], s57 offen lds
    s_add_u32 m0, s65, 11264
    s_nop 0
    s_nop 0
    buffer_load_dwordx4 v13, s[36:39], s57 offen lds
    s_add_u32 m0, s65, 12288
    s_add_u32 s57, s56, 768
    buffer_load_dwordx4 v10, s[36:39], s57 offen lds
    s_add_u32 m0, s65, 13312
    s_nop 0
    buffer_load_dwordx4 v11, s[36:39], s57 offen lds
    s_add_u32 m0, s65, 14336
    s_nop 0
    buffer_load_dwordx4 v12, s[36:39], s57 offen lds
    s_add_u32 m0, s65, 15360
    s_nop 0
    s_nop 0
    buffer_load_dwordx4 v13, s[36:39], s57 offen lds
    s_add_u32 m0, s65, 16384
    s_add_u32 s57, s56, 1024
    buffer_load_dwordx4 v10, s[36:39], s57 offen lds
    s_add_u32 m0, s65, 17408
    s_nop 0
    buffer_load_dwordx4 v11, s[36:39], s57 offen lds
    s_add_u32 m0, s65, 18432
    s_nop 0
    buffer_load_dwordx4 v12, s[36:39], s57 offen lds
    s_add_u32 m0, s65, 19456
    s_nop 0
    buffer_load_dwordx4 v13, s[36:39], s57 offen lds
    s_branch L_F2
L_F2:
    s_mov_b32 s44, s32
    s_mov_b32 s45, s33
    s_mov_b32 s46, 14942208
    s_mov_b32 s47, 0x20000
    s_mov_b32 s48, s28
    s_mov_b32 s49, s29
    s_mov_b32 s50, 2621440
    s_mov_b32 s51, 0x20000
    v_mov_b32_e64 v254, 0
    buffer_load_dword v254, v254, s[44:47], 0 offen sc1
    v_lshrrev_b32 v14, 3, v0
    v_and_b32 v15, 7, v0
    v_mul_u32_u24 v14, 3456, v14
    v_lshl_add_u32 v61, v15, 4, v14
    s_mul_i32 s56, s3, 552960
    s_lshl_b32 s57, s62, 7
    s_add_u32 s56, s56, s57
    s_or_b32 s80, s56, s63
    s_lshl_b32 s56, s62, 7
    v_lshl_add_u32 v15, v0, 1, s56
    global_load_ushort v15, v15, s[22:23]
    v_xor_b32 v8, s64, v3
    v_xor_b32 v8, v8, v2
    v_lshlrev_b32 v9, 8, v3
    v_add_u32 v9, s65, v9
    v_xor_b32_e64 v14, 0, v8
    v_lshl_add_u32 v16, v14, 4, v9
    v_xor_b32_e64 v14, 4, v8
    v_lshl_add_u32 v17, v14, 4, v9
    v_xor_b32_e64 v14, 8, v8
    v_lshl_add_u32 v18, v14, 4, v9
    v_xor_b32_e64 v14, 12, v8
    v_lshl_add_u32 v19, v14, 4, v9
    s_mov_b32 s66, 0x3f803f80
    v_mov_b32 v20, 0
    v_mov_b32 v21, 0
    v_mov_b32 v22, 0
    v_mov_b32 v23, 0
    v_mov_b32 v24, 0
    v_mov_b32 v25, 0
    v_mov_b32_e64 v26, 0
    v_mov_b32 v27, 0
    s_waitcnt vmcnt(18)
    ds_read_b128 v[160:163], v16 offset:0
    ds_read_b128 v[164:167], v17 offset:0
    ds_read_b128 v[168:171], v18 offset:0
    ds_read_b128 v[172:175], v19 offset:0
    s_waitcnt vmcnt(14)
    ds_read_b128 v[176:179], v16 offset:4096
    ds_read_b128 v[180:183], v17 offset:4096
    ds_read_b128 v[184:187], v18 offset:4096
    ds_read_b128 v[188:191], v19 offset:4096
    s_waitcnt lgkmcnt(7)
    v_dot2_f32_bf16 v20, v160, s66, v20
    v_dot2_f32_bf16 v24, v160, v160, v24
    v_dot2_f32_bf16 v21, v161, s66, v21
    v_dot2_f32_bf16 v25, v161, v161, v25
    v_dot2_f32_bf16 v22, v162, s66, v22
    v_dot2_f32_bf16 v26, v162, v162, v26
    v_dot2_f32_bf16 v23, v163, s66, v23
    v_dot2_f32_bf16 v27, v163, v163, v27
    s_waitcnt lgkmcnt(6)
    s_nop 0
    v_dot2_f32_bf16 v20, v164, s66, v20
    v_dot2_f32_bf16 v24, v164, v164, v24
    v_dot2_f32_bf16 v21, v165, s66, v21
    v_dot2_f32_bf16 v25, v165, v165, v25
    v_dot2_f32_bf16 v22, v166, s66, v22
    v_dot2_f32_bf16 v26, v166, v166, v26
    v_dot2_f32_bf16 v23, v167, s66, v23
    v_dot2_f32_bf16 v27, v167, v167, v27
    s_waitcnt lgkmcnt(5)
    s_nop 0
    v_dot2_f32_bf16 v20, v168, s66, v20
    v_dot2_f32_bf16 v24, v168, v168, v24
    v_dot2_f32_bf16 v21, v169, s66, v21
    v_dot2_f32_bf16 v25, v169, v169, v25
    v_dot2_f32_bf16 v22, v170, s66, v22
    v_dot2_f32_bf16 v26, v170, v170, v26
    v_dot2_f32_bf16 v23, v171, s66, v23
    v_dot2_f32_bf16 v27, v171, v171, v27
    s_waitcnt lgkmcnt(4)
    s_nop 0
    v_dot2_f32_bf16 v20, v172, s66, v20
    v_dot2_f32_bf16 v24, v172, v172, v24
    v_dot2_f32_bf16 v21, v173, s66, v21
    v_dot2_f32_bf16 v25, v173, v173, v25
    v_dot2_f32_bf16 v22, v174, s66, v22
    v_dot2_f32_bf16 v26, v174, v174, v26
    v_dot2_f32_bf16 v23, v175, s66, v23
    v_dot2_f32_bf16 v27, v175, v175, v27
    s_waitcnt vmcnt(10)
    ds_read_b128 v[160:163], v16 offset:8192
    ds_read_b128 v[164:167], v17 offset:8192
    ds_read_b128 v[168:171], v18 offset:8192
    ds_read_b128 v[172:175], v19 offset:8192
    s_waitcnt lgkmcnt(7)
    v_dot2_f32_bf16 v20, v176, s66, v20
    v_dot2_f32_bf16 v24, v176, v176, v24
    v_dot2_f32_bf16 v21, v177, s66, v21
    v_dot2_f32_bf16 v25, v177, v177, v25
    v_dot2_f32_bf16 v22, v178, s66, v22
    v_dot2_f32_bf16 v26, v178, v178, v26
    v_dot2_f32_bf16 v23, v179, s66, v23
    v_dot2_f32_bf16 v27, v179, v179, v27
    s_waitcnt lgkmcnt(6)
    s_nop 0
    v_dot2_f32_bf16 v20, v180, s66, v20
    v_dot2_f32_bf16 v24, v180, v180, v24
    v_dot2_f32_bf16 v21, v181, s66, v21
    v_dot2_f32_bf16 v25, v181, v181, v25
    v_dot2_f32_bf16 v22, v182, s66, v22
    v_dot2_f32_bf16 v26, v182, v182, v26
    v_dot2_f32_bf16 v23, v183, s66, v23
    v_dot2_f32_bf16 v27, v183, v183, v27
    s_add_u32 s57, s80, 0
    buffer_load_dwordx4 v[64:67], v61, s[40:43], s57 offen
    s_waitcnt lgkmcnt(5)
    v_dot2_f32_bf16 v20, v184, s66, v20
    v_dot2_f32_bf16 v24, v184, v184, v24
    v_dot2_f32_bf16 v21, v185, s66, v21
    v_dot2_f32_bf16 v25, v185, v185, v25
    v_dot2_f32_bf16 v22, v186, s66, v22
    v_dot2_f32_bf16 v26, v186, v186, v26
    v_dot2_f32_bf16 v23, v187, s66, v23
    v_dot2_f32_bf16 v27, v187, v187, v27
    s_waitcnt lgkmcnt(4)
    s_nop 0
    v_dot2_f32_bf16 v20, v188, s66, v20
    v_dot2_f32_bf16 v24, v188, v188, v24
    v_dot2_f32_bf16 v21, v189, s66, v21
    v_dot2_f32_bf16 v25, v189, v189, v25
    v_dot2_f32_bf16 v22, v190, s66, v22
    v_dot2_f32_bf16 v26, v190, v190, v26
    v_dot2_f32_bf16 v23, v191, s66, v23
    v_dot2_f32_bf16 v27, v191, v191, v27
    s_add_u32 s57, s80, 27648
    buffer_load_dwordx4 v[68:71], v61, s[40:43], s57 offen
    s_waitcnt vmcnt(8)
    ds_read_b128 v[176:179], v16 offset:12288
    ds_read_b128 v[180:183], v17 offset:12288
    ds_read_b128 v[184:187], v18 offset:12288
    ds_read_b128 v[188:191], v19 offset:12288
    s_waitcnt lgkmcnt(7)
    v_dot2_f32_bf16 v20, v160, s66, v20
    v_dot2_f32_bf16 v24, v160, v160, v24
    v_dot2_f32_bf16 v21, v161, s66, v21
    v_dot2_f32_bf16 v25, v161, v161, v25
    v_dot2_f32_bf16 v22, v162, s66, v22
    v_dot2_f32_bf16 v26, v162, v162, v26
    v_dot2_f32_bf16 v23, v163, s66, v23
    v_dot2_f32_bf16 v27, v163, v163, v27
    s_add_u32 s57, s80, 55296
    buffer_load_dwordx4 v[72:75], v61, s[40:43], s57 offen
    s_waitcnt lgkmcnt(6)
    s_nop 0
    v_dot2_f32_bf16 v20, v164, s66, v20
    v_dot2_f32_bf16 v24, v164, v164, v24
    v_dot2_f32_bf16 v21, v165, s66, v21
    v_dot2_f32_bf16 v25, v165, v165, v25
    v_dot2_f32_bf16 v22, v166, s66, v22
    v_dot2_f32_bf16 v26, v166, v166, v26
    v_dot2_f32_bf16 v23, v167, s66, v23
    v_dot2_f32_bf16 v27, v167, v167, v27
    s_add_u32 s57, s80, 82944
    buffer_load_dwordx4 v[76:79], v61, s[40:43], s57 offen
    s_waitcnt lgkmcnt(5)
    s_nop 0
    v_dot2_f32_bf16 v20, v168, s66, v20
    v_dot2_f32_bf16 v24, v168, v168, v24
    v_dot2_f32_bf16 v21, v169, s66, v21
    v_dot2_f32_bf16 v25, v169, v169, v25
    v_dot2_f32_bf16 v22, v170, s66, v22
    v_dot2_f32_bf16 v26, v170, v170, v26
    v_dot2_f32_bf16 v23, v171, s66, v23
    v_dot2_f32_bf16 v27, v171, v171, v27
    s_add_u32 s57, s80, 110592
    buffer_load_dwordx4 v[80:83], v61, s[40:43], s57 offen
    s_waitcnt lgkmcnt(4)
    s_nop 0
    v_dot2_f32_bf16 v20, v172, s66, v20
    v_dot2_f32_bf16 v24, v172, v172, v24
    v_dot2_f32_bf16 v21, v173, s66, v21
    v_dot2_f32_bf16 v25, v173, v173, v25
    v_dot2_f32_bf16 v22, v174, s66, v22
    v_dot2_f32_bf16 v26, v174, v174, v26
    v_dot2_f32_bf16 v23, v175, s66, v23
    v_dot2_f32_bf16 v27, v175, v175, v27
    s_add_u32 s57, s80, 138240
    buffer_load_dwordx4 v[84:87], v61, s[40:43], s57 offen
    s_waitcnt vmcnt(8)
    ds_read_b128 v[160:163], v16 offset:16384
    ds_read_b128 v[164:167], v17 offset:16384
    ds_read_b128 v[168:171], v18 offset:16384
    ds_read_b128 v[172:175], v19 offset:16384
    s_waitcnt lgkmcnt(7)
    v_dot2_f32_bf16 v20, v176, s66, v20
    v_dot2_f32_bf16 v24, v176, v176, v24
    v_dot2_f32_bf16 v21, v177, s66, v21
    v_dot2_f32_bf16 v25, v177, v177, v25
    v_dot2_f32_bf16 v22, v178, s66, v22
    v_dot2_f32_bf16 v26, v178, v178, v26
    v_dot2_f32_bf16 v23, v179, s66, v23
    v_dot2_f32_bf16 v27, v179, v179, v27
    s_add_u32 s57, s80, 165888
    buffer_load_dwordx4 v[88:91], v61, s[40:43], s57 offen
    s_waitcnt lgkmcnt(6)
    s_nop 0
    v_dot2_f32_bf16 v20, v180, s66, v20
    v_dot2_f32_bf16 v24, v180, v180, v24
    v_dot2_f32_bf16 v21, v181, s66, v21
    v_dot2_f32_bf16 v25, v181, v181, v25
    v_dot2_f32_bf16 v22, v182, s66, v22
    v_dot2_f32_bf16 v26, v182, v182, v26
    v_dot2_f32_bf16 v23, v183, s66, v23
    v_dot2_f32_bf16 v27, v183, v183, v27
    s_add_u32 s57, s80, 193536
    buffer_load_dwordx4 v[92:95], v61, s[40:43], s57 offen
    s_waitcnt lgkmcnt(5)
    s_nop 0
    v_dot2_f32_bf16 v20, v184, s66, v20
    v_dot2_f32_bf16 v24, v184, v184, v24
    v_dot2_f32_bf16 v21, v185, s66, v21
    v_dot2_f32_bf16 v25, v185, v185, v25
    v_dot2_f32_bf16 v22, v186, s66, v22
    v_dot2_f32_bf16 v26, v186, v186, v26
    v_dot2_f32_bf16 v23, v187, s66, v23
    v_dot2_f32_bf16 v27, v187, v187, v27
    s_add_u32 s57, s80, 221184
    buffer_load_dwordx4 v[96:99], v61, s[40:43], s57 offen
    s_waitcnt lgkmcnt(4)
    s_nop 0
    v_dot2_f32_bf16 v20, v188, s66, v20
    v_dot2_f32_bf16 v24, v188, v188, v24
    v_dot2_f32_bf16 v21, v189, s66, v21
    v_dot2_f32_bf16 v25, v189, v189, v25
    v_dot2_f32_bf16 v22, v190, s66, v22
    v_dot2_f32_bf16 v26, v190, v190, v26
    v_dot2_f32_bf16 v23, v191, s66, v23
    v_dot2_f32_bf16 v27, v191, v191, v27
    s_add_u32 s57, s80, 248832
    buffer_load_dwordx4 v[100:103], v61, s[40:43], s57 offen
    s_waitcnt lgkmcnt(3)
    s_nop 0
    v_dot2_f32_bf16 v20, v160, s66, v20
    v_dot2_f32_bf16 v24, v160, v160, v24
    v_dot2_f32_bf16 v21, v161, s66, v21
    v_dot2_f32_bf16 v25, v161, v161, v25
    v_dot2_f32_bf16 v22, v162, s66, v22
    v_dot2_f32_bf16 v26, v162, v162, v26
    v_dot2_f32_bf16 v23, v163, s66, v23
    v_dot2_f32_bf16 v27, v163, v163, v27
    s_add_u32 s57, s80, 276480
    buffer_load_dwordx4 v[104:107], v61, s[40:43], s57 offen
    s_waitcnt lgkmcnt(2)
    s_nop 0
    v_dot2_f32_bf16 v20, v164, s66, v20
    v_dot2_f32_bf16 v24, v164, v164, v24
    v_dot2_f32_bf16 v21, v165, s66, v21
    v_dot2_f32_bf16 v25, v165, v165, v25
    v_dot2_f32_bf16 v22, v166, s66, v22
    v_dot2_f32_bf16 v26, v166, v166, v26
    v_dot2_f32_bf16 v23, v167, s66, v23
    v_dot2_f32_bf16 v27, v167, v167, v27
    s_add_u32 s57, s80, 304128
    buffer_load_dwordx4 v[108:111], v61, s[40:43], s57 offen
    s_waitcnt lgkmcnt(1)
    s_nop 0
    v_dot2_f32_bf16 v20, v168, s66, v20
    v_dot2_f32_bf16 v24, v168, v168, v24
    v_dot2_f32_bf16 v21, v169, s66, v21
    v_dot2_f32_bf16 v25, v169, v169, v25
    v_dot2_f32_bf16 v22, v170, s66, v22
    v_dot2_f32_bf16 v26, v170, v170, v26
    v_dot2_f32_bf16 v23, v171, s66, v23
    v_dot2_f32_bf16 v27, v171, v171, v27
    s_add_u32 s57, s80, 331776
    buffer_load_dwordx4 v[112:115], v61, s[40:43], s57 offen
    s_waitcnt lgkmcnt(0)
    s_nop 0
    v_dot2_f32_bf16 v20, v172, s66, v20
    v_dot2_f32_bf16 v24, v172, v172, v24
    v_dot2_f32_bf16 v21, v173, s66, v21
    v_dot2_f32_bf16 v25, v173, v173, v25
    v_dot2_f32_bf16 v22, v174, s66, v22
    v_dot2_f32_bf16 v26, v174, v174, v26
    v_dot2_f32_bf16 v23, v175, s66, v23
    v_dot2_f32_bf16 v27, v175, v175, v27
    s_add_u32 s57, s80, 359424
    buffer_load_dwordx4 v[116:119], v61, s[40:43], s57 offen
    v_add_f32 v20, v20, v21
    v_add_f32 v22, v22, v23
    v_add_f32 v24, v24, v25
    v_add_f32 v26, v26, v27
    v_add_f32 v20, v20, v22
    v_add_f32 v21, v24, v26
    v_mov_b32 v22, v20
    s_nop 1
    v_permlane16_swap_b32 v20, v22
    v_add_f32 v20, v20, v22
    v_mov_b32 v23, v21
    s_nop 1
    v_permlane16_swap_b32 v21, v23
    v_add_f32 v21, v21, v23
    v_mov_b32 v22, v20
    s_nop 1
    v_permlane32_swap_b32 v20, v22
    v_add_f32 v20, v20, v22
    v_mov_b32 v23, v21
    s_nop 1
    v_permlane32_swap_b32 v21, v23
    v_add_f32 v21, v21, v23
    v_mul_f32 v20, 0x3acccccd, v20
    v_mul_f32 v21, 0x3acccccd, v21
    v_fma_f32 v21, -v20, v20, v21
    v_max_f32_e64 v21, 0, v21
    v_cvt_pk_bf16_f32 v22, v20, v20
    v_and_b32 v22, 0xffff0000, v22
    v_cvt_pk_bf16_f32 v23, v21, v21
    v_and_b32 v23, 0xffff0000, v23
    v_add_f32 v23, 0x3727c5ac, v23
    v_cvt_pk_bf16_f32 v23, v23, v23
    v_and_b32 v23, 0xffff0000, v23
    v_sqrt_f32 v23, v23
    s_nop 0
    v_cvt_pk_bf16_f32 v23, v23, v23
    v_and_b32 v23, 0xffff0000, v23
    v_rcp_f32 v24, v23
    v_sub_f32 v25, v20, v22
    v_mul_f32 v25, v25, v24
    v_mul_f32 v26, v21, v24
    v_mul_f32 v26, v26, v24
    v_mul_f32 v27, v22, v24
    v_sub_f32_e64 v27, 0, v27
    v_cvt_pk_bf16_f32 v25, v25, v25
    v_and_b32 v25, 0xffff0000, v25
    v_cvt_pk_bf16_f32 v26, v26, v26
    v_and_b32 v26, 0xffff0000, v26
    v_add_f32 v26, 0x3727c5ac, v26
    v_cvt_pk_bf16_f32 v26, v26, v26
    v_and_b32 v26, 0xffff0000, v26
    v_sqrt_f32 v26, v26
    s_nop 0
    v_cvt_pk_bf16_f32 v26, v26, v26
    v_and_b32 v26, 0xffff0000, v26
    v_mul_f32_e64 v26, v26, v23
    v_fma_f32 v25, v25, v23, v22
    v_rcp_f32_e64 v31, v26
    v_cvt_pk_bf16_f32 v22, v25, v25
    v_and_b32 v22, 0xffff0000, v22
    s_waitcnt vmcnt(15)
    v_readfirstlane_b32 s76, v254
    s_nop 0
    s_nop 0
    s_mul_i32 s76, s76, 0x19660d
    s_add_u32 s76, s76, 0x3c6ef35f
    v_sub_f32_e64 v25, v25, v22
    v_cvt_pk_bf16_f32 v28, -v22, -v25
    v_mov_b32_e64 v29, s76
    v_cvt_pk_bf16_f32 v22, v26, v26
    v_and_b32 v22, 0xffff0000, v22
    v_sub_f32_e64 v26, v26, v22
    v_cvt_pk_bf16_f32 v30, v22, v26
    s_lshl_b32 s56, s61, 2
    s_add_u32 s56, s56, s3
    s_lshl_b32 s56, s56, 8
    s_add_u32 s56, s56, 32768
    s_lshl_b32 s57, s3, 6
    v_lshl_add_u32 v22, v0, 2, s57
    s_mov_b64 exec, 0xffff
    buffer_store_dwordx4 v[28:31], v1, s[44:47], s56 offen sc1
    v_add_u32 v22, 81920, v22
    ds_write_b32 v22, v24
    ds_write_b32 v22, v27 offset:256
    s_mov_b64 exec, -1
    s_waitcnt lgkmcnt(0)
    s_barrier
    s_nop 0
    v_bfe_u32 v23, v0, 2, 3
    v_lshlrev_b32_e64 v23, 5, v23
    v_add_u32 v23, 81920, v23
    ds_read_b128 v[44:47], v23 offset:0
    ds_read_b128 v[48:51], v23 offset:16
    ds_read_b128 v[52:55], v23 offset:256
    ds_read_b128 v[56:59], v23 offset:272
    s_lshl_b32 s59, s35, 1
    s_mov_b32 s60, s35
    s_lshr_b32 s56, s34, 1
    s_lshl_b32 s56, s56, 3
    s_add_u32 s59, s59, s56
    s_and_b32 s56, s34, 1
    s_lshl_b32 s56, s56, 2
    s_add_u32 s60, s60, s56
    s_mul_i32 s79, s3, 2048
    s_add_u32 s79, s79, 8192
    v_bfe_u32 v8, v0, 2, 2
    v_and_b32_e64 v9, 1, v0
    v_lshl_add_u32 v8, v9, 3, v8
    v_bfe_u32 v9, v0, 4, 1
    v_bfe_u32 v22, v0, 1, 1
    v_lshl_add_u32 v9, v9, 1, v22
    v_lshlrev_b32 v14, 2, v22
    v_xor_b32 v14, v14, v8
    v_xor_b32_e64 v14, s3, v14
    v_mul_u32_u24 v9, 20480, v9
    v_lshl_add_u32 v9, v8, 8, v9
    v_lshrrev_b32_e64 v22, 5, v0
    v_lshl_add_u32 v9, v22, 3, v9
    v_and_b32 v24, 31, v0
    v_lshlrev_b32 v24, 4, v24
    v_lshl_add_u32 v24, v22, 14, v24
    s_lshl_b32 s81, s3, 15
    s_lshl_b32 s57, s61, 9
    s_add_u32 s81, s81, s57
    s_nop 0
    s_add_u32 s81, s81, 131072
    v_xor_b32_e64 v22, 0, v14
    v_lshl_add_u32 v16, v22, 4, v9
    v_xor_b32_e64 v22, 4, v14
    v_lshl_add_u32 v17, v22, 4, v9
    v_xor_b32_e64 v22, 8, v14
    v_lshl_add_u32 v18, v22, 4, v9
    v_xor_b32_e64 v22, 12, v14
    v_lshl_add_u32 v19, v22, 4, v9
    ds_read_b64_tr_b16 v[160:161], v16 offset:0
    ds_read_b64_tr_b16 v[162:163], v17 offset:1024
    ds_read_b64_tr_b16 v[164:165], v17 offset:0
    ds_read_b64_tr_b16 v[166:167], v16 offset:1024
    ds_read_b64_tr_b16 v[168:169], v18 offset:0
    ds_read_b64_tr_b16 v[170:171], v19 offset:1024
    s_waitcnt lgkmcnt(6)
    ds_read_b64_tr_b16 v[172:173], v19 offset:0
    ds_read_b64_tr_b16 v[174:175], v18 offset:1024
    s_waitcnt lgkmcnt(6)
    v_lshlrev_b32_e64 v176, 16, v160
    v_and_b32 v177, 0xffff0000, v160
    v_lshlrev_b32_e64 v178, 16, v161
    v_and_b32 v179, 0xffff0000, v161
    v_lshlrev_b32_e64 v180, 16, v162
    v_and_b32 v181, 0xffff0000, v162
    v_lshlrev_b32_e64 v182, 16, v163
    v_and_b32 v183, 0xffff0000, v163
    s_add_u32 s57, s80, 387072
    buffer_load_dwordx4 v[120:123], v61, s[40:43], s57 offen
    v_pk_fma_f32 v[176:177], v[176:177], v[44:45], v[52:53]
    v_pk_fma_f32 v[178:179], v[178:179], v[46:47], v[54:55]
    v_pk_fma_f32 v[180:181], v[180:181], v[48:49], v[56:57]
    v_pk_fma_f32 v[182:183], v[182:183], v[50:51], v[58:59]
    v_cvt_pk_bf16_f32 v184, v176, v177
    v_cvt_pk_bf16_f32 v185, v178, v179
    v_cvt_pk_bf16_f32 v186, v180, v181
    v_cvt_pk_bf16_f32 v187, v182, v183
    s_add_u32 s57, s81, 0
    buffer_store_dwordx4 v[184:187], v24, s[44:47], s57 offen sc1
    ds_read_b64_tr_b16 v[160:161], v16 offset:4096
    ds_read_b64_tr_b16 v[162:163], v17 offset:5120
    s_waitcnt lgkmcnt(6)
    v_lshlrev_b32_e64 v176, 16, v164
    v_and_b32 v177, 0xffff0000, v164
    v_lshlrev_b32_e64 v178, 16, v165
    v_and_b32 v179, 0xffff0000, v165
    v_lshlrev_b32_e64 v180, 16, v166
    v_and_b32 v181, 0xffff0000, v166
    v_lshlrev_b32_e64 v182, 16, v167
    v_and_b32 v183, 0xffff0000, v167
    s_add_u32 s57, s80, 414720
    buffer_load_dwordx4 v[124:127], v61, s[40:43], s57 offen
    v_pk_fma_f32 v[176:177], v[176:177], v[44:45], v[52:53]
    v_pk_fma_f32 v[178:179], v[178:179], v[46:47], v[54:55]
    v_pk_fma_f32 v[180:181], v[180:181], v[48:49], v[56:57]
    v_pk_fma_f32 v[182:183], v[182:183], v[50:51], v[58:59]
    v_cvt_pk_bf16_f32 v188, v176, v177
    v_cvt_pk_bf16_f32 v189, v178, v179
    v_cvt_pk_bf16_f32 v190, v180, v181
    v_cvt_pk_bf16_f32 v191, v182, v183
    s_add_u32 s57, s81, 131072
    buffer_store_dwordx4 v[188:191], v24, s[44:47], s57 offen sc1
    ds_read_b64_tr_b16 v[164:165], v17 offset:4096
    ds_read_b64_tr_b16 v[166:167], v16 offset:5120
    s_waitcnt lgkmcnt(6)
    v_lshlrev_b32 v176, 16, v168
    v_and_b32 v177, 0xffff0000, v168
    v_lshlrev_b32_e64 v178, 16, v169
    v_and_b32 v179, 0xffff0000, v169
    v_lshlrev_b32_e64 v180, 16, v170
    v_and_b32 v181, 0xffff0000, v170
    v_lshlrev_b32_e64 v182, 16, v171
    v_and_b32 v183, 0xffff0000, v171
    s_add_u32 s57, s80, 442368
    buffer_load_dwordx4 v[128:131], v61, s[40:43], s57 offen
    v_pk_fma_f32 v[176:177], v[176:177], v[44:45], v[52:53]
    v_pk_fma_f32 v[178:179], v[178:179], v[46:47], v[54:55]
    v_pk_fma_f32 v[180:181], v[180:181], v[48:49], v[56:57]
    v_pk_fma_f32 v[182:183], v[182:183], v[50:51], v[58:59]
    v_cvt_pk_bf16_f32 v184, v176, v177
    v_cvt_pk_bf16_f32 v185, v178, v179
    v_cvt_pk_bf16_f32 v186, v180, v181
    v_cvt_pk_bf16_f32 v187, v182, v183
    s_add_u32 s57, s81, 262144
    buffer_store_dwordx4 v[184:187], v24, s[44:47], s57 offen sc1
    ds_read_b64_tr_b16 v[168:169], v18 offset:4096
    ds_read_b64_tr_b16 v[170:171], v19 offset:5120
    s_waitcnt lgkmcnt(6)
    v_lshlrev_b32 v176, 16, v172
    v_and_b32 v177, 0xffff0000, v172
    v_lshlrev_b32_e64 v178, 16, v173
    v_and_b32 v179, 0xffff0000, v173
    v_lshlrev_b32_e64 v180, 16, v174
    v_and_b32 v181, 0xffff0000, v174
    v_lshlrev_b32_e64 v182, 16, v175
    v_and_b32 v183, 0xffff0000, v175
    s_add_u32 s57, s80, 470016
    buffer_load_dwordx4 v[132:135], v61, s[40:43], s57 offen
    v_pk_fma_f32 v[176:177], v[176:177], v[44:45], v[52:53]
    v_pk_fma_f32 v[178:179], v[178:179], v[46:47], v[54:55]
    v_pk_fma_f32 v[180:181], v[180:181], v[48:49], v[56:57]
    v_pk_fma_f32 v[182:183], v[182:183], v[50:51], v[58:59]
    v_cvt_pk_bf16_f32 v188, v176, v177
    v_cvt_pk_bf16_f32 v189, v178, v179
    v_cvt_pk_bf16_f32 v190, v180, v181
    v_cvt_pk_bf16_f32 v191, v182, v183
    s_add_u32 s57, s81, 393216
    buffer_store_dwordx4 v[188:191], v24, s[44:47], s57 offen sc1
    s_add_u32 s57, s80, 497664
    buffer_load_dwordx4 v[136:139], v61, s[40:43], s57 offen
    s_add_u32 s57, s80, 525312
    buffer_load_dwordx4 v[140:143], v61, s[40:43], s57 offen
    s_mov_b32 s66, 0x3f80
    s_mov_b32 s67, 0x3f800000
    s_waitcnt vmcnt(21)
    v_dot2_f32_bf16 v32, v64, s66, 0
    v_dot2_f32_bf16 v33, v64, s67, 0
    v_dot2_f32_bf16 v34, v65, s66, 0
    v_dot2_f32_bf16 v35, v65, s67, 0
    v_dot2_f32_bf16 v36, v66, s66, 0
    v_dot2_f32_bf16 v37, v66, s67, 0
    v_dot2_f32_bf16 v38, v67, s66, 0
    v_dot2_f32_bf16 v39, v67, s67, 0
    v_dot2_f32_bf16 v32, v68, s66, v32
    v_dot2_f32_bf16 v33, v68, s67, v33
    v_dot2_f32_bf16 v34, v69, s66, v34
    v_dot2_f32_bf16 v35, v69, s67, v35
    v_dot2_f32_bf16 v36, v70, s66, v36
    v_dot2_f32_bf16 v37, v70, s67, v37
    v_dot2_f32_bf16 v38, v71, s66, v38
    v_dot2_f32_bf16 v39, v71, s67, v39
    v_dot2_f32_bf16 v32, v72, s66, v32
    v_dot2_f32_bf16 v33, v72, s67, v33
    v_dot2_f32_bf16 v34, v73, s66, v34
    v_dot2_f32_bf16 v35, v73, s67, v35
    v_dot2_f32_bf16 v36, v74, s66, v36
    v_dot2_f32_bf16 v37, v74, s67, v37
    v_dot2_f32_bf16 v38, v75, s66, v38
    v_dot2_f32_bf16 v39, v75, s67, v39
    v_dot2_f32_bf16 v32, v76, s66, v32
    v_dot2_f32_bf16 v33, v76, s67, v33
    v_dot2_f32_bf16 v34, v77, s66, v34
    v_dot2_f32_bf16 v35, v77, s67, v35
    v_dot2_f32_bf16 v36, v78, s66, v36
    v_dot2_f32_bf16 v37, v78, s67, v37
    v_dot2_f32_bf16 v38, v79, s66, v38
    v_dot2_f32_bf16 v39, v79, s67, v39
    s_waitcnt vmcnt(17)
    s_nop 0
    v_dot2_f32_bf16 v32, v80, s66, v32
    v_dot2_f32_bf16 v33, v80, s67, v33
    v_dot2_f32_bf16 v34, v81, s66, v34
    v_dot2_f32_bf16 v35, v81, s67, v35
    v_dot2_f32_bf16 v36, v82, s66, v36
    v_dot2_f32_bf16 v37, v82, s67, v37
    v_dot2_f32_bf16 v38, v83, s66, v38
    v_dot2_f32_bf16 v39, v83, s67, v39
    v_dot2_f32_bf16 v32, v84, s66, v32
    v_dot2_f32_bf16 v33, v84, s67, v33
    v_dot2_f32_bf16 v34, v85, s66, v34
    v_dot2_f32_bf16 v35, v85, s67, v35
    v_dot2_f32_bf16 v36, v86, s66, v36
    v_dot2_f32_bf16 v37, v86, s67, v37
    v_dot2_f32_bf16 v38, v87, s66, v38
    v_dot2_f32_bf16 v39, v87, s67, v39
    v_dot2_f32_bf16 v32, v88, s66, v32
    v_dot2_f32_bf16 v33, v88, s67, v33
    v_dot2_f32_bf16 v34, v89, s66, v34
    v_dot2_f32_bf16 v35, v89, s67, v35
    v_dot2_f32_bf16 v36, v90, s66, v36
    v_dot2_f32_bf16 v37, v90, s67, v37
    v_dot2_f32_bf16 v38, v91, s66, v38
    v_dot2_f32_bf16 v39, v91, s67, v39
    v_dot2_f32_bf16 v32, v92, s66, v32
    v_dot2_f32_bf16 v33, v92, s67, v33
    v_dot2_f32_bf16 v34, v93, s66, v34
    v_dot2_f32_bf16 v35, v93, s67, v35
    v_dot2_f32_bf16 v36, v94, s66, v36
    v_dot2_f32_bf16 v37, v94, s67, v37
    v_dot2_f32_bf16 v38, v95, s66, v38
    v_dot2_f32_bf16 v39, v95, s67, v39
    s_waitcnt vmcnt(13)
    s_nop 0
    v_dot2_f32_bf16 v32, v96, s66, v32
    v_dot2_f32_bf16 v33, v96, s67, v33
    v_dot2_f32_bf16 v34, v97, s66, v34
    v_dot2_f32_bf16 v35, v97, s67, v35
    v_dot2_f32_bf16 v36, v98, s66, v36
    v_dot2_f32_bf16 v37, v98, s67, v37
    v_dot2_f32_bf16 v38, v99, s66, v38
    v_dot2_f32_bf16 v39, v99, s67, v39
    v_dot2_f32_bf16 v32, v100, s66, v32
    v_dot2_f32_bf16 v33, v100, s67, v33
    v_dot2_f32_bf16 v34, v101, s66, v34
    v_dot2_f32_bf16 v35, v101, s67, v35
    v_dot2_f32_bf16 v36, v102, s66, v36
    v_dot2_f32_bf16 v37, v102, s67, v37
    v_dot2_f32_bf16 v38, v103, s66, v38
    v_dot2_f32_bf16 v39, v103, s67, v39
    v_dot2_f32_bf16 v32, v104, s66, v32
    v_dot2_f32_bf16 v33, v104, s67, v33
    v_dot2_f32_bf16 v34, v105, s66, v34
    v_dot2_f32_bf16 v35, v105, s67, v35
    v_dot2_f32_bf16 v36, v106, s66, v36
    v_dot2_f32_bf16 v37, v106, s67, v37
    v_dot2_f32_bf16 v38, v107, s66, v38
    v_dot2_f32_bf16 v39, v107, s67, v39
    v_dot2_f32_bf16 v32, v108, s66, v32
    v_dot2_f32_bf16 v33, v108, s67, v33
    v_dot2_f32_bf16 v34, v109, s66, v34
    v_dot2_f32_bf16 v35, v109, s67, v35
    v_dot2_f32_bf16 v36, v110, s66, v36
    v_dot2_f32_bf16 v37, v110, s67, v37
    v_dot2_f32_bf16 v38, v111, s66, v38
    v_dot2_f32_bf16 v39, v111, s67, v39
    s_waitcnt vmcnt(7)
    s_nop 0
    v_dot2_f32_bf16 v32, v112, s66, v32
    v_dot2_f32_bf16 v33, v112, s67, v33
    v_dot2_f32_bf16 v34, v113, s66, v34
    v_dot2_f32_bf16 v35, v113, s67, v35
    v_dot2_f32_bf16 v36, v114, s66, v36
    v_dot2_f32_bf16 v37, v114, s67, v37
    v_dot2_f32_bf16 v38, v115, s66, v38
    v_dot2_f32_bf16 v39, v115, s67, v39
    v_dot2_f32_bf16 v32, v116, s66, v32
    v_dot2_f32_bf16 v33, v116, s67, v33
    v_dot2_f32_bf16 v34, v117, s66, v34
    v_dot2_f32_bf16 v35, v117, s67, v35
    v_dot2_f32_bf16 v36, v118, s66, v36
    v_dot2_f32_bf16 v37, v118, s67, v37
    v_dot2_f32_bf16 v38, v119, s66, v38
    v_dot2_f32_bf16 v39, v119, s67, v39
    v_dot2_f32_bf16 v32, v120, s66, v32
    v_dot2_f32_bf16 v33, v120, s67, v33
    v_dot2_f32_bf16 v34, v121, s66, v34
    v_dot2_f32_bf16 v35, v121, s67, v35
    v_dot2_f32_bf16 v36, v122, s66, v36
    v_dot2_f32_bf16 v37, v122, s67, v37
    v_dot2_f32_bf16 v38, v123, s66, v38
    v_dot2_f32_bf16 v39, v123, s67, v39
    v_dot2_f32_bf16 v32, v124, s66, v32
    v_dot2_f32_bf16 v33, v124, s67, v33
    v_dot2_f32_bf16 v34, v125, s66, v34
    v_dot2_f32_bf16 v35, v125, s67, v35
    v_dot2_f32_bf16 v36, v126, s66, v36
    v_dot2_f32_bf16 v37, v126, s67, v37
    v_dot2_f32_bf16 v38, v127, s66, v38
    v_dot2_f32_bf16 v39, v127, s67, v39
    s_waitcnt vmcnt(0)
    s_nop 0
    v_dot2_f32_bf16 v32, v128, s66, v32
    v_dot2_f32_bf16 v33, v128, s67, v33
    v_dot2_f32_bf16 v34, v129, s66, v34
    v_dot2_f32_bf16 v35, v129, s67, v35
    v_dot2_f32_bf16 v36, v130, s66, v36
    v_dot2_f32_bf16 v37, v130, s67, v37
    v_dot2_f32_bf16 v38, v131, s66, v38
    v_dot2_f32_bf16 v39, v131, s67, v39
    v_dot2_f32_bf16 v32, v132, s66, v32
    v_dot2_f32_bf16 v33, v132, s67, v33
    v_dot2_f32_bf16 v34, v133, s66, v34
    v_dot2_f32_bf16 v35, v133, s67, v35
    v_dot2_f32_bf16 v36, v134, s66, v36
    v_dot2_f32_bf16 v37, v134, s67, v37
    v_dot2_f32_bf16 v38, v135, s66, v38
    v_dot2_f32_bf16 v39, v135, s67, v39
    v_dot2_f32_bf16 v32, v136, s66, v32
    v_dot2_f32_bf16 v33, v136, s67, v33
    v_dot2_f32_bf16 v34, v137, s66, v34
    v_dot2_f32_bf16 v35, v137, s67, v35
    v_dot2_f32_bf16 v36, v138, s66, v36
    v_dot2_f32_bf16 v37, v138, s67, v37
    v_dot2_f32_bf16 v38, v139, s66, v38
    v_dot2_f32_bf16 v39, v139, s67, v39
    v_dot2_f32_bf16 v32, v140, s66, v32
    v_dot2_f32_bf16 v33, v140, s67, v33
    v_dot2_f32_bf16 v34, v141, s66, v34
    v_dot2_f32_bf16 v35, v141, s67, v35
    v_dot2_f32_bf16 v36, v142, s66, v36
    v_dot2_f32_bf16 v37, v142, s67, v37
    v_dot2_f32_bf16 v38, v143, s66, v38
    v_dot2_f32_bf16 v39, v143, s67, v39
    v_add_f32_dpp v32, v32, v32 row_ror:8 row_mask:0xf bank_mask:0xf
    v_add_f32_dpp v33, v33, v33 row_ror:8 row_mask:0xf bank_mask:0xf
    v_add_f32_dpp v34, v34, v34 row_ror:8 row_mask:0xf bank_mask:0xf
    v_add_f32_dpp v35, v35, v35 row_ror:8 row_mask:0xf bank_mask:0xf
    v_add_f32_dpp v36, v36, v36 row_ror:8 row_mask:0xf bank_mask:0xf
    v_add_f32_dpp v37, v37, v37 row_ror:8 row_mask:0xf bank_mask:0xf
    v_add_f32_dpp v38, v38, v38 row_ror:8 row_mask:0xf bank_mask:0xf
    v_add_f32_dpp v39, v39, v39 row_ror:8 row_mask:0xf bank_mask:0xf
    v_mov_b32 v64, v32
    v_mov_b32 v65, v33
    v_mov_b32 v66, v34
    v_mov_b32 v67, v35
    v_mov_b32 v68, v36
    v_mov_b32 v69, v37
    v_mov_b32 v70, v38
    v_mov_b32 v71, v39
    v_permlane16_swap_b32 v32, v64
    v_permlane16_swap_b32 v33, v65
    v_permlane16_swap_b32 v34, v66
    v_permlane16_swap_b32 v35, v67
    v_permlane16_swap_b32 v36, v68
    v_permlane16_swap_b32 v37, v69
    v_permlane16_swap_b32 v38, v70
    v_permlane16_swap_b32 v39, v71
    v_pk_add_f32 v[32:33], v[32:33], v[64:65]
    v_pk_add_f32 v[34:35], v[34:35], v[66:67]
    v_pk_add_f32 v[36:37], v[36:37], v[68:69]
    v_pk_add_f32 v[38:39], v[38:39], v[70:71]
    v_mov_b32 v64, v32
    v_mov_b32 v65, v33
    v_mov_b32 v66, v34
    v_mov_b32 v67, v35
    v_mov_b32 v68, v36
    v_mov_b32 v69, v37
    v_mov_b32 v70, v38
    v_mov_b32 v71, v39
    v_permlane32_swap_b32 v32, v64
    v_permlane32_swap_b32 v33, v65
    v_permlane32_swap_b32 v34, v66
    v_permlane32_swap_b32 v35, v67
    v_permlane32_swap_b32 v36, v68
    v_permlane32_swap_b32 v37, v69
    v_permlane32_swap_b32 v38, v70
    v_permlane32_swap_b32 v39, v71
    v_pk_add_f32 v[32:33], v[32:33], v[64:65]
    v_pk_add_f32 v[34:35], v[34:35], v[66:67]
    v_pk_add_f32 v[36:37], v[36:37], v[68:69]
    v_pk_add_f32 v[38:39], v[38:39], v[70:71]
    s_lshl_b32 s57, s3, 8
    s_nop 0
    s_add_u32 s57, s57, 82944
    v_lshl_add_u32 v22, v0, 5, s57
    s_mov_b64 exec, 0xff
    ds_write_b128 v22, v[32:35]
    ds_write_b128 v22, v[36:39] offset:16
    s_mov_b64 exec, -1
    s_waitcnt lgkmcnt(0)
    s_barrier
    s_cmp_lg_u32 s3, 0
    s_cbranch_scc1 Lw0_26
    v_lshlrev_b32 v22, 2, v0
    v_add_u32 v22, 82944, v22
    ds_read_b32 v32, v22 offset:0
    ds_read_b32 v33, v22 offset:256
    ds_read_b32 v34, v22 offset:512
    ds_read_b32 v35, v22 offset:768
    s_waitcnt lgkmcnt(0)
    v_add_f32 v32, v32, v33
    v_add_f32 v34, v34, v35
    v_add_f32 v32, v32, v34
    v_cvt_pk_bf16_f32 v36, v32, v32
    v_and_b32 v33, 0xffff0000, v36
    v_sub_f32_e64 v33, v32, v33
    v_cvt_pk_bf16_f32 v37, v33, v33
    v_lshl_add_u32 v38, v15, 16, v15
    v_mov_b32 v39, s76
    s_lshl_b32 s56, s62, 10
    s_add_u32 s56, s56, 65536
    s_or_b32 s56, s56, s63
    s_nop 0
    buffer_store_dwordx4 v[36:39], v1, s[44:47], s56 offen sc1
Lw0_26:
    ds_read_b64_tr_b16 v[172:173], v19 offset:4096
    ds_read_b64_tr_b16 v[174:175], v18 offset:5120
    v_lshlrev_b32_e64 v176, 16, v160
    v_and_b32 v177, 0xffff0000, v160
    v_lshlrev_b32_e64 v178, 16, v161
    v_and_b32 v179, 0xffff0000, v161
    v_lshlrev_b32_e64 v180, 16, v162
    v_and_b32 v181, 0xffff0000, v162
    v_lshlrev_b32_e64 v182, 16, v163
    v_and_b32 v183, 0xffff0000, v163
    v_pk_fma_f32 v[176:177], v[176:177], v[44:45], v[52:53]
    v_pk_fma_f32 v[178:179], v[178:179], v[46:47], v[54:55]
    v_pk_fma_f32 v[180:181], v[180:181], v[48:49], v[56:57]
    v_pk_fma_f32 v[182:183], v[182:183], v[50:51], v[58:59]
    v_cvt_pk_bf16_f32 v184, v176, v177
    v_cvt_pk_bf16_f32 v185, v178, v179
    v_cvt_pk_bf16_f32 v186, v180, v181
    v_cvt_pk_bf16_f32 v187, v182, v183
    s_add_u32 s57, s81, 524288
    buffer_store_dwordx4 v[184:187], v24, s[44:47], s57 offen sc1
    ds_read_b64_tr_b16 v[160:161], v16 offset:8192
    ds_read_b64_tr_b16 v[162:163], v17 offset:9216
    v_lshlrev_b32_e64 v176, 16, v164
    v_and_b32 v177, 0xffff0000, v164
    v_lshlrev_b32_e64 v178, 16, v165
    v_and_b32 v179, 0xffff0000, v165
    v_lshlrev_b32_e64 v180, 16, v166
    v_and_b32 v181, 0xffff0000, v166
    v_lshlrev_b32_e64 v182, 16, v167
    v_and_b32 v183, 0xffff0000, v167
    v_pk_fma_f32 v[176:177], v[176:177], v[44:45], v[52:53]
    v_pk_fma_f32 v[178:179], v[178:179], v[46:47], v[54:55]
    v_pk_fma_f32 v[180:181], v[180:181], v[48:49], v[56:57]
    v_pk_fma_f32 v[182:183], v[182:183], v[50:51], v[58:59]
    v_cvt_pk_bf16_f32 v188, v176, v177
    v_cvt_pk_bf16_f32 v189, v178, v179
    v_cvt_pk_bf16_f32 v190, v180, v181
    v_cvt_pk_bf16_f32 v191, v182, v183
    s_add_u32 s57, s81, 655360
    buffer_store_dwordx4 v[188:191], v24, s[44:47], s57 offen sc1
    ds_read_b64_tr_b16 v[164:165], v17 offset:8192
    ds_read_b64_tr_b16 v[166:167], v16 offset:9216
    v_lshlrev_b32_e64 v176, 16, v168
    v_and_b32 v177, 0xffff0000, v168
    v_lshlrev_b32_e64 v178, 16, v169
    v_and_b32 v179, 0xffff0000, v169
    v_lshlrev_b32_e64 v180, 16, v170
    v_and_b32 v181, 0xffff0000, v170
    v_lshlrev_b32_e64 v182, 16, v171
    v_and_b32 v183, 0xffff0000, v171
    v_pk_fma_f32 v[176:177], v[176:177], v[44:45], v[52:53]
    v_pk_fma_f32 v[178:179], v[178:179], v[46:47], v[54:55]
    v_pk_fma_f32 v[180:181], v[180:181], v[48:49], v[56:57]
    v_pk_fma_f32 v[182:183], v[182:183], v[50:51], v[58:59]
    v_cvt_pk_bf16_f32 v184, v176, v177
    v_cvt_pk_bf16_f32 v185, v178, v179
    v_cvt_pk_bf16_f32 v186, v180, v181
    v_cvt_pk_bf16_f32 v187, v182, v183
    s_add_u32 s57, s81, 786432
    buffer_store_dwordx4 v[184:187], v24, s[44:47], s57 offen sc1
    ds_read_b64_tr_b16 v[168:169], v18 offset:8192
    ds_read_b64_tr_b16 v[170:171], v19 offset:9216
    s_waitcnt lgkmcnt(6)
    v_lshlrev_b32 v176, 16, v172
    v_and_b32 v177, 0xffff0000, v172
    v_lshlrev_b32_e64 v178, 16, v173
    v_and_b32 v179, 0xffff0000, v173
    v_lshlrev_b32_e64 v180, 16, v174
    v_and_b32 v181, 0xffff0000, v174
    v_lshlrev_b32_e64 v182, 16, v175
    v_and_b32 v183, 0xffff0000, v175
    v_pk_fma_f32 v[176:177], v[176:177], v[44:45], v[52:53]
    v_pk_fma_f32 v[178:179], v[178:179], v[46:47], v[54:55]
    v_pk_fma_f32 v[180:181], v[180:181], v[48:49], v[56:57]
    v_pk_fma_f32 v[182:183], v[182:183], v[50:51], v[58:59]
    v_cvt_pk_bf16_f32 v188, v176, v177
    v_cvt_pk_bf16_f32 v189, v178, v179
    v_cvt_pk_bf16_f32 v190, v180, v181
    v_cvt_pk_bf16_f32 v191, v182, v183
    s_add_u32 s57, s81, 917504
    buffer_store_dwordx4 v[188:191], v24, s[44:47], s57 offen sc1
    ds_read_b64_tr_b16 v[172:173], v19 offset:8192
    ds_read_b64_tr_b16 v[174:175], v18 offset:9216
    s_waitcnt lgkmcnt(6)
    v_lshlrev_b32 v176, 16, v160
    v_and_b32 v177, 0xffff0000, v160
    v_lshlrev_b32_e64 v178, 16, v161
    v_and_b32 v179, 0xffff0000, v161
    v_lshlrev_b32_e64 v180, 16, v162
    v_and_b32 v181, 0xffff0000, v162
    v_lshlrev_b32_e64 v182, 16, v163
    v_and_b32 v183, 0xffff0000, v163
    v_pk_fma_f32 v[176:177], v[176:177], v[44:45], v[52:53]
    v_pk_fma_f32 v[178:179], v[178:179], v[46:47], v[54:55]
    v_pk_fma_f32 v[180:181], v[180:181], v[48:49], v[56:57]
    v_pk_fma_f32 v[182:183], v[182:183], v[50:51], v[58:59]
    v_cvt_pk_bf16_f32 v184, v176, v177
    v_cvt_pk_bf16_f32 v185, v178, v179
    v_cvt_pk_bf16_f32 v186, v180, v181
    v_cvt_pk_bf16_f32 v187, v182, v183
    s_add_u32 s57, s81, 1048576
    buffer_store_dwordx4 v[184:187], v24, s[44:47], s57 offen sc1
    ds_read_b64_tr_b16 v[160:161], v16 offset:12288
    ds_read_b64_tr_b16 v[162:163], v17 offset:13312
    s_waitcnt lgkmcnt(6)
    v_lshlrev_b32 v176, 16, v164
    v_and_b32 v177, 0xffff0000, v164
    v_lshlrev_b32_e64 v178, 16, v165
    v_and_b32 v179, 0xffff0000, v165
    v_lshlrev_b32_e64 v180, 16, v166
    v_and_b32 v181, 0xffff0000, v166
    v_lshlrev_b32_e64 v182, 16, v167
    v_and_b32 v183, 0xffff0000, v167
    v_pk_fma_f32 v[176:177], v[176:177], v[44:45], v[52:53]
    v_pk_fma_f32 v[178:179], v[178:179], v[46:47], v[54:55]
    v_pk_fma_f32 v[180:181], v[180:181], v[48:49], v[56:57]
    v_pk_fma_f32 v[182:183], v[182:183], v[50:51], v[58:59]
    v_cvt_pk_bf16_f32 v188, v176, v177
    v_cvt_pk_bf16_f32 v189, v178, v179
    v_cvt_pk_bf16_f32 v190, v180, v181
    v_cvt_pk_bf16_f32 v191, v182, v183
    s_add_u32 s57, s81, 1179648
    buffer_store_dwordx4 v[188:191], v24, s[44:47], s57 offen sc1
    ds_read_b64_tr_b16 v[164:165], v17 offset:12288
    ds_read_b64_tr_b16 v[166:167], v16 offset:13312
    s_waitcnt lgkmcnt(6)
    v_lshlrev_b32 v176, 16, v168
    v_and_b32 v177, 0xffff0000, v168
    v_lshlrev_b32_e64 v178, 16, v169
    v_and_b32 v179, 0xffff0000, v169
    v_lshlrev_b32_e64 v180, 16, v170
    v_and_b32 v181, 0xffff0000, v170
    v_lshlrev_b32_e64 v182, 16, v171
    v_and_b32 v183, 0xffff0000, v171
    v_pk_fma_f32 v[176:177], v[176:177], v[44:45], v[52:53]
    v_pk_fma_f32 v[178:179], v[178:179], v[46:47], v[54:55]
    v_pk_fma_f32 v[180:181], v[180:181], v[48:49], v[56:57]
    v_pk_fma_f32 v[182:183], v[182:183], v[50:51], v[58:59]
    v_cvt_pk_bf16_f32 v184, v176, v177
    v_cvt_pk_bf16_f32 v185, v178, v179
    v_cvt_pk_bf16_f32 v186, v180, v181
    v_cvt_pk_bf16_f32 v187, v182, v183
    s_add_u32 s57, s81, 1310720
    buffer_store_dwordx4 v[184:187], v24, s[44:47], s57 offen sc1
    ds_read_b64_tr_b16 v[168:169], v18 offset:12288
    ds_read_b64_tr_b16 v[170:171], v19 offset:13312
    s_waitcnt lgkmcnt(6)
    v_lshlrev_b32 v176, 16, v172
    v_and_b32 v177, 0xffff0000, v172
    v_lshlrev_b32_e64 v178, 16, v173
    v_and_b32 v179, 0xffff0000, v173
    v_lshlrev_b32_e64 v180, 16, v174
    v_and_b32 v181, 0xffff0000, v174
    v_lshlrev_b32_e64 v182, 16, v175
    v_and_b32 v183, 0xffff0000, v175
    v_pk_fma_f32 v[176:177], v[176:177], v[44:45], v[52:53]
    v_pk_fma_f32 v[178:179], v[178:179], v[46:47], v[54:55]
    v_pk_fma_f32 v[180:181], v[180:181], v[48:49], v[56:57]
    v_pk_fma_f32 v[182:183], v[182:183], v[50:51], v[58:59]
    v_cvt_pk_bf16_f32 v188, v176, v177
    v_cvt_pk_bf16_f32 v189, v178, v179
    v_cvt_pk_bf16_f32 v190, v180, v181
    v_cvt_pk_bf16_f32 v191, v182, v183
    s_add_u32 s57, s81, 1441792
    buffer_store_dwordx4 v[188:191], v24, s[44:47], s57 offen sc1
    ds_read_b64_tr_b16 v[172:173], v19 offset:12288
    ds_read_b64_tr_b16 v[174:175], v18 offset:13312
    s_waitcnt lgkmcnt(6)
    v_lshlrev_b32 v176, 16, v160
    v_and_b32 v177, 0xffff0000, v160
    v_lshlrev_b32_e64 v178, 16, v161
    v_and_b32 v179, 0xffff0000, v161
    v_lshlrev_b32_e64 v180, 16, v162
    v_and_b32 v181, 0xffff0000, v162
    v_lshlrev_b32_e64 v182, 16, v163
    v_and_b32 v183, 0xffff0000, v163
    v_pk_fma_f32 v[176:177], v[176:177], v[44:45], v[52:53]
    v_pk_fma_f32 v[178:179], v[178:179], v[46:47], v[54:55]
    v_pk_fma_f32 v[180:181], v[180:181], v[48:49], v[56:57]
    v_pk_fma_f32 v[182:183], v[182:183], v[50:51], v[58:59]
    v_cvt_pk_bf16_f32 v184, v176, v177
    v_cvt_pk_bf16_f32 v185, v178, v179
    v_cvt_pk_bf16_f32 v186, v180, v181
    v_cvt_pk_bf16_f32 v187, v182, v183
    s_add_u32 s57, s81, 1572864
    buffer_store_dwordx4 v[184:187], v24, s[44:47], s57 offen sc1
    ds_read_b64_tr_b16 v[160:161], v16 offset:16384
    ds_read_b64_tr_b16 v[162:163], v17 offset:17408
    s_waitcnt lgkmcnt(6)
    v_lshlrev_b32 v176, 16, v164
    v_and_b32 v177, 0xffff0000, v164
    v_lshlrev_b32_e64 v178, 16, v165
    v_and_b32 v179, 0xffff0000, v165
    v_lshlrev_b32_e64 v180, 16, v166
    v_and_b32 v181, 0xffff0000, v166
    v_lshlrev_b32_e64 v182, 16, v167
    v_and_b32 v183, 0xffff0000, v167
    v_pk_fma_f32 v[176:177], v[176:177], v[44:45], v[52:53]
    v_pk_fma_f32 v[178:179], v[178:179], v[46:47], v[54:55]
    v_pk_fma_f32 v[180:181], v[180:181], v[48:49], v[56:57]
    v_pk_fma_f32 v[182:183], v[182:183], v[50:51], v[58:59]
    v_cvt_pk_bf16_f32 v188, v176, v177
    v_cvt_pk_bf16_f32 v189, v178, v179
    v_cvt_pk_bf16_f32 v190, v180, v181
    v_cvt_pk_bf16_f32 v191, v182, v183
    s_add_u32 s57, s81, 1703936
    buffer_store_dwordx4 v[188:191], v24, s[44:47], s57 offen sc1
    ds_read_b64_tr_b16 v[164:165], v17 offset:16384
    ds_read_b64_tr_b16 v[166:167], v16 offset:17408
    s_waitcnt lgkmcnt(6)
    v_lshlrev_b32 v176, 16, v168
    v_and_b32 v177, 0xffff0000, v168
    v_lshlrev_b32_e64 v178, 16, v169
    v_and_b32 v179, 0xffff0000, v169
    v_lshlrev_b32_e64 v180, 16, v170
    v_and_b32 v181, 0xffff0000, v170
    v_lshlrev_b32_e64 v182, 16, v171
    v_and_b32 v183, 0xffff0000, v171
    v_pk_fma_f32 v[176:177], v[176:177], v[44:45], v[52:53]
    v_pk_fma_f32 v[178:179], v[178:179], v[46:47], v[54:55]
    v_pk_fma_f32 v[180:181], v[180:181], v[48:49], v[56:57]
    v_pk_fma_f32 v[182:183], v[182:183], v[50:51], v[58:59]
    v_cvt_pk_bf16_f32 v184, v176, v177
    v_cvt_pk_bf16_f32 v185, v178, v179
    v_cvt_pk_bf16_f32 v186, v180, v181
    v_cvt_pk_bf16_f32 v187, v182, v183
    s_add_u32 s57, s81, 1835008
    buffer_store_dwordx4 v[184:187], v24, s[44:47], s57 offen sc1
    ds_read_b64_tr_b16 v[168:169], v18 offset:16384
    ds_read_b64_tr_b16 v[170:171], v19 offset:17408
    s_waitcnt lgkmcnt(6)
    v_lshlrev_b32 v176, 16, v172
    v_and_b32 v177, 0xffff0000, v172
    v_lshlrev_b32_e64 v178, 16, v173
    v_and_b32 v179, 0xffff0000, v173
    v_lshlrev_b32_e64 v180, 16, v174
    v_and_b32 v181, 0xffff0000, v174
    v_lshlrev_b32_e64 v182, 16, v175
    v_and_b32 v183, 0xffff0000, v175
    v_pk_fma_f32 v[176:177], v[176:177], v[44:45], v[52:53]
    v_pk_fma_f32 v[178:179], v[178:179], v[46:47], v[54:55]
    v_pk_fma_f32 v[180:181], v[180:181], v[48:49], v[56:57]
    v_pk_fma_f32 v[182:183], v[182:183], v[50:51], v[58:59]
    v_cvt_pk_bf16_f32 v188, v176, v177
    v_cvt_pk_bf16_f32 v189, v178, v179
    v_cvt_pk_bf16_f32 v190, v180, v181
    v_cvt_pk_bf16_f32 v191, v182, v183
    s_add_u32 s57, s81, 1966080
    buffer_store_dwordx4 v[188:191], v24, s[44:47], s57 offen sc1
    ds_read_b64_tr_b16 v[172:173], v19 offset:16384
    ds_read_b64_tr_b16 v[174:175], v18 offset:17408
    s_waitcnt lgkmcnt(6)
    v_lshlrev_b32 v176, 16, v160
    v_and_b32 v177, 0xffff0000, v160
    v_lshlrev_b32_e64 v178, 16, v161
    v_and_b32 v179, 0xffff0000, v161
    v_lshlrev_b32_e64 v180, 16, v162
    v_and_b32 v181, 0xffff0000, v162
    v_lshlrev_b32_e64 v182, 16, v163
    v_and_b32 v183, 0xffff0000, v163
    v_pk_fma_f32 v[176:177], v[176:177], v[44:45], v[52:53]
    v_pk_fma_f32 v[178:179], v[178:179], v[46:47], v[54:55]
    v_pk_fma_f32 v[180:181], v[180:181], v[48:49], v[56:57]
    v_pk_fma_f32 v[182:183], v[182:183], v[50:51], v[58:59]
    v_cvt_pk_bf16_f32 v184, v176, v177
    v_cvt_pk_bf16_f32 v185, v178, v179
    v_cvt_pk_bf16_f32 v186, v180, v181
    v_cvt_pk_bf16_f32 v187, v182, v183
    s_add_u32 s57, s81, 2097152
    buffer_store_dwordx4 v[184:187], v24, s[44:47], s57 offen sc1
    s_waitcnt lgkmcnt(4)
    v_lshlrev_b32 v176, 16, v164
    v_and_b32 v177, 0xffff0000, v164
    v_lshlrev_b32_e64 v178, 16, v165
    v_and_b32 v179, 0xffff0000, v165
    v_lshlrev_b32_e64 v180, 16, v166
    v_and_b32 v181, 0xffff0000, v166
    v_lshlrev_b32_e64 v182, 16, v167
    v_and_b32 v183, 0xffff0000, v167
    v_pk_fma_f32 v[176:177], v[176:177], v[44:45], v[52:53]
    v_pk_fma_f32 v[178:179], v[178:179], v[46:47], v[54:55]
    v_pk_fma_f32 v[180:181], v[180:181], v[48:49], v[56:57]
    v_pk_fma_f32 v[182:183], v[182:183], v[50:51], v[58:59]
    v_cvt_pk_bf16_f32 v188, v176, v177
    v_cvt_pk_bf16_f32 v189, v178, v179
    v_cvt_pk_bf16_f32 v190, v180, v181
    v_cvt_pk_bf16_f32 v191, v182, v183
    s_add_u32 s57, s81, 2228224
    buffer_store_dwordx4 v[188:191], v24, s[44:47], s57 offen sc1
    s_waitcnt lgkmcnt(2)
    v_lshlrev_b32 v176, 16, v168
    v_and_b32 v177, 0xffff0000, v168
    v_lshlrev_b32_e64 v178, 16, v169
    v_and_b32 v179, 0xffff0000, v169
    v_lshlrev_b32_e64 v180, 16, v170
    v_and_b32 v181, 0xffff0000, v170
    v_lshlrev_b32_e64 v182, 16, v171
    v_and_b32 v183, 0xffff0000, v171
    v_pk_fma_f32 v[176:177], v[176:177], v[44:45], v[52:53]
    v_pk_fma_f32 v[178:179], v[178:179], v[46:47], v[54:55]
    v_pk_fma_f32 v[180:181], v[180:181], v[48:49], v[56:57]
    v_pk_fma_f32 v[182:183], v[182:183], v[50:51], v[58:59]
    v_cvt_pk_bf16_f32 v184, v176, v177
    v_cvt_pk_bf16_f32 v185, v178, v179
    v_cvt_pk_bf16_f32 v186, v180, v181
    v_cvt_pk_bf16_f32 v187, v182, v183
    s_add_u32 s57, s81, 2359296
    buffer_store_dwordx4 v[184:187], v24, s[44:47], s57 offen sc1
    s_waitcnt lgkmcnt(0)
    v_lshlrev_b32 v176, 16, v172
    v_and_b32 v177, 0xffff0000, v172
    v_lshlrev_b32_e64 v178, 16, v173
    v_and_b32 v179, 0xffff0000, v173
    v_lshlrev_b32_e64 v180, 16, v174
    v_and_b32 v181, 0xffff0000, v174
    v_lshlrev_b32_e64 v182, 16, v175
    v_and_b32 v183, 0xffff0000, v175
    v_pk_fma_f32 v[176:177], v[176:177], v[44:45], v[52:53]
    v_pk_fma_f32 v[178:179], v[178:179], v[46:47], v[54:55]
    v_pk_fma_f32 v[180:181], v[180:181], v[48:49], v[56:57]
    v_pk_fma_f32 v[182:183], v[182:183], v[50:51], v[58:59]
    v_cvt_pk_bf16_f32 v188, v176, v177
    v_cvt_pk_bf16_f32 v189, v178, v179
    v_cvt_pk_bf16_f32 v190, v180, v181
    v_cvt_pk_bf16_f32 v191, v182, v183
    s_add_u32 s57, s81, 2490368
    buffer_store_dwordx4 v[188:191], v24, s[44:47], s57 offen sc1
    s_lshl_b32 s58, s61, 7
    s_add_u32 s58, s58, 4096
    s_waitcnt vmcnt(0)
    s_barrier
    s_cmp_lg_u32 s3, 0
    s_cbranch_scc1 Lw0_27
    v_mov_b32 v60, s76
    v_mov_b32 v61, 0
    s_mov_b64 exec, 1
    buffer_store_dword v60, v61, s[44:47], s58 offen sc1
    s_mov_b64 exec, -1
Lw0_27:
    v_min_u32 v60, 15, v0
    v_lshlrev_b32_e64 v60, 7, v60
    buffer_load_dword v60, v60, s[44:47], s79 offen sc1
    s_waitcnt vmcnt(0)
    v_cmp_eq_u32 vcc, s76, v60
    s_nop 0
    s_cmp_eq_u64 vcc, -1
    s_cbranch_scc1 Lok_28
    s_mov_b32 s96, 0
Lsp_29:
    s_sleep 2
    v_min_u32 v60, 15, v0
    v_lshlrev_b32_e64 v60, 7, v60
    buffer_load_dword v60, v60, s[44:47], s79 offen sc1
    s_waitcnt vmcnt(0)
    v_cmp_eq_u32 vcc, s76, v60
    s_nop 0
    s_cmp_eq_u64 vcc, -1
    s_cbranch_scc1 Lok_28
    s_add_u32 s96, s96, 1
    s_cmp_lt_u32 s96, 20000
    s_cbranch_scc1 Lsp_29
Lok_28:
    s_barrier
    s_mul_i32 s90, s60, 276480
    s_mul_i32 s91, s3, 5120
    s_add_u32 s90, s90, s91
    s_add_u32 s90, s90, 5373952
    v_add_u32 v2, 0x1000, v1
    s_add_u32 s77, s90, 266240
    s_cmp_lt_u32 s3, 2
    s_cselect_b32 s77, s77, 0x80000000
    buffer_load_dwordx4 a[0:3], v1, s[44:47], s90 offen sc1
    buffer_load_dwordx4 a[4:7], v1, s[44:47], s90 offen offset:1024 sc1
    buffer_load_dwordx4 a[8:11], v1, s[44:47], s90 offen offset:2048 sc1
    buffer_load_dwordx4 a[12:15], v1, s[44:47], s90 offen offset:3072 sc1
    buffer_load_dwordx4 a[16:19], v2, s[44:47], s90 offen sc1
    s_add_u32 s92, s90, 20480
    buffer_load_dwordx4 a[20:23], v1, s[44:47], s92 offen sc1
    buffer_load_dwordx4 a[24:27], v1, s[44:47], s92 offen offset:1024 sc1
    buffer_load_dwordx4 a[28:31], v1, s[44:47], s92 offen offset:2048 sc1
    buffer_load_dwordx4 a[32:35], v1, s[44:47], s92 offen offset:3072 sc1
    buffer_load_dwordx4 a[36:39], v2, s[44:47], s92 offen sc1
    s_add_u32 s92, s90, 40960
    buffer_load_dwordx4 a[40:43], v1, s[44:47], s92 offen sc1
    buffer_load_dwordx4 a[44:47], v1, s[44:47], s92 offen offset:1024 sc1
    buffer_load_dwordx4 a[48:51], v1, s[44:47], s92 offen offset:2048 sc1
    buffer_load_dwordx4 a[52:55], v1, s[44:47], s92 offen offset:3072 sc1
    buffer_load_dwordx4 a[56:59], v2, s[44:47], s92 offen sc1
    s_add_u32 s92, s90, 61440
    buffer_load_dwordx4 a[60:63], v1, s[44:47], s92 offen sc1
    buffer_load_dwordx4 a[64:67], v1, s[44:47], s92 offen offset:1024 sc1
    buffer_load_dwordx4 a[68:71], v1, s[44:47], s92 offen offset:2048 sc1
    buffer_load_dwordx4 a[72:75], v1, s[44:47], s92 offen offset:3072 sc1
    buffer_load_dwordx4 a[76:79], v2, s[44:47], s92 offen sc1
    s_add_u32 s92, s90, 81920
    buffer_load_dwordx4 a[80:83], v1, s[44:47], s92 offen sc1
    buffer_load_dwordx4 a[84:87], v1, s[44:47], s92 offen offset:1024 sc1
    buffer_load_dwordx4 a[88:91], v1, s[44:47], s92 offen offset:2048 sc1
    buffer_load_dwordx4 a[92:95], v1, s[44:47], s92 offen offset:3072 sc1
    buffer_load_dwordx4 a[96:99], v2, s[44:47], s92 offen sc1
    s_add_u32 s92, s90, 102400
    buffer_load_dwordx4 a[100:103], v1, s[44:47], s92 offen sc1
    buffer_load_dwordx4 a[104:107], v1, s[44:47], s92 offen offset:1024 sc1
    buffer_load_dwordx4 a[108:111], v1, s[44:47], s92 offen offset:2048 sc1
    buffer_load_dwordx4 a[112:115], v1, s[44:47], s92 offen offset:3072 sc1
    buffer_load_dwordx4 a[116:119], v2, s[44:47], s92 offen sc1
    s_add_u32 s92, s90, 122880
    buffer_load_dwordx4 a[120:123], v1, s[44:47], s92 offen sc1
    buffer_load_dwordx4 a[124:127], v1, s[44:47], s92 offen offset:1024 sc1
    buffer_load_dwordx4 a[128:131], v1, s[44:47], s92 offen offset:2048 sc1
    buffer_load_dwordx4 a[132:135], v1, s[44:47], s92 offen offset:3072 sc1
    buffer_load_dwordx4 a[136:139], v2, s[44:47], s92 offen sc1
    s_add_u32 s92, s90, 143360
    buffer_load_dwordx4 a[140:143], v1, s[44:47], s92 offen sc1
    buffer_load_dwordx4 a[144:147], v1, s[44:47], s92 offen offset:1024 sc1
    buffer_load_dwordx4 a[148:151], v1, s[44:47], s92 offen offset:2048 sc1
    buffer_load_dwordx4 a[152:155], v1, s[44:47], s92 offen offset:3072 sc1
    buffer_load_dwordx4 a[156:159], v2, s[44:47], s92 offen sc1
    s_add_u32 s92, s90, 163840
    buffer_load_dwordx4 a[160:163], v1, s[44:47], s92 offen sc1
    buffer_load_dwordx4 a[164:167], v1, s[44:47], s92 offen offset:1024 sc1
    buffer_load_dwordx4 a[168:171], v1, s[44:47], s92 offen offset:2048 sc1
    buffer_load_dwordx4 a[172:175], v1, s[44:47], s92 offen offset:3072 sc1
    buffer_load_dwordx4 a[176:179], v2, s[44:47], s92 offen sc1
    s_add_u32 s92, s90, 184320
    buffer_load_dwordx4 a[180:183], v1, s[44:47], s92 offen sc1
    buffer_load_dwordx4 a[184:187], v1, s[44:47], s92 offen offset:1024 sc1
    buffer_load_dwordx4 a[188:191], v1, s[44:47], s92 offen offset:2048 sc1
    buffer_load_dwordx4 a[192:195], v1, s[44:47], s92 offen offset:3072 sc1
    buffer_load_dwordx4 a[196:199], v2, s[44:47], s92 offen sc1
    s_add_u32 s92, s90, 204800
    buffer_load_dwordx4 a[200:203], v1, s[44:47], s92 offen sc1
    buffer_load_dwordx4 a[204:207], v1, s[44:47], s92 offen offset:1024 sc1
    buffer_load_dwordx4 a[208:211], v1, s[44:47], s92 offen offset:2048 sc1
    buffer_load_dwordx4 a[212:215], v1, s[44:47], s92 offen offset:3072 sc1
    buffer_load_dwordx4 a[216:219], v2, s[44:47], s92 offen sc1
    s_add_u32 s92, s90, 225280
    buffer_load_dwordx4 a[220:223], v1, s[44:47], s92 offen sc1
    s_branch L_noconv
L_codeend:
.section .rodata,"a"
.p2align 6
.amdhsa_kernel parallel_sum__ssm_conv_s4d__mixer_channel_mlp__prompt_kernel
  .amdhsa_next_free_vgpr 512
  .amdhsa_next_free_sgpr 102
  .amdhsa_accum_offset 256
  .amdhsa_group_segment_fixed_size 0
  .amdhsa_kernarg_size 120
  .amdhsa_user_sgpr_count 2
  .amdhsa_user_sgpr_kernarg_segment_ptr 1
  .amdhsa_system_sgpr_workgroup_id_x 1
.end_amdhsa_kernel
```
